```python
import torch

def _softmax(x, axis=-1):
    return torch.softmax(x, dim=axis)
def _gelu(x):
    return torch.nn.functional.gelu(x, approximate="tanh")
def _silu(x):
    return torch.nn.functional.silu(x)
def _sigmoid(x):
    return torch.sigmoid(x)
def _layernorm(x, axis=-1, eps=1e-5):
    m = x.mean(dim=axis, keepdim=True)
    v = x.var(dim=axis, keepdim=True, unbiased=False)
    return (x - m) / torch.sqrt(v + eps)
def _scatter_add(tgt, idx, src, axis=0):
    return tgt.clone().index_add_(axis, idx, src)
def _segment_sum(src, seg, n):
    out = torch.zeros((n,) + src.shape[1:], dtype=src.dtype)
    return out.index_add_(0, seg, src)
def _pad(x, pw):
    flat = tuple(v for pair in reversed(pw) for v in pair)
    return torch.nn.functional.pad(x, flat)

kernel_name = 'parallel_sum__ssm_conv_s5__glu_gated_swiglu__prompt'

def setup_inputs():

    _w = (lambda a: (lambda t: t.to(torch.bfloat16) if t.is_floating_point() else t)(torch.as_tensor(a)))
    def _A_setup():
        B, S, D = 1, 2048, 640
        P = D
        Lambda_re = -0.5 * (lambda _x: torch.exp(torch.as_tensor(_x)))((lambda *s: torch.randn(*s, dtype=torch.bfloat16) * 0.2)(P))
        Lambda_im = (lambda *s: torch.randn(*s, dtype=torch.bfloat16) * 0.8)(P) * 1.0
        B_re = (lambda *s: torch.randn(*s, dtype=torch.bfloat16) * 0.2)(P, D) * (D ** -0.5)
        B_im = (lambda *s: torch.randn(*s, dtype=torch.bfloat16) * 0.2)(P, D) * (D ** -0.5)
        C_re = (lambda *s: torch.randn(*s, dtype=torch.bfloat16) * 0.2)(D, P) * (P ** -0.5)
        C_im = (lambda *s: torch.randn(*s, dtype=torch.bfloat16) * 0.2)(D, P) * (P ** -0.5)
        log_dt = (lambda *s: torch.randn(*s, dtype=torch.bfloat16) * 0.2)(P) * 0.3 - 2.0
        Dskip = (lambda *s: torch.randn(*s, dtype=torch.bfloat16) * 0.05)(D)
        return {
            "x": _w((lambda *s: torch.randn(*s, dtype=torch.bfloat16) * 0.05)(B, S, D)),
            "Lambda_re": _w(Lambda_re),
            "Lambda_im": _w(Lambda_im),
            "B_re": _w(B_re),
            "B_im": _w(B_im),
            "C_re": _w(C_re),
            "C_im": _w(C_im),
            "log_dt": _w(log_dt),
            "Dskip": _w(Dskip),
        }
    _A_in = _A_setup()

    def _B_setup():
        B, S, D, F = 1, 2048, 640, 1728
        return {
            "x": _w((lambda *s: torch.randn(*s, dtype=torch.bfloat16) * 0.05)(B, S, D)),
            "w1": _w((lambda *s: torch.randn(*s, dtype=torch.bfloat16) * 0.4)(D, F) * (2.0 / D) ** 0.5),
            "w3": _w((lambda *s: torch.randn(*s, dtype=torch.bfloat16) * 0.4)(D, F) * (2.0 / D) ** 0.5),
            "w2": _w((lambda *s: torch.randn(*s, dtype=torch.bfloat16) * 0.4)(F, D) * (2.0 / F) ** 0.5),
        }
    _B_in = _B_setup()

    return {
        "A_x": _A_in["x"],
        "A_Lambda_re": _A_in["Lambda_re"],
        "A_Lambda_im": _A_in["Lambda_im"],
        "A_B_re": _A_in["B_re"],
        "A_B_im": _A_in["B_im"],
        "A_C_re": _A_in["C_re"],
        "A_C_im": _A_in["C_im"],
        "A_log_dt": _A_in["log_dt"],
        "A_Dskip": _A_in["Dskip"],
        "B_x": _B_in["x"],
        "B_w1": _B_in["w1"],
        "B_w3": _B_in["w3"],
        "B_w2": _B_in["w2"],
    }

def reference(A_x, A_Lambda_re, A_Lambda_im, A_B_re, A_B_im, A_C_re, A_C_im, A_log_dt, A_Dskip, B_x, B_w1, B_w3, B_w2):
    def _A_ref(x, Lambda_re, Lambda_im, B_re, B_im, C_re, C_im, log_dt, Dskip):
        Bsz, L, H = x.shape
        Lam = Lambda_re + 1j * Lambda_im
        Bmat = B_re + 1j * B_im
        Cmat = C_re + 1j * C_im
        dt = torch.exp(log_dt)
        Lam_bar = torch.exp(dt * Lam)
        B_bar = ((Lam_bar - 1.0) / Lam)[:, None] * Bmat
        Bu = torch.einsum("bld,pd->blp", x + 0j, B_bar)
        h = torch.zeros_like(Bu[:, 0, :])
        hs = []
        for t in range(L):
            h = Lam_bar[None, :] * h + Bu[:, t, :]
            hs.append(h)
        hseq = torch.stack(hs, 1)
        y = 2.0 * torch.einsum("blp,dp->bld", hseq, Cmat).real + x * Dskip[None, None, :]
        return y

    def _B_ref(x, w1, w3, w2):
        gate = torch.einsum("bsd,df->bsf", x, w1)
        up = torch.einsum("bsd,df->bsf", x, w3)
        h = _silu(gate) * up
        out = torch.einsum("bsf,fd->bsd", h, w2)
        return out

    x = A_x
    xn = _layernorm(x, axis=-1)
    return x + _A_ref(xn, A_Lambda_re, A_Lambda_im, A_B_re, A_B_im, A_C_re, A_C_im, A_log_dt, A_Dskip) + _B_ref(xn, B_w1, B_w3, B_w2)
```

```asm
; @launch grid=(256,1,1) block=(256,1,1) lds=163840
.amdgcn_target "amdgcn-amd-amdhsa--gfx950"
.text
.globl parallel_sum__ssm_conv_s5__glu_gated_swiglu__prompt_kernel
.p2align 12
.type parallel_sum__ssm_conv_s5__glu_gated_swiglu__prompt_kernel,@function
parallel_sum__ssm_conv_s5__glu_gated_swiglu__prompt_kernel:
    s_cmp_ge_u32 s2, 256
    s_cbranch_scc1 L_end
    s_load_dwordx16 s[64:79], s[0:1], 0
    s_load_dwordx16 s[80:95], s[0:1], 64
    v_lshrrev_b32 v1, 6, v0
    s_lshr_b32 s4, s2, 3
    v_readfirstlane_b32 s15, v1
    s_getpc_b64 s[16:17]
L_pc:
    s_lshl_b32 s18, s4, 11
    v_lshl_add_u32 v5, v0, 3, s18
    v_min_u32 v5, L_end-L_pc, v5
    global_load_dword a255, v5, s[16:17]
    v_and_b32 v1, 63, v0
    v_lshrrev_b32 v6, 5, v0
    s_lshl_b32 s18, s2, 3
    v_add_u32 v6, s18, v6
    v_and_b32 v7, 31, v0
    v_mul_u32_u24 v5, 1280, v6
    v_lshl_add_u32 v5, v7, 3, v5
    s_and_b32 s3, s2, 7
    s_lshl_b32 s12, s3, 3
    s_mov_b32 s18, 0x28181000
    s_mov_b32 s19, 0x50404030
    s_lshr_b64 s[18:19], s[18:19], s12
    s_and_b32 s13, s18, 0xff
    s_mov_b32 s18, 0x8100810
    s_mov_b32 s19, 0x100010
    s_lshr_b64 s[18:19], s[18:19], s12
    s_and_b32 s11, s18, 0xff
    s_add_u32 s13, s13, s4
    s_mov_b32 s5, 0
    s_lshr_b32 s6, s13, 3
    s_and_b32 s7, s13, 7
    s_cmp_lt_u32 s4, s11
    s_cbranch_scc1 Ldec_1
    s_mov_b32 s18, 0x4e362810
    s_mov_b32 s19, 0xa6867a5c
    s_lshr_b64 s[18:19], s[18:19], s12
    s_and_b32 s13, s18, 0xff
    s_mov_b32 s18, 0x1e201e20
    s_mov_b32 s19, 0x1c201c1e
    s_lshr_b64 s[18:19], s[18:19], s12
    s_and_b32 s11, s18, 0xff
    s_add_u32 s13, s13, s4
    s_sub_u32 s13, s13, 32
    s_mov_b32 s5, 1
    s_mul_i32 s19, s13, 171
    s_lshr_b32 s6, s19, 10
    s_mul_i32 s19, s6, 6
    s_sub_u32 s7, s13, s19
    s_cmp_lt_u32 s4, s11
    s_cbranch_scc1 Ldec_1
    s_mov_b32 s18, 0x2020000
    s_mov_b32 s19, 0xa0a0604
    s_lshr_b64 s[18:19], s[18:19], s12
    s_and_b32 s13, s18, 0xff
    s_mov_b32 s5, 2
    s_add_u32 s13, s13, s4
    s_sub_u32 s7, s13, s11
Ldec_1:
    s_mul_i32 s56, s15, 10240
    s_mul_i32 s53, s7, 40960
    v_lshrrev_b32 v3, 3, v1
    v_and_b32 v4, 7, v1
    s_mov_b32 s11, 24690688
    s_lshr_b32 s17, s15, 1
    s_cmp_eq_u32 s5, 0
    s_cbranch_scc1 L_wssm
    s_lshl_b32 s16, s6, 7
    s_mul_i32 s17, s17, 384
    s_add_u32 s17, s17, s7
    s_mul_i32 s17, s17, 3456
    s_add_u32 s19, s16, s17
    v_mul_u32_u24 v12, 20736, v1
    v_and_b32 v32, 2, v3
    v_xor_b32 v32, v4, v32
    v_mul_u32_u24 v33, 3456, v3
    v_lshl_add_u32 v32, v32, 4, v33
    v_xor_b32 v33, 64, v32
    v_mov_b32 v34, v32
    v_mov_b32 v35, v33
    s_mul_i32 s62, s15, 276480
    s_add_u32 s62, s62, s16
    s_mov_b32 s59, 27648
    s_mov_b32 s60, 138240
    s_mov_b32 s61, 1105920
    s_waitcnt lgkmcnt(0)
    s_load_dword s14, s[94:95], s11
    s_mov_b64 s[32:33], s[84:85]
    s_mov_b32 s34, 2211840
    s_mov_b32 s35, 0x20000
    s_cmp_eq_u32 s5, 2
    s_cselect_b32 s34, 0, s34
    s_mov_b64 s[36:37], s[86:87]
    s_mov_b64 s[38:39], s[34:35]
    s_bitcmp1_b32 s15, 0
    s_cselect_b32 s44, s86, s84
    s_cselect_b32 s45, s87, s85
    s_mov_b32 s46, s34
    s_mov_b32 s47, 0x20000
    buffer_load_dword a254, v12, s[44:47], s19 offen
    s_mov_b64 s[20:21], s[64:65]
    s_mov_b32 s22, 2621440
    s_mov_b32 s23, 0x20000
    buffer_load_dwordx2 v[72:73], v5, s[20:23], 0 offen offset:0
    buffer_load_dwordx2 v[74:75], v5, s[20:23], 0 offen offset:256
    buffer_load_dwordx2 v[76:77], v5, s[20:23], 0 offen offset:512
    buffer_load_dwordx2 v[78:79], v5, s[20:23], 0 offen offset:768
    buffer_load_dwordx2 v[80:81], v5, s[20:23], 0 offen offset:1024
    s_mov_b32 s65, 245760
    v_lshrrev_b32 v16, 4, v1
    v_bfe_u32 v17, v1, 2, 2
    v_and_b32 v18, 3, v1
    v_and_b32 v19, 1, v16
    v_lshrrev_b32 v20, 1, v17
    v_lshl_add_u32 v19, v19, 1, v20
    v_xor_b32 v19, s15, v19
    v_lshlrev_b32 v19, 5, v19
    v_lshl_add_u32 v19, v18, 3, v19
    v_lshl_add_u32 v19, v17, 7, v19
    v_lshl_add_u32 v36, v16, 10, v19
    v_add_u32 v37, 40960, v36
    v_add_u32 v38, 122880, v36
    v_and_b32 v17, 15, v1
    v_lshrrev_b32 v18, 3, v17
    v_mul_u32_u24 v18, 10240, v18
    v_and_b32 v19, 7, v17
    v_lshl_add_u32 v18, v19, 7, v18
    v_lshrrev_b32 v19, 1, v17
    v_xor_b32 v19, v19, v16
    v_lshl_add_u32 v18, v19, 4, v18
    v_add_u32 v8, 81920, v18
    v_xor_b32 v9, 64, v8
    s_branch L_wjoin
L_wssm:
    s_mul_i32 s16, s6, 81920
    s_mul_i32 s17, s17, 5120
    s_add_u32 s19, s16, s17
    s_mul_i32 s17, s7, 10240
    s_add_u32 s19, s19, s17
    v_min_u32 v12, 39, v1
    v_lshlrev_b32 v12, 7, v12
    v_lshrrev_b32 v32, 1, v3
    v_xor_b32 v32, v4, v32
    v_mul_u32_u24 v33, 1280, v3
    v_lshl_add_u32 v32, v32, 4, v33
    v_mov_b32 v33, v32
    v_xor_b32 v34, 64, v32
    v_mov_b32 v35, v34
    s_mul_i32 s62, s15, 20480
    s_add_u32 s62, s62, s16
    s_mov_b32 s59, 128
    s_mov_b32 s60, 10240
    s_mov_b32 s61, 640
    s_waitcnt lgkmcnt(0)
    s_load_dword s14, s[94:95], s11
    s_mov_b64 s[32:33], s[70:71]
    s_mov_b32 s34, 819200
    s_mov_b32 s35, 0x20000
    s_mov_b64 s[36:37], s[72:73]
    s_mov_b64 s[38:39], s[34:35]
    s_bitcmp1_b32 s15, 0
    s_cselect_b32 s44, s72, s70
    s_cselect_b32 s45, s73, s71
    s_mov_b32 s46, s34
    s_mov_b32 s47, 0x20000
    buffer_load_dword a254, v12, s[44:47], s19 offen
    s_mov_b64 s[20:21], s[64:65]
    s_mov_b32 s22, 2621440
    s_mov_b32 s23, 0x20000
    buffer_load_dwordx2 v[72:73], v5, s[20:23], 0 offen offset:0
    buffer_load_dwordx2 v[74:75], v5, s[20:23], 0 offen offset:256
    buffer_load_dwordx2 v[76:77], v5, s[20:23], 0 offen offset:512
    buffer_load_dwordx2 v[78:79], v5, s[20:23], 0 offen offset:768
    buffer_load_dwordx2 v[80:81], v5, s[20:23], 0 offen offset:1024
    s_lshl_b32 s52, s6, 2
    s_add_u32 s52, s52, s15
    s_lshl_b32 s17, s52, 5
    v_and_b32 v16, 30, v1
    v_add_u32 v16, s17, v16
    global_load_ushort v88, v16, s[66:67]
    global_load_ushort v89, v16, s[68:69]
    global_load_ushort v90, v16, s[78:79]
    s_mov_b32 s65, 327680
    v_and_b32 v14, 1, v1
    v_bfe_u32 v19, v1, 1, 4
    v_lshrrev_b32 v20, 5, v1
    v_bfe_u32 v16, v19, 1, 2
    v_lshl_add_u32 v16, v14, 2, v16
    v_xor_b32 v16, v16, v20
    v_lshlrev_b32 v16, 4, v16
    v_and_b32 v17, 7, v19
    v_lshlrev_b32 v17, 7, v17
    v_lshrrev_b32 v18, 3, v19
    v_mul_u32_u24 v18, 5120, v18
    v_add3_u32 v17, v17, v18, s56
    v_mul_u32_u24 v18, 40960, v14
    v_add_u32 v17, v17, v18
    v_xor_b32 v36, 0, v16
    v_add_u32 v36, v36, v17
    v_xor_b32 v37, 32, v16
    v_add_u32 v37, v37, v17
    v_xor_b32 v38, 64, v16
    v_add_u32 v38, v38, v17
    v_xor_b32 v39, 96, v16
    v_add_u32 v39, v39, v17
    v_and_b32 v16, 31, v1
    v_lshrrev_b32 v17, 3, v16
    v_mul_u32_u24 v17, 10240, v17
    v_and_b32 v18, 7, v16
    v_lshl_add_u32 v17, v18, 7, v17
    v_bfe_u32 v18, v16, 1, 3
    v_xor_b32 v18, v18, v20
    v_lshl_add_u32 v17, v18, 4, v17
    v_add_u32 v8, 81920, v17
    v_xor_b32 v9, 32, v8
    v_xor_b32 v10, 64, v8
    v_xor_b32 v11, 96, v8
L_wjoin:
    v_mul_u32_u24 v16, 20, v1
    global_load_dword a253, v16, s[80:81]
    v_lshlrev_b32 v2, 4, v1
    v_and_b32 v12, 4, v3
    v_lshlrev_b32 v12, 2, v12
    v_and_b32 v16, 3, v3
    s_lshl_b32 s16, s15, 2
    v_add3_u32 v12, v12, v16, s16
    v_mul_u32_u24 v12, 1280, v12
    v_lshrrev_b32 v16, 1, v3
    s_and_b32 s16, s16, 4
    v_xor_b32 v16, v16, v4
    v_xor_b32 v16, s16, v16
    v_lshl_add_u32 v12, v16, 4, v12
    s_add_u32 s28, s94, 24690688
    s_addc_u32 s29, s95, 0
    s_mov_b32 s30, 942208
    s_mov_b32 s31, 0x20000
    v_mov_b32 v15, 0
    v_lshlrev_b32 v82, 6, v6
    v_lshl_add_u32 v82, v7, 3, v82
    v_add_u32 v82, 811136, v82
    v_cmp_gt_u32 vcc, 8, v7
    v_mov_b32 v3, 2146435072
    v_mov_b32 v44, 0x3f803f80
    v_mov_b32 v45, v44
    v_mov_b32 v46, v44
    v_mov_b32 v47, v44
    v_cndmask_b32 v82, v3, v82, vcc
    v_mov_b32 v68, 0
    v_mov_b32 v69, 0
    v_cmp_lt_u32 s[82:83], 31, v1
    s_add_u32 s24, s94, 2621440
    s_addc_u32 s25, s95, 0
    s_mov_b32 s26, 12320768
    s_mov_b32 s27, 0x20000
    s_bfe_u32 s8, s3, 0x10001
    s_and_b32 s9, s3, 1
    s_lshl_b32 s9, s9, 3
    s_and_b32 s13, s3, 4
    s_add_u32 s9, s9, s13
    s_lshr_b32 s13, s4, 3
    s_add_u32 s9, s9, s13
    s_and_b32 s10, s4, 7
    s_lshl_b32 s92, s9, 1
    s_add_u32 s92, s92, s8
    s_mul_i32 s16, s15, 12
    s_add_u32 s17, s16, 10
    s_mul_i32 s18, s15, 10
    s_add_u32 s18, s18, 54
    s_lshl_b32 s19, s15, 1
    s_add_u32 s19, s19, 47
    s_cmp_eq_u32 s8, 0
    s_cselect_b32 s16, s16, s18
    s_cselect_b32 s17, s17, s19
    s_lshl_b32 s93, s16, 10
    s_lshl_b32 s100, s17, 10
    s_add_u32 s101, s100, 1024
    s_cmp_eq_u32 s15, 3
    s_cselect_b32 s101, 2146435072, s101
    s_mul_i32 s18, s10, 94
    s_add_u32 s16, s16, s18
    s_add_u32 s17, s17, s18
    s_mul_i32 s48, s16, 5120
    s_mul_i32 s49, s17, 5120
    s_add_u32 s84, s49, 5120
    s_cmp_eq_u32 s15, 3
    s_cselect_b32 s84, 2146435072, s84
    s_add_u32 s40, s94, 14942208
    s_addc_u32 s41, s95, 0
    s_mov_b32 s42, 3850240
    s_mov_b32 s43, 0x20000
    s_lshr_b32 s16, s93, 10
    s_lshr_b32 s17, s100, 10
    s_cmp_eq_u32 s8, 0
    s_cselect_b32 s16, s16, s17
    s_cselect_b32 s17, 11, 1
    s_cselect_b32 s18, 64, 4
    v_lshrrev_b32 v7, 1, v1
    v_min_u32 v7, s17, v7
    v_add_u32 v7, s16, v7
    v_min_u32 v7, 53, v7
    s_lshl_b32 s16, s10, 1
    v_lshl_add_u32 v7, v7, 4, s16
    v_and_b32 v16, 1, v1
    v_add_u32 v7, v7, v16
    v_subrev_u32 v16, 4, v1
    v_min_u32 v16, 24, v16
    v_mul_u32_u24 v17, 52, v16
    v_lshrrev_b32 v17, 8, v17
    v_mul_u32_u24 v17, 5, v17
    v_add_u32 v16, v16, v17
    s_lshr_b32 s16, s15, 1
    s_mul_i32 s16, s16, 400
    s_mul_i32 s17, s10, 50
    s_add_u32 s16, s16, s17
    s_and_b32 s17, s15, 1
    s_mul_i32 s17, s17, 5
    s_add_u32 s16, s16, s17
    s_add_u32 s16, s16, 160
    v_add_u32 v16, s16, v16
    v_cmp_gt_u32 vcc, s18, v1
    v_and_b32 v16, 1023, v16
    s_nop 0
    v_cndmask_b32 v7, v16, v7, vcc
    v_lshlrev_b32 v7, 7, v7
    s_lshl_b32 s11, s2, 2
    s_add_u32 s11, s11, s15
    s_lshr_b32 s12, s11, 4
    s_bfe_u32 s16, s11, 0x30001
    s_and_b32 s17, s11, 1
    s_mul_i32 s18, s12, 40960
    s_mul_i32 s19, s16, 160
    s_add_u32 s18, s18, s19
    s_mul_i32 s19, s17, 96
    s_add_u32 s85, s18, s19
    s_mul_i32 s16, s16, 94
    s_add_u32 s16, s16, s12
    s_mul_i32 s16, s16, 5
    s_mul_i32 s17, s17, 3
    s_add_u32 s16, s16, s17
    s_lshl_b32 s16, s16, 10
    s_cmp_lt_u32 s12, 54
    s_cselect_b32 s57, s16, 2146435072
    s_mul_i32 s86, s15, 5120
    s_add_u32 s86, s86, 122880
    v_add_u32 v16, 0, v1
    v_mul_u32_u24 v17, 171, v16
    v_lshrrev_b32 v17, 10, v17
    v_mul_u32_u24 v17, 1184, v17
    v_lshl_add_u32 v40, v16, 4, v17
    v_add_u32 v16, 64, v1
    v_mul_u32_u24 v17, 171, v16
    v_lshrrev_b32 v17, 10, v17
    v_mul_u32_u24 v17, 1184, v17
    v_lshl_add_u32 v41, v16, 4, v17
    v_add_u32 v16, 128, v1
    v_mul_u32_u24 v17, 171, v16
    v_lshrrev_b32 v17, 10, v17
    v_mul_u32_u24 v17, 1184, v17
    v_lshl_add_u32 v42, v16, 4, v17
    v_lshrrev_b32 v16, 3, v1
    v_mul_u32_u24 v16, 1152, v16
    v_add_u32 v43, v16, v2
    v_lshrrev_b32 v16, 4, v1
    v_bfe_u32 v17, v1, 2, 2
    v_lshl_add_u32 v17, v16, 3, v17
    v_mul_u32_u24 v17, 96, v17
    v_and_b32 v18, 3, v1
    v_lshl_add_u32 v17, v18, 3, v17
    v_add_u32 v4, s86, v17
    v_and_b32 v18, 15, v1
    v_lshlrev_b32 v18, 7, v18
    v_lshl_add_u32 v18, v16, 4, v18
    v_add_u32 v5, s86, v18
    s_add_u32 s11, s11, 864
    s_and_b32 s11, s11, 1023
    s_cmp_ge_u32 s11, 400
    s_cselect_b32 s74, s76, s74
    s_cselect_b32 s75, s77, s75
    s_cselect_b32 s12, 400, 0
    s_cselect_b32 s16, 74, 54
    s_sub_u32 s12, s11, s12
    s_mul_hi_u32 s17, s12, 429496730
    s_mul_i32 s18, s17, 10
    s_sub_u32 s12, s12, s18
    s_mul_i32 s18, s17, 20480
    s_lshl_b32 s19, s12, 7
    s_add_u32 s87, s18, s19
    s_mul_hi_u32 s18, s17, 858993460
    s_mul_i32 s19, s18, 5
    s_sub_u32 s17, s17, s19
    s_mul_i32 s18, s18, 94
    s_add_u32 s18, s18, s16
    s_lshl_b32 s12, s12, 1
    s_add_u32 s18, s18, s12
    s_mul_i32 s18, s18, 5
    s_add_u32 s18, s18, s17
    s_lshl_b32 s18, s18, 10
    s_cmp_lt_u32 s11, 800
    s_cselect_b32 s58, s18, 2146435072
    s_lshl_b32 s16, s2, 2
    s_add_u32 s16, s16, s15
    s_lshl_b32 s16, s16, 7
    v_lshlrev_b32 v3, 25, v1
    v_and_b32 v3, 0x40000000, v3
    v_lshl_add_u32 v3, v1, 2, v3
    v_add_u32 v3, s16, v3
    s_mov_b32 s51, 548992
    s_cmp_eq_u32 s5, 0
    s_cbranch_scc1 L_essm
    v_lshrrev_b32 v16, 4, v1
    v_and_b32 v17, 15, v1
    v_lshlrev_b32 v17, 4, v17
    v_add_u32 v0, 143360, v17
    v_and_b32 v18, 1, v16
    v_mul_u32_u24 v18, 96256, v18
    v_lshrrev_b32 v19, 1, v16
    v_lshl_add_u32 v18, v19, 8, v18
    s_lshl_b32 s16, s6, 2
    s_add_u32 s16, s16, s15
    s_lshl_b32 s16, s16, 9
    v_add3_u32 v10, v18, v17, s16
    s_mul_i32 s54, s7, 192512
    s_lshl_b32 s16, s6, 7
    s_cmp_eq_u32 s15, 0
    s_cselect_b32 s16, s16, 2146435072
    v_lshlrev_b32 v11, 25, v1
    v_and_b32 v11, 0x40000000, v11
    v_lshl_add_u32 v11, v1, 2, v11
    v_add_u32 v11, s16, v11
    v_lshrrev_b32 v19, 5, v1
    v_mul_u32_u24 v19, 49024, v19
    v_lshl_add_u32 v14, v1, 2, v19
    v_add_u32 v14, s16, v14
    s_mov_b32 s64, 536608768
    s_lshl_b32 s55, s7, 13
    s_add_u32 s55, s55, 8320
    v_and_b32 v17, 31, v1
    v_and_b32 v18, 4, v17
    v_lshlrev_b32 v18, 2, v18
    v_and_b32 v19, 3, v17
    v_add_u32 v18, v18, v19
    v_lshrrev_b32 v19, 3, v17
    v_lshl_add_u32 v18, v19, 2, v18
    v_lshlrev_b32 v18, 6, v18
    v_lshrrev_b32 v19, 5, v1
    v_lshlrev_b32 v19, 2, v19
    v_add_u32 v19, s15, v19
    v_lshlrev_b32 v17, 4, v17
    v_lshl_add_u32 v91, v19, 9, v17
    v_add_u32 v91, 143360, v91
    v_mul_u32_u24 v19, 12288, v19
    s_lshl_b32 s16, s7, 11
    s_add_u32 s16, s16, 811136
    v_add3_u32 v90, v19, v18, s16
    s_add_u32 s17, s15, 8
    s_min_u32 s17, s17, 10
    s_lshl_b32 s18, s17, 9
    s_add_u32 s18, s18, 143360
    v_add_u32 v95, s18, v17
    s_mul_i32 s17, s17, 6
    s_add_u32 s17, s17, s7
    s_min_u32 s17, s17, 63
    s_lshl_b32 s17, s17, 11
    s_add_u32 s17, s17, 811136
    v_add_u32 v94, s17, v18
    s_mov_b64 exec, 0
    s_cmp_eq_u32 s15, 0
    s_cbranch_scc1 L_chain4
    s_cmp_eq_u32 s15, 1
    s_cbranch_scc1 L_chain5
    s_cmp_eq_u32 s15, 2
    s_cbranch_scc1 L_chain6
    s_branch L_chain7
L_essm:
    v_and_b32 v16, 31, v1
    v_lshrrev_b32 v19, 5, v1
    v_lshlrev_b32 v17, 2, v19
    v_add_u32 v17, s15, v17
    v_lshlrev_b32 v18, 7, v17
    v_lshl_add_u32 v18, v16, 2, v18
    v_add_u32 v31, 143360, v18
    v_lshlrev_b32 v17, 14, v17
    v_lshl_add_u32 v17, v16, 6, v17
    s_lshl_b32 s16, s7, 11
    s_add_u32 s16, s16, 811136
    v_add_u32 v30, s16, v17
    v_lshlrev_b32 v17, 6, v19
    v_add_u32 v0, 143360, v17
    v_add_u32 v24, 2688, v12
    v_add_u32 v25, 1792, v12
    v_add_u32 v26, 896, v12
    s_lshl_b32 s16, s52, 14
    s_add_u32 s16, s16, 18792448
    s_add_u32 s44, s94, s16
    s_addc_u32 s45, s95, 0
    s_mov_b32 s46, 16384
    s_mov_b32 s47, 0x20000
    s_mov_b32 s72, 0
    s_mov_b32 s73, 0
    v_and_b32 v16, 31, v1
    v_lshrrev_b32 v17, 5, v1
    v_lshlrev_b32 v18, 3, v16
    s_lshl_b32 s16, s7, 8
    v_add_u32 v169, s16, v18
    v_lshl_add_u32 v170, v17, 10, v18
    v_mul_u32_u24 v171, 80, v16
    v_lshl_add_u32 v171, v17, 5, v171
    v_add_u32 v171, s86, v171
    v_bfe_u32 v18, v1, 4, 1
    v_bfe_u32 v19, v1, 2, 2
    v_lshl_add_u32 v19, v18, 3, v19
    v_lshl_add_u32 v19, v19, 1, v17
    v_mul_u32_u24 v19, 80, v19
    v_and_b32 v18, 1, v1
    v_lshl_add_u32 v19, v18, 5, v19
    v_bfe_u32 v18, v1, 1, 1
    v_lshl_add_u32 v19, v18, 3, v19
    v_add_u32 v172, s86, v19
    v_mul_u32_u24 v173, 20480, v17
    v_lshl_add_u32 v173, v16, 4, v173
    s_lshl_b32 s16, s52, 9
    s_add_u32 s16, s16, 55296
    v_add_u32 v173, s16, v173
    s_mul_i32 s54, s7, 192512
    s_lshl_b32 s55, s7, 13
    s_add_u32 s55, s55, 8320
    v_and_b32 v16, 4, v1
    v_lshlrev_b32 v16, 2, v16
    v_and_b32 v17, 3, v1
    v_add_u32 v16, v16, v17
    v_bfe_u32 v17, v1, 3, 2
    v_lshl_add_u32 v16, v17, 2, v16
    v_lshlrev_b32 v16, 2, v16
    v_add_u32 v27, 144384, v16
    s_mov_b64 exec, 0
    s_cmp_eq_u32 s15, 0
    s_cbranch_scc1 L_chain0
    s_cmp_eq_u32 s15, 1
    s_cbranch_scc1 L_chain1
    s_cmp_eq_u32 s15, 2
    s_cbranch_scc1 L_chain2
    s_branch L_chain3
.p2align 12
L_hback:
    s_mov_b64 exec, -1
    s_mov_b32 s11, 0xffff0000
    s_add_u32 m0, s56, 0
    s_mov_b32 s63, s62
    buffer_load_dwordx4 v32, s[32:35], s63 offen lds
    s_add_u32 m0, s56, 40960
    s_nop 0
    buffer_load_dwordx4 v34, s[36:39], s63 offen lds
    s_add_u32 m0, s56, 1024
    s_add_u32 s63, s63, s59
    buffer_load_dwordx4 v33, s[32:35], s63 offen lds
    s_add_u32 m0, s56, 41984
    s_nop 0
    buffer_load_dwordx4 v35, s[36:39], s63 offen lds
    s_add_u32 m0, s56, 2048
    s_add_u32 s63, s63, s59
    buffer_load_dwordx4 v32, s[32:35], s63 offen lds
    s_add_u32 m0, s56, 43008
    s_nop 0
    buffer_load_dwordx4 v34, s[36:39], s63 offen lds
    s_waitcnt vmcnt(7)
    v_dot2c_f32_bf16 v68, v72, v44
    v_dot2c_f32_bf16 v69, v73, v44
    v_dot2c_f32_bf16 v68, v74, v44
    s_add_u32 m0, s56, 3072
    s_add_u32 s63, s63, s59
    buffer_load_dwordx4 v33, s[32:35], s63 offen lds
    s_add_u32 m0, s56, 44032
    v_dot2c_f32_bf16 v69, v75, v44
    v_dot2c_f32_bf16 v68, v76, v44
    v_dot2c_f32_bf16 v69, v77, v44
    buffer_load_dwordx4 v35, s[36:39], s63 offen lds
    v_dot2c_f32_bf16 v68, v78, v44
    v_dot2c_f32_bf16 v69, v79, v44
    v_dot2c_f32_bf16 v68, v80, v44
    s_add_u32 m0, s56, 4096
    s_add_u32 s63, s63, s59
    buffer_load_dwordx4 v32, s[32:35], s63 offen lds
    s_add_u32 m0, s56, 45056
    v_dot2c_f32_bf16 v69, v81, v44
    v_lshlrev_b32 v48, 16, v72
    v_and_b32 v49, s11, v72
    buffer_load_dwordx4 v34, s[36:39], s63 offen lds
    v_lshlrev_b32 v50, 16, v73
    v_and_b32 v51, s11, v73
    v_lshlrev_b32 v52, 16, v74
    v_and_b32 v53, s11, v74
    s_add_u32 m0, s56, 5120
    s_add_u32 s63, s62, s60
    buffer_load_dwordx4 v33, s[32:35], s63 offen lds
    s_add_u32 m0, s56, 46080
    v_lshlrev_b32 v54, 16, v75
    v_and_b32 v55, s11, v75
    v_lshlrev_b32 v56, 16, v76
    buffer_load_dwordx4 v35, s[36:39], s63 offen lds
    v_and_b32 v57, s11, v76
    v_lshlrev_b32 v58, 16, v77
    v_and_b32 v59, s11, v77
    s_add_u32 m0, s56, 6144
    s_add_u32 s63, s63, s59
    buffer_load_dwordx4 v32, s[32:35], s63 offen lds
    s_add_u32 m0, s56, 47104
    v_lshlrev_b32 v60, 16, v78
    v_and_b32 v61, s11, v78
    v_lshlrev_b32 v62, 16, v79
    buffer_load_dwordx4 v34, s[36:39], s63 offen lds
    v_and_b32 v63, s11, v79
    v_lshlrev_b32 v64, 16, v80
    v_and_b32 v65, s11, v80
    s_add_u32 m0, s56, 7168
    s_add_u32 s63, s63, s59
    buffer_load_dwordx4 v33, s[32:35], s63 offen lds
    s_add_u32 m0, s56, 48128
    v_lshlrev_b32 v66, 16, v81
    v_and_b32 v67, s11, v81
    v_add_f32 v68, v68, v69
    s_nop 1
    v_add_f32_dpp v68, v68, v68 row_ror:8 row_mask:0xf bank_mask:0xf
    buffer_load_dwordx4 v35, s[36:39], s63 offen lds
    s_nop 0
    v_add_f32_dpp v68, v68, v68 row_ror:4 row_mask:0xf bank_mask:0xf
    s_nop 1
    v_add_f32_dpp v68, v68, v68 row_ror:2 row_mask:0xf bank_mask:0xf
    s_nop 1
    v_add_f32_dpp v68, v68, v68 row_ror:1 row_mask:0xf bank_mask:0xf
    s_add_u32 m0, s56, 8192
    s_add_u32 s63, s63, s59
    buffer_load_dwordx4 v32, s[32:35], s63 offen lds
    s_add_u32 m0, s56, 49152
    v_mov_b32 v69, v68
    s_nop 1
    v_permlane16_swap_b32 v68, v69
    v_add_f32 v68, v68, v69
    buffer_load_dwordx4 v34, s[36:39], s63 offen lds
    v_mul_f32 v68, 0xbacccccd, v68
    v_pk_add_f32 v[48:49], v[48:49], v[68:69] op_sel_hi:[1,0]
    v_pk_add_f32 v[50:51], v[50:51], v[68:69] op_sel_hi:[1,0]
    s_add_u32 m0, s56, 9216
    s_add_u32 s63, s63, s59
    buffer_load_dwordx4 v33, s[32:35], s63 offen lds
    s_add_u32 m0, s56, 50176
    v_pk_add_f32 v[52:53], v[52:53], v[68:69] op_sel_hi:[1,0]
    v_pk_add_f32 v[54:55], v[54:55], v[68:69] op_sel_hi:[1,0]
    v_pk_add_f32 v[56:57], v[56:57], v[68:69] op_sel_hi:[1,0]
    buffer_load_dwordx4 v35, s[36:39], s63 offen lds
    v_pk_add_f32 v[58:59], v[58:59], v[68:69] op_sel_hi:[1,0]
    v_pk_add_f32 v[60:61], v[60:61], v[68:69] op_sel_hi:[1,0]
    v_pk_add_f32 v[62:63], v[62:63], v[68:69] op_sel_hi:[1,0]
    v_pk_add_f32 v[64:65], v[64:65], v[68:69] op_sel_hi:[1,0]
    s_add_u32 m0, s56, 81920
    s_nop 0
    buffer_load_dwordx4 v12, s[20:23], s53 offen offset:0 lds
    s_add_u32 m0, s56, 82816
    v_pk_add_f32 v[66:67], v[66:67], v[68:69] op_sel_hi:[1,0]
    v_pk_mul_f32 v[70:71], v[48:49], v[48:49]
    v_pk_fma_f32 v[70:71], v[50:51], v[50:51], v[70:71]
    buffer_load_dwordx4 v12, s[20:23], s53 offen offset:128 lds
    s_add_u32 m0, s56, 83712
    v_pk_fma_f32 v[70:71], v[52:53], v[52:53], v[70:71]
    v_pk_fma_f32 v[70:71], v[54:55], v[54:55], v[70:71]
    v_pk_fma_f32 v[70:71], v[56:57], v[56:57], v[70:71]
    buffer_load_dwordx4 v12, s[20:23], s53 offen offset:256 lds
    s_add_u32 m0, s56, 84608
    v_pk_fma_f32 v[70:71], v[58:59], v[58:59], v[70:71]
    v_pk_fma_f32 v[70:71], v[60:61], v[60:61], v[70:71]
    v_pk_fma_f32 v[70:71], v[62:63], v[62:63], v[70:71]
    buffer_load_dwordx4 v12, s[20:23], s53 offen offset:384 lds
    s_add_u32 m0, s56, 85504
    v_pk_fma_f32 v[70:71], v[64:65], v[64:65], v[70:71]
    v_pk_fma_f32 v[70:71], v[66:67], v[66:67], v[70:71]
    v_add_f32 v70, v70, v71
    buffer_load_dwordx4 v12, s[20:23], s53 offen offset:512 lds
    s_add_u32 m0, s56, 86400
    v_add_f32_dpp v70, v70, v70 row_ror:8 row_mask:0xf bank_mask:0xf
    s_nop 1
    v_add_f32_dpp v70, v70, v70 row_ror:4 row_mask:0xf bank_mask:0xf
    s_nop 1
    v_add_f32_dpp v70, v70, v70 row_ror:2 row_mask:0xf bank_mask:0xf
    s_nop 1
    v_add_f32_dpp v70, v70, v70 row_ror:1 row_mask:0xf bank_mask:0xf
    buffer_load_dwordx4 v12, s[20:23], s53 offen offset:640 lds
    s_add_u32 m0, s56, 87296
    v_mov_b32 v71, v70
    s_nop 1
    v_permlane16_swap_b32 v70, v71
    v_add_f32 v70, v70, v71
    buffer_load_dwordx4 v12, s[20:23], s53 offen offset:768 lds
    s_add_u32 m0, s56, 88192
    v_mul_f32 v70, 0x3acccccd, v70
    v_cvt_pk_bf16_f32 v70, v70, v70
    v_and_b32 v70, 0xffff0000, v70
    buffer_load_dwordx4 v12, s[20:23], s53 offen offset:896 lds
    s_add_u32 m0, s56, 89088
    v_add_f32 v70, 0x3727c5ac, v70
    v_cvt_pk_bf16_f32 v70, v70, v70
    v_and_b32 v70, 0xffff0000, v70
    buffer_load_dwordx4 v12, s[20:23], s53 offen offset:1024 lds
    s_add_u32 m0, s56, 89984
    v_sqrt_f32 v70, v70
    v_mov_b32 v6, v82
    v_cvt_pk_bf16_f32 v70, v68, v70
    buffer_load_dwordx4 v12, s[20:23], s53 offen offset:1152 lds
    s_add_u32 m0, s56, 40960
    s_add_u32 s53, s53, s65
    s_waitcnt lgkmcnt(0)
    s_mul_i32 s14, s14, 0x9e3779b1
    s_add_u32 s14, s14, 0x7f4a7c15
    v_mov_b32 v71, s14
    v_mov_b32 v13, s14
    buffer_store_dwordx2 v[70:71], v6, s[28:31], 0 offen sc1
    s_waitcnt vmcnt(11)
    s_cmp_eq_u32 s5, 0
    s_cbranch_scc1 L_ssm
    s_cmp_eq_u32 s5, 2
    s_cbranch_scc1 L_spare
    s_barrier
    ds_read_b64_tr_b16 v[96:97], v36 offset:0
    ds_read_b64_tr_b16 v[98:99], v36 offset:512
    ds_read_b64_tr_b16 v[100:101], v37 offset:0
    ds_read_b64_tr_b16 v[102:103], v37 offset:512
    ds_read_b64_tr_b16 v[104:105], v36 offset:4096
    ds_read_b64_tr_b16 v[106:107], v36 offset:4608
    ds_read_b64_tr_b16 v[108:109], v37 offset:4096
    s_add_u32 m0, s56, 122880
    s_add_u32 s62, s62, s61
    s_mov_b32 s63, s62
    buffer_load_dwordx4 v32, s[32:35], s63 offen lds
    ds_read_b64_tr_b16 v[110:111], v37 offset:4608
    ds_read_b64_tr_b16 v[112:113], v36 offset:8192
    ds_read_b64_tr_b16 v[114:115], v36 offset:8704
    ds_read_b64_tr_b16 v[116:117], v37 offset:8192
    ds_read_b64_tr_b16 v[118:119], v37 offset:8704
    s_waitcnt lgkmcnt(8)
    v_mfma_f32_16x16x32_bf16 v[80:83], v[96:99], v[44:47], 0
    s_add_u32 m0, s56, 123904
    s_add_u32 s63, s63, s59
    buffer_load_dwordx4 v33, s[32:35], s63 offen lds
    v_mfma_f32_16x16x32_bf16 v[84:87], v[100:103], v[44:47], 0
    ds_read_b64_tr_b16 v[120:121], v36 offset:12288
    ds_read_b64_tr_b16 v[122:123], v36 offset:12800
    ds_read_b64_tr_b16 v[124:125], v37 offset:12288
    ds_read_b64_tr_b16 v[126:127], v37 offset:12800
    s_waitcnt lgkmcnt(8)
    v_mfma_f32_16x16x32_bf16 v[80:83], v[104:107], v[44:47], v[80:83]
    s_add_u32 m0, s56, 124928
    s_add_u32 s63, s63, s59
    buffer_load_dwordx4 v32, s[32:35], s63 offen lds
    v_mfma_f32_16x16x32_bf16 v[84:87], v[108:111], v[44:47], v[84:87]
    ds_read_b64_tr_b16 v[128:129], v36 offset:16384
    ds_read_b64_tr_b16 v[130:131], v36 offset:16896
    ds_read_b64_tr_b16 v[132:133], v37 offset:16384
    ds_read_b64_tr_b16 v[134:135], v37 offset:16896
    s_waitcnt lgkmcnt(8)
    v_mfma_f32_16x16x32_bf16 v[80:83], v[112:115], v[44:47], v[80:83]
    s_add_u32 m0, s56, 125952
    s_add_u32 s63, s63, s59
    buffer_load_dwordx4 v33, s[32:35], s63 offen lds
    v_mfma_f32_16x16x32_bf16 v[84:87], v[116:119], v[44:47], v[84:87]
    ds_read_b64_tr_b16 v[136:137], v36 offset:20480
    ds_read_b64_tr_b16 v[138:139], v36 offset:20992
    ds_read_b64_tr_b16 v[140:141], v37 offset:20480
    ds_read_b64_tr_b16 v[142:143], v37 offset:20992
    s_waitcnt lgkmcnt(8)
    v_mfma_f32_16x16x32_bf16 v[80:83], v[120:123], v[44:47], v[80:83]
    s_add_u32 m0, s56, 126976
    s_add_u32 s63, s63, s59
    buffer_load_dwordx4 v32, s[32:35], s63 offen lds
    v_mfma_f32_16x16x32_bf16 v[84:87], v[124:127], v[44:47], v[84:87]
    ds_read_b64_tr_b16 v[144:145], v36 offset:24576
    ds_read_b64_tr_b16 v[146:147], v36 offset:25088
    ds_read_b64_tr_b16 v[148:149], v37 offset:24576
    ds_read_b64_tr_b16 v[150:151], v37 offset:25088
    s_waitcnt lgkmcnt(8)
    v_mfma_f32_16x16x32_bf16 v[80:83], v[128:131], v[44:47], v[80:83]
    s_add_u32 m0, s56, 128000
    s_add_u32 s63, s62, s60
    buffer_load_dwordx4 v33, s[32:35], s63 offen lds
    v_mfma_f32_16x16x32_bf16 v[84:87], v[132:135], v[44:47], v[84:87]
    ds_read_b64_tr_b16 v[152:153], v36 offset:28672
    ds_read_b64_tr_b16 v[154:155], v36 offset:29184
    ds_read_b64_tr_b16 v[156:157], v37 offset:28672
    ds_read_b64_tr_b16 v[158:159], v37 offset:29184
    s_waitcnt lgkmcnt(8)
    v_mfma_f32_16x16x32_bf16 v[80:83], v[136:139], v[44:47], v[80:83]
    s_add_u32 m0, s56, 129024
    s_add_u32 s63, s63, s59
    buffer_load_dwordx4 v32, s[32:35], s63 offen lds
    v_mfma_f32_16x16x32_bf16 v[84:87], v[140:143], v[44:47], v[84:87]
    ds_read_b64_tr_b16 v[160:161], v36 offset:32768
    ds_read_b64_tr_b16 v[162:163], v36 offset:33280
    ds_read_b64_tr_b16 v[164:165], v37 offset:32768
    ds_read_b64_tr_b16 v[166:167], v37 offset:33280
    s_waitcnt lgkmcnt(8)
    v_mfma_f32_16x16x32_bf16 v[80:83], v[144:147], v[44:47], v[80:83]
    s_add_u32 m0, s56, 130048
    s_add_u32 s63, s63, s59
    buffer_load_dwordx4 v33, s[32:35], s63 offen lds
    v_mfma_f32_16x16x32_bf16 v[84:87], v[148:151], v[44:47], v[84:87]
    ds_read_b64_tr_b16 v[168:169], v36 offset:36864
    ds_read_b64_tr_b16 v[170:171], v36 offset:37376
    ds_read_b64_tr_b16 v[172:173], v37 offset:36864
    ds_read_b64_tr_b16 v[174:175], v37 offset:37376
    s_waitcnt lgkmcnt(8)
    v_mfma_f32_16x16x32_bf16 v[80:83], v[152:155], v[44:47], v[80:83]
    s_add_u32 m0, s56, 131072
    s_add_u32 s63, s63, s59
    buffer_load_dwordx4 v32, s[32:35], s63 offen lds
    v_mfma_f32_16x16x32_bf16 v[84:87], v[156:159], v[44:47], v[84:87]
    s_waitcnt lgkmcnt(4)
    v_mfma_f32_16x16x32_bf16 v[80:83], v[160:163], v[44:47], v[80:83]
    v_mfma_f32_16x16x32_bf16 v[84:87], v[164:167], v[44:47], v[84:87]
    s_waitcnt lgkmcnt(0)
    v_mfma_f32_16x16x32_bf16 v[80:83], v[168:171], v[44:47], v[80:83]
    v_mfma_f32_16x16x32_bf16 v[84:87], v[172:175], v[44:47], v[84:87]
    s_add_u32 m0, s56, 132096
    s_add_u32 s63, s63, s59
    buffer_load_dwordx4 v33, s[32:35], s63 offen lds
    s_waitcnt lgkmcnt(0)
    s_waitcnt vmcnt(11)
    s_barrier
    ds_read_b128 v[48:51], v8 offset:0
    ds_read_b128 v[52:55], v8 offset:20480
    ds_read_b128 v[56:59], v9 offset:0
    ds_read_b128 v[60:63], v9 offset:20480
    ds_read_b128 v[64:67], v8 offset:1024
    ds_read_b128 v[68:71], v8 offset:21504
    ds_read_b128 a[240:243], v9 offset:1024
    ds_read_b128 a[244:247], v9 offset:21504
    s_waitcnt lgkmcnt(4)
    v_mfma_f32_16x16x32_bf16 v[16:19], v[96:99], v[48:51], 0
    ds_read_b128 a[248:251], v8 offset:2048
    s_add_u32 m0, s56, 0
    s_mov_b32 s63, s62
    buffer_load_dwordx4 v34, s[36:39], s63 offen lds
    v_mfma_f32_16x16x32_bf16 v[20:23], v[100:103], v[48:51], 0
    v_mfma_f32_16x16x32_bf16 v[24:27], v[96:99], v[52:55], 0
    ds_read_b128 a[252:255], v8 offset:22528
    s_add_u32 m0, s56, 1024
    s_add_u32 s63, s63, s59
    buffer_load_dwordx4 v35, s[36:39], s63 offen lds
    v_mfma_f32_16x16x32_bf16 v[28:31], v[100:103], v[52:55], 0
    v_mfma_f32_16x16x32_bf16 v[16:19], v[104:107], v[56:59], v[16:19]
    ds_read_b128 v[48:51], v9 offset:2048
    s_add_u32 m0, s56, 2048
    s_add_u32 s63, s63, s59
    buffer_load_dwordx4 v34, s[36:39], s63 offen lds
    v_mfma_f32_16x16x32_bf16 v[20:23], v[108:111], v[56:59], v[20:23]
    v_mfma_f32_16x16x32_bf16 v[24:27], v[104:107], v[60:63], v[24:27]
    ds_read_b128 v[52:55], v9 offset:22528
    s_add_u32 m0, s56, 3072
    s_add_u32 s63, s63, s59
    buffer_load_dwordx4 v35, s[36:39], s63 offen lds
    v_mfma_f32_16x16x32_bf16 v[28:31], v[108:111], v[60:63], v[28:31]
    s_waitcnt lgkmcnt(4)
    v_mfma_f32_16x16x32_bf16 v[16:19], v[112:115], v[64:67], v[16:19]
    ds_read_b128 v[56:59], v8 offset:3072
    s_add_u32 m0, s56, 4096
    s_add_u32 s63, s63, s59
    buffer_load_dwordx4 v34, s[36:39], s63 offen lds
    v_mfma_f32_16x16x32_bf16 v[20:23], v[116:119], v[64:67], v[20:23]
    v_mfma_f32_16x16x32_bf16 v[24:27], v[112:115], v[68:71], v[24:27]
    ds_read_b128 v[60:63], v8 offset:23552
    s_add_u32 m0, s56, 5120
    s_add_u32 s63, s62, s60
    buffer_load_dwordx4 v35, s[36:39], s63 offen lds
    v_mfma_f32_16x16x32_bf16 v[28:31], v[116:119], v[68:71], v[28:31]
    v_mfma_f32_16x16x32_bf16 v[16:19], v[120:123], a[240:243], v[16:19]
    ds_read_b128 v[64:67], v9 offset:3072
    s_add_u32 m0, s56, 6144
    s_add_u32 s63, s63, s59
    buffer_load_dwordx4 v34, s[36:39], s63 offen lds
    s_waitcnt vmcnt(7)
    s_barrier
    v_mfma_f32_16x16x32_bf16 v[20:23], v[124:127], a[240:243], v[20:23]
    ds_read_b64_tr_b16 v[176:177], v38 offset:0
    v_mfma_f32_16x16x32_bf16 v[24:27], v[120:123], a[244:247], v[24:27]
    ds_read_b128 v[68:71], v9 offset:23552
    s_add_u32 m0, s56, 7168
    s_add_u32 s63, s63, s59
    buffer_load_dwordx4 v35, s[36:39], s63 offen lds
    ds_read_b64_tr_b16 v[178:179], v38 offset:512
    v_mfma_f32_16x16x32_bf16 v[28:31], v[124:127], a[244:247], v[28:31]
    s_waitcnt lgkmcnt(6)
    ds_read_b64_tr_b16 v[184:185], v38 offset:4096
    v_mfma_f32_16x16x32_bf16 v[16:19], v[128:131], a[248:251], v[16:19]
    ds_read_b128 a[240:243], v8 offset:4096
    s_add_u32 m0, s56, 8192
    s_add_u32 s63, s63, s59
    buffer_load_dwordx4 v34, s[36:39], s63 offen lds
    ds_read_b64_tr_b16 v[186:187], v38 offset:4608
    v_mfma_f32_16x16x32_bf16 v[20:23], v[132:135], a[248:251], v[20:23]
    v_mfma_f32_16x16x32_bf16 v[24:27], v[128:131], a[252:255], v[24:27]
    ds_read_b128 a[244:247], v8 offset:24576
    s_add_u32 m0, s56, 9216
    s_add_u32 s63, s63, s59
    buffer_load_dwordx4 v35, s[36:39], s63 offen lds
    ds_read_b64_tr_b16 v[192:193], v38 offset:8192
    v_mfma_f32_16x16x32_bf16 v[28:31], v[132:135], a[252:255], v[28:31]
    ds_read_b64_tr_b16 v[194:195], v38 offset:8704
    v_mfma_f32_16x16x32_bf16 v[16:19], v[136:139], v[48:51], v[16:19]
    ds_read_b128 a[248:251], v9 offset:4096
    s_mov_b64 s[32:33], s[88:89]
    s_mov_b32 s34, 2211840
    s_mov_b32 s35, 0x20000
    s_mov_b64 s[36:37], s[74:75]
    s_mov_b32 s38, 819200
    s_mov_b32 s39, 0x20000
    ds_read_b64_tr_b16 v[200:201], v38 offset:12288
    buffer_load_dwordx2 v[88:89], v90, s[28:31], 0 offen sc1
    buffer_load_dwordx2 v[92:93], v94, s[28:31], 0 offen sc1
    v_mfma_f32_16x16x32_bf16 v[20:23], v[140:143], v[48:51], v[20:23]
    s_add_u32 m0, s56, 40960
    s_nop 0
    buffer_load_dwordx4 v12, s[20:23], s53 offen offset:0 lds
    s_add_u32 m0, s56, 41856
    v_mfma_f32_16x16x32_bf16 v[24:27], v[136:139], v[52:55], v[24:27]
    ds_read_b128 a[252:255], v9 offset:24576
    ds_read_b64_tr_b16 v[202:203], v38 offset:12800
    v_mfma_f32_16x16x32_bf16 v[28:31], v[140:143], v[52:55], v[28:31]
    s_waitcnt lgkmcnt(11)
    buffer_load_dwordx4 v12, s[20:23], s53 offen offset:128 lds
    s_add_u32 m0, s56, 42752
    ds_read_b64_tr_b16 v[208:209], v38 offset:16384
    v_mfma_f32_16x16x32_bf16 v[16:19], v[144:147], v[56:59], v[16:19]
    ds_read_b128 v[48:51], v8 offset:5120
    ds_read_b64_tr_b16 v[210:211], v38 offset:16896
    v_mfma_f32_16x16x32_bf16 v[20:23], v[148:151], v[56:59], v[20:23]
    buffer_load_dwordx4 v12, s[20:23], s53 offen offset:256 lds
    s_add_u32 m0, s56, 43648
    v_mfma_f32_16x16x32_bf16 v[24:27], v[144:147], v[60:63], v[24:27]
    ds_read_b128 v[52:55], v8 offset:25600
    ds_read_b64_tr_b16 v[216:217], v38 offset:20480
    v_mfma_f32_16x16x32_bf16 v[28:31], v[148:151], v[60:63], v[28:31]
    buffer_load_dwordx4 v12, s[20:23], s53 offen offset:384 lds
    s_add_u32 m0, s56, 44544
    ds_read_b64_tr_b16 v[218:219], v38 offset:20992
    v_mfma_f32_16x16x32_bf16 v[16:19], v[152:155], v[64:67], v[16:19]
    ds_read_b128 v[56:59], v9 offset:5120
    ds_read_b64_tr_b16 v[224:225], v38 offset:24576
    v_mfma_f32_16x16x32_bf16 v[20:23], v[156:159], v[64:67], v[20:23]
    ds_read_b64_tr_b16 v[226:227], v38 offset:25088
    v_mfma_f32_16x16x32_bf16 v[24:27], v[152:155], v[68:71], v[24:27]
    ds_read_b128 v[60:63], v9 offset:25600
    v_mfma_f32_16x16x32_bf16 v[28:31], v[156:159], v[68:71], v[28:31]
    s_waitcnt lgkmcnt(11)
    ds_read_b64_tr_b16 v[232:233], v38 offset:28672
    v_mfma_f32_16x16x32_bf16 v[16:19], v[160:163], a[240:243], v[16:19]
    ds_read_b128 v[64:67], v8 offset:6144
    ds_read_b64_tr_b16 v[234:235], v38 offset:29184
    v_mfma_f32_16x16x32_bf16 v[20:23], v[164:167], a[240:243], v[20:23]
    ds_read_b64_tr_b16 v[240:241], v38 offset:32768
    v_mfma_f32_16x16x32_bf16 v[24:27], v[160:163], a[244:247], v[24:27]
    ds_read_b128 v[68:71], v8 offset:26624
    v_mfma_f32_16x16x32_bf16 v[28:31], v[164:167], a[244:247], v[28:31]
    ds_read_b64_tr_b16 v[242:243], v38 offset:33280
    v_mfma_f32_16x16x32_bf16 v[16:19], v[168:171], a[248:251], v[16:19]
    ds_read_b128 a[240:243], v9 offset:6144
    ds_read_b64_tr_b16 v[248:249], v38 offset:36864
    v_mfma_f32_16x16x32_bf16 v[20:23], v[172:175], a[248:251], v[20:23]
    ds_read_b64_tr_b16 v[250:251], v38 offset:37376
    v_mfma_f32_16x16x32_bf16 v[24:27], v[168:171], a[252:255], v[24:27]
    ds_read_b128 a[244:247], v9 offset:26624
    v_mfma_f32_16x16x32_bf16 v[28:31], v[172:175], a[252:255], v[28:31]
    s_waitcnt vmcnt(6) lgkmcnt(0)
    s_barrier
    ds_read_b64_tr_b16 v[180:181], v36 offset:0
    ds_read_b64_tr_b16 v[182:183], v36 offset:512
    ds_read_b64_tr_b16 v[188:189], v36 offset:4096
    ds_read_b64_tr_b16 v[190:191], v36 offset:4608
    v_mfma_f32_16x16x32_bf16 v[80:83], v[176:179], v[44:47], v[80:83]
    buffer_load_dwordx4 v12, s[20:23], s53 offen offset:512 lds
    s_add_u32 m0, s56, 45440
    ds_read_b64_tr_b16 v[196:197], v36 offset:8192
    ds_read_b64_tr_b16 v[198:199], v36 offset:8704
    v_mfma_f32_16x16x32_bf16 v[80:83], v[184:187], v[44:47], v[80:83]
    buffer_load_dwordx4 v12, s[20:23], s53 offen offset:640 lds
    s_add_u32 m0, s56, 46336
    ds_read_b64_tr_b16 v[204:205], v36 offset:12288
    ds_read_b64_tr_b16 v[206:207], v36 offset:12800
    v_mfma_f32_16x16x32_bf16 v[80:83], v[192:195], v[44:47], v[80:83]
    buffer_load_dwordx4 v12, s[20:23], s53 offen offset:768 lds
    s_add_u32 m0, s56, 47232
    ds_read_b64_tr_b16 v[212:213], v36 offset:16384
    ds_read_b64_tr_b16 v[214:215], v36 offset:16896
    v_mfma_f32_16x16x32_bf16 v[80:83], v[200:203], v[44:47], v[80:83]
    buffer_load_dwordx4 v12, s[20:23], s53 offen offset:896 lds
    s_add_u32 m0, s56, 48128
    ds_read_b64_tr_b16 v[220:221], v36 offset:20480
    ds_read_b64_tr_b16 v[222:223], v36 offset:20992
    v_mfma_f32_16x16x32_bf16 v[80:83], v[208:211], v[44:47], v[80:83]
    buffer_load_dwordx4 v12, s[20:23], s53 offen offset:1024 lds
    s_add_u32 m0, s56, 49024
    v_mfma_f32_16x16x32_bf16 v[80:83], v[216:219], v[44:47], v[80:83]
    buffer_load_dwordx4 v12, s[20:23], s53 offen offset:1152 lds
    s_add_u32 m0, s56, 0
    s_add_u32 s53, s53, 245760
    v_mfma_f32_16x16x32_bf16 v[80:83], v[224:227], v[44:47], v[80:83]
    v_mfma_f32_16x16x32_bf16 v[80:83], v[232:235], v[44:47], v[80:83]
    v_mfma_f32_16x16x32_bf16 v[80:83], v[240:243], v[44:47], v[80:83]
    v_mfma_f32_16x16x32_bf16 v[80:83], v[248:251], v[44:47], v[80:83]
    s_waitcnt lgkmcnt(8)
    v_mfma_f32_16x16x32_bf16 v[16:19], v[176:179], v[48:51], v[16:19]
    ds_read_b128 a[248:251], v8 offset:7168
    v_mfma_f32_16x16x32_bf16 v[20:23], v[180:183], v[48:51], v[20:23]
    ds_read_b64_tr_b16 v[228:229], v36 offset:24576
    ds_read_b64_tr_b16 v[230:231], v36 offset:25088
    s_mov_b32 m0, s86
    v_mfma_f32_16x16x32_bf16 v[24:27], v[176:179], v[52:55], v[24:27]
    ds_read_b128 a[252:255], v8 offset:27648
    v_mfma_f32_16x16x32_bf16 v[28:31], v[180:183], v[52:55], v[28:31]
    v_mfma_f32_16x16x32_bf16 v[84:87], v[180:183], v[44:47], v[84:87]
    buffer_load_dwordx4 v40, s[32:35], s85 offen lds
    s_add_u32 m0, s86, 1024
    v_mfma_f32_16x16x32_bf16 v[16:19], v[184:187], v[56:59], v[16:19]
    ds_read_b128 v[48:51], v9 offset:7168
    v_mfma_f32_16x16x32_bf16 v[20:23], v[188:191], v[56:59], v[20:23]
    ds_read_b64_tr_b16 v[236:237], v36 offset:28672
    ds_read_b64_tr_b16 v[238:239], v36 offset:29184
    buffer_load_dwordx4 v41, s[32:35], s85 offen lds
    s_add_u32 m0, s86, 2048
    v_mfma_f32_16x16x32_bf16 v[24:27], v[184:187], v[60:63], v[24:27]
    ds_read_b128 v[52:55], v9 offset:27648
    v_mfma_f32_16x16x32_bf16 v[28:31], v[188:191], v[60:63], v[28:31]
    s_waitcnt lgkmcnt(12)
    v_mfma_f32_16x16x32_bf16 v[84:87], v[188:191], v[44:47], v[84:87]
    buffer_load_dwordx4 v42, s[32:35], s85 offen lds
    s_add_u32 m0, s86, 3072
    v_mfma_f32_16x16x32_bf16 v[16:19], v[192:195], v[64:67], v[16:19]
    ds_read_b128 v[56:59], v8 offset:8192
    v_mfma_f32_16x16x32_bf16 v[20:23], v[196:199], v[64:67], v[20:23]
    ds_read_b64_tr_b16 v[244:245], v36 offset:32768
    ds_read_b64_tr_b16 v[246:247], v36 offset:33280
    buffer_load_dwordx4 v43, s[36:39], s87 offen lds
    s_add_u32 m0, s86, 4096
    s_add_u32 s87, s87, 10240
    v_mfma_f32_16x16x32_bf16 v[24:27], v[192:195], v[68:71], v[24:27]
    ds_read_b128 v[60:63], v8 offset:28672
    v_mfma_f32_16x16x32_bf16 v[28:31], v[196:199], v[68:71], v[28:31]
    v_mfma_f32_16x16x32_bf16 v[84:87], v[196:199], v[44:47], v[84:87]
    buffer_load_dwordx4 v43, s[36:39], s87 offen lds
    s_add_u32 m0, s56, 0
    v_mfma_f32_16x16x32_bf16 v[16:19], v[200:203], a[240:243], v[16:19]
    ds_read_b128 v[64:67], v9 offset:8192
    v_mfma_f32_16x16x32_bf16 v[20:23], v[204:207], a[240:243], v[20:23]
    ds_read_b64_tr_b16 v[252:253], v36 offset:36864
    ds_read_b64_tr_b16 v[254:255], v36 offset:37376
    v_mfma_f32_16x16x32_bf16 v[24:27], v[200:203], a[244:247], v[24:27]
    ds_read_b128 v[68:71], v9 offset:28672
    v_mfma_f32_16x16x32_bf16 v[28:31], v[204:207], a[244:247], v[28:31]
    s_waitcnt lgkmcnt(8)
    v_mfma_f32_16x16x32_bf16 v[84:87], v[204:207], v[44:47], v[84:87]
    v_mfma_f32_16x16x32_bf16 v[16:19], v[208:211], a[248:251], v[16:19]
    ds_read_b128 a[240:243], v8 offset:9216
    v_mfma_f32_16x16x32_bf16 v[20:23], v[212:215], a[248:251], v[20:23]
    v_mfma_f32_16x16x32_bf16 v[24:27], v[208:211], a[252:255], v[24:27]
    ds_read_b128 a[244:247], v8 offset:29696
    s_waitcnt vmcnt(15)
    v_xor_b32 v72, v89, v13
    v_xor_b32 v73, v93, v13
    v_or_b32 v72, v72, v73
    v_cmp_ne_u32 vcc, 0, v72
    s_cbranch_vccnz Lgrs_2
Lgrb_3:
    v_and_b32 v74, 0xffff0000, v88
    v_mfma_f32_16x16x32_bf16 v[28:31], v[212:215], a[252:255], v[28:31]
    v_mfma_f32_16x16x32_bf16 v[84:87], v[212:215], v[44:47], v[84:87]
    v_lshlrev_b32 v72, 16, v88
    v_rcp_f32 v73, v74
    v_mfma_f32_16x16x32_bf16 v[16:19], v[216:219], v[48:51], v[16:19]
    ds_read_b128 a[248:251], v9 offset:9216
    v_mul_f32 v74, v74, v74
    v_mul_f32 v73, 0xbfb8aa3b, v73
    v_mfma_f32_16x16x32_bf16 v[20:23], v[220:223], v[48:51], v[20:23]
    ds_write_b96 v91, v[72:74]
    v_and_b32 v78, 0xffff0000, v92
    v_mfma_f32_16x16x32_bf16 v[24:27], v[216:219], v[52:55], v[24:27]
    ds_read_b128 a[252:255], v9 offset:29696
    v_lshlrev_b32 v76, 16, v92
    v_rcp_f32 v77, v78
    v_mfma_f32_16x16x32_bf16 v[28:31], v[220:223], v[52:55], v[28:31]
    s_waitcnt lgkmcnt(5)
    v_mfma_f32_16x16x32_bf16 v[84:87], v[220:223], v[44:47], v[84:87]
    v_mul_f32 v78, v78, v78
    v_mul_f32 v77, 0xbfb8aa3b, v77
    v_mfma_f32_16x16x32_bf16 v[16:19], v[224:227], v[56:59], v[16:19]
    ds_write_b96 v95, v[76:78]
    v_mfma_f32_16x16x32_bf16 v[20:23], v[228:231], v[56:59], v[20:23]
    v_add_u32 v8, 0xffff6000, v8
    v_mfma_f32_16x16x32_bf16 v[24:27], v[224:227], v[60:63], v[24:27]
    v_add_u32 v9, 0xffff6000, v9
    v_mfma_f32_16x16x32_bf16 v[28:31], v[228:231], v[60:63], v[28:31]
    s_waitcnt vmcnt(5) lgkmcnt(0)
    s_barrier
    ds_read_b128 v[48:51], v8 offset:0
    ds_read_b128 v[52:55], v8 offset:20480
    v_mfma_f32_16x16x32_bf16 v[84:87], v[228:231], v[44:47], v[84:87]
    v_mfma_f32_16x16x32_bf16 v[16:19], v[232:235], v[64:67], v[16:19]
    ds_read_b128 v[56:59], v9 offset:0
    v_mfma_f32_16x16x32_bf16 v[20:23], v[236:239], v[64:67], v[20:23]
    buffer_load_dwordx4 v12, s[20:23], s53 offen offset:0 lds
    s_add_u32 m0, s56, 896
    v_mfma_f32_16x16x32_bf16 v[24:27], v[232:235], v[68:71], v[24:27]
    ds_read_b128 v[60:63], v9 offset:20480
    v_mfma_f32_16x16x32_bf16 v[28:31], v[236:239], v[68:71], v[28:31]
    ds_read_b96 v[88:90], v0 offset:0
    v_mfma_f32_16x16x32_bf16 v[84:87], v[236:239], v[44:47], v[84:87]
    v_mfma_f32_16x16x32_bf16 v[16:19], v[240:243], a[240:243], v[16:19]
    ds_read_b128 v[64:67], v8 offset:1024
    buffer_load_dwordx4 v12, s[20:23], s53 offen offset:128 lds
    s_add_u32 m0, s56, 1792
    v_mfma_f32_16x16x32_bf16 v[20:23], v[244:247], a[240:243], v[20:23]
    buffer_load_dwordx4 v12, s[20:23], s53 offen offset:256 lds
    s_add_u32 m0, s56, 2688
    v_mfma_f32_16x16x32_bf16 v[24:27], v[240:243], a[244:247], v[24:27]
    ds_read_b128 v[68:71], v8 offset:21504
    v_mfma_f32_16x16x32_bf16 v[28:31], v[244:247], a[244:247], v[28:31]
    v_mfma_f32_16x16x32_bf16 v[84:87], v[244:247], v[44:47], v[84:87]
    buffer_load_dwordx4 v12, s[20:23], s53 offen offset:384 lds
    s_add_u32 m0, s56, 3584
    v_mfma_f32_16x16x32_bf16 v[16:19], v[248:251], a[248:251], v[16:19]
    ds_read_b128 a[240:243], v9 offset:1024
    v_mfma_f32_16x16x32_bf16 v[20:23], v[252:255], a[248:251], v[20:23]
    buffer_load_dwordx4 v12, s[20:23], s53 offen offset:512 lds
    s_add_u32 m0, s56, 4480
    v_mfma_f32_16x16x32_bf16 v[24:27], v[248:251], a[252:255], v[24:27]
L_chain4:
L_hk1135:
    s_cbranch_execz L_hk3574
    ds_read_b128 a[244:247], v9 offset:21504
    v_mfma_f32_16x16x32_bf16 v[28:31], v[252:255], a[252:255], v[28:31]
    s_waitcnt lgkmcnt(5)
    v_mfma_f32_16x16x32_bf16 v[84:87], v[252:255], v[44:47], v[84:87]
    v_mfma_f32_16x16x32_bf16 v[32:35], v[96:99], v[48:51], 0
    ds_read_b128 a[248:251], v8 offset:2048
    v_mfma_f32_16x16x32_bf16 v[36:39], v[100:103], v[48:51], 0
    buffer_load_dwordx4 v12, s[20:23], s53 offen offset:640 lds
    v_mfma_f32_16x16x32_bf16 v[40:43], v[96:99], v[52:55], 0
    ds_read_b128 a[252:255], v8 offset:22528
    v_mfma_f32_16x16x32_bf16 v[44:47], v[100:103], v[52:55], 0
    s_add_u32 m0, s56, 5376
    v_mfma_f32_16x16x32_bf16 v[32:35], v[104:107], v[56:59], v[32:35]
    s_waitcnt lgkmcnt(6)
    ds_read_b128 v[48:51], v9 offset:2048
    ds_read_b96 v[92:94], v0 offset:256
    v_mfma_f32_16x16x32_bf16 v[36:39], v[108:111], v[56:59], v[36:39]
    buffer_load_dwordx4 v12, s[20:23], s53 offen offset:768 lds
    v_fmac_f32 v16, v88, v80
    v_mfma_f32_16x16x32_bf16 v[40:43], v[104:107], v[60:63], v[40:43]
    ds_read_b128 v[52:55], v9 offset:22528
    v_mul_f32 v76, v89, v16
    v_mfma_f32_16x16x32_bf16 v[44:47], v[108:111], v[60:63], v[44:47]
    s_add_u32 m0, s56, 6272
    s_waitcnt lgkmcnt(5)
    v_exp_f32 v76, v76
    v_mfma_f32_16x16x32_bf16 v[32:35], v[112:115], v[64:67], v[32:35]
    ds_read_b128 v[56:59], v8 offset:3072
    v_fmac_f32 v20, v88, v84
    v_mfma_f32_16x16x32_bf16 v[36:39], v[116:119], v[64:67], v[36:39]
    buffer_load_dwordx4 v12, s[20:23], s53 offen offset:896 lds
    v_mul_f32 v16, v16, v20
    v_mfma_f32_16x16x32_bf16 v[40:43], v[112:115], v[68:71], v[40:43]
    ds_read_b128 v[60:63], v8 offset:23552
    v_fma_f32 v76, v76, v90, v90
    v_mfma_f32_16x16x32_bf16 v[44:47], v[116:119], v[68:71], v[44:47]
    v_rcp_f32 v76, v76
    v_mfma_f32_16x16x32_bf16 v[32:35], v[120:123], a[240:243], v[32:35]
    s_add_u32 m0, s56, 7168
    ds_read_b128 v[64:67], v9 offset:3072
    v_fmac_f32 v17, v88, v81
    v_mfma_f32_16x16x32_bf16 v[36:39], v[124:127], a[240:243], v[36:39]
    buffer_load_dwordx4 v12, s[20:23], s53 offen offset:1024 lds
    v_mul_f32 v76, v16, v76
    v_mfma_f32_16x16x32_bf16 v[40:43], v[120:123], a[244:247], v[40:43]
    ds_read_b128 v[68:71], v9 offset:23552
    v_mul_f32 v77, v89, v17
    v_mfma_f32_16x16x32_bf16 v[44:47], v[124:127], a[244:247], v[44:47]
    s_waitcnt lgkmcnt(4)
    v_exp_f32 v77, v77
    v_mfma_f32_16x16x32_bf16 v[32:35], v[128:131], a[248:251], v[32:35]
    s_add_u32 m0, s56, 8064
    ds_read_b128 a[240:243], v8 offset:4096
    v_fmac_f32 v21, v88, v85
    v_mfma_f32_16x16x32_bf16 v[36:39], v[132:135], a[248:251], v[36:39]
    v_mul_f32 v17, v17, v21
    v_fma_f32 v77, v77, v90, v90
    v_mfma_f32_16x16x32_bf16 v[40:43], v[128:131], a[252:255], v[40:43]
    ds_read_b128 a[244:247], v8 offset:24576
    v_rcp_f32 v77, v77
    v_mfma_f32_16x16x32_bf16 v[44:47], v[132:135], a[252:255], v[44:47]
    buffer_load_dwordx4 v12, s[20:23], s53 offen offset:1152 lds
    v_mfma_f32_16x16x32_bf16 v[32:35], v[136:139], v[48:51], v[32:35]
    ds_read_b128 a[248:251], v9 offset:4096
    v_fmac_f32 v18, v88, v82
    v_mfma_f32_16x16x32_bf16 v[36:39], v[140:143], v[48:51], v[36:39]
    s_add_u32 m0, s56, 81920
    v_mul_f32 v77, v17, v77
    v_mul_f32 v78, v89, v18
    v_mfma_f32_16x16x32_bf16 v[40:43], v[136:139], v[52:55], v[40:43]
    ds_read_b128 a[252:255], v9 offset:24576
    v_exp_f32 v78, v78
    v_mfma_f32_16x16x32_bf16 v[44:47], v[140:143], v[52:55], v[44:47]
    s_add_u32 s53, s53, 245760
    s_waitcnt lgkmcnt(4)
    v_fmac_f32 v22, v88, v86
    v_mfma_f32_16x16x32_bf16 v[32:35], v[144:147], v[56:59], v[32:35]
    ds_read_b128 v[48:51], v8 offset:5120
    v_cvt_pk_bf16_f32 v72, v76, v77
    v_mfma_f32_16x16x32_bf16 v[36:39], v[148:151], v[56:59], v[36:39]
    buffer_load_dwordx4 v12, s[20:23], s53 offen offset:0 lds
    v_mul_f32 v18, v18, v22
    v_mfma_f32_16x16x32_bf16 v[40:43], v[144:147], v[60:63], v[40:43]
    ds_read_b128 v[52:55], v8 offset:25600
    v_fma_f32 v78, v78, v90, v90
    v_mfma_f32_16x16x32_bf16 v[44:47], v[148:151], v[60:63], v[44:47]
    s_add_u32 m0, s56, 82816
    v_rcp_f32 v78, v78
    v_mfma_f32_16x16x32_bf16 v[32:35], v[152:155], v[64:67], v[32:35]
    ds_read_b128 v[56:59], v9 offset:5120
    v_fmac_f32 v19, v88, v83
    v_mfma_f32_16x16x32_bf16 v[36:39], v[156:159], v[64:67], v[36:39]
    buffer_load_dwordx4 v12, s[20:23], s53 offen offset:128 lds
    v_mul_f32 v78, v18, v78
    v_mfma_f32_16x16x32_bf16 v[40:43], v[152:155], v[68:71], v[40:43]
    s_waitcnt vmcnt(12)
    ds_read_b128 v[60:63], v9 offset:25600
    v_mul_f32 v79, v89, v19
    v_mfma_f32_16x16x32_bf16 v[44:47], v[156:159], v[68:71], v[44:47]
    s_waitcnt lgkmcnt(4)
    v_exp_f32 v79, v79
    v_mfma_f32_16x16x32_bf16 v[32:35], v[160:163], a[240:243], v[32:35]
    s_add_u32 m0, s56, 83712
    ds_read_b128 v[64:67], v8 offset:6144
    ds_read_b64_tr_b16 a[200:201], v4 offset:0
    v_mfma_f32_16x16x32_bf16 v[36:39], v[164:167], a[240:243], v[36:39]
    buffer_load_dwordx4 v12, s[20:23], s53 offen offset:256 lds
    v_fmac_f32 v23, v88, v87
    v_mfma_f32_16x16x32_bf16 v[40:43], v[160:163], a[244:247], v[40:43]
    ds_read_b128 v[68:71], v8 offset:26624
    ds_read_b64_tr_b16 a[202:203], v4 offset:384
    v_mfma_f32_16x16x32_bf16 v[44:47], v[164:167], a[244:247], v[44:47]
    v_mul_f32 v19, v19, v23
    v_fma_f32 v79, v79, v90, v90
    v_mfma_f32_16x16x32_bf16 v[32:35], v[168:171], a[248:251], v[32:35]
    s_add_u32 m0, s56, 84608
    ds_read_b128 a[240:243], v9 offset:6144
    ds_read_b64_tr_b16 a[204:205], v4 offset:32
    v_mfma_f32_16x16x32_bf16 v[36:39], v[172:175], a[248:251], v[36:39]
    v_rcp_f32 v79, v79
    v_mfma_f32_16x16x32_bf16 v[40:43], v[168:171], a[252:255], v[40:43]
    ds_read_b128 a[244:247], v9 offset:26624
    ds_read_b64_tr_b16 a[206:207], v4 offset:416
    v_mfma_f32_16x16x32_bf16 v[44:47], v[172:175], a[252:255], v[44:47]
    s_waitcnt lgkmcnt(8)
    buffer_load_dwordx4 v12, s[20:23], s53 offen offset:384 lds
    v_fmac_f32 v24, v92, v80
    v_mfma_f32_16x16x32_bf16 v[32:35], v[176:179], v[48:51], v[32:35]
    ds_read_b128 a[248:251], v8 offset:7168
    ds_read_b64_tr_b16 a[208:209], v4 offset:64
    v_mfma_f32_16x16x32_bf16 v[36:39], v[180:183], v[48:51], v[36:39]
    s_add_u32 m0, s56, 85504
    v_mul_f32 v79, v19, v79
    v_mul_f32 v76, v93, v24
    v_mfma_f32_16x16x32_bf16 v[40:43], v[176:179], v[52:55], v[40:43]
    ds_read_b128 a[252:255], v8 offset:27648
    ds_read_b64_tr_b16 a[210:211], v4 offset:448
    v_mfma_f32_16x16x32_bf16 v[44:47], v[180:183], v[52:55], v[44:47]
    buffer_load_dwordx4 v12, s[20:23], s53 offen offset:512 lds
    v_exp_f32 v76, v76
    v_mfma_f32_16x16x32_bf16 v[32:35], v[184:187], v[56:59], v[32:35]
    ds_read_b128 v[48:51], v9 offset:7168
    ds_read_b128 a[212:215], v5 offset:3072
    v_mfma_f32_16x16x32_bf16 v[36:39], v[188:191], v[56:59], v[36:39]
    s_add_u32 m0, s56, 86400
    v_fmac_f32 v28, v92, v84
    v_cvt_pk_bf16_f32 v73, v78, v79
    v_mfma_f32_16x16x32_bf16 v[40:43], v[184:187], v[60:63], v[40:43]
    ds_read_b128 v[52:55], v9 offset:27648
    ds_read_b128 a[216:219], v5 offset:3136
    v_mfma_f32_16x16x32_bf16 v[44:47], v[188:191], v[60:63], v[44:47]
    s_waitcnt lgkmcnt(9)
    buffer_load_dwordx4 v12, s[20:23], s53 offen offset:640 lds
    v_mul_f32 v24, v24, v28
    v_mfma_f32_16x16x32_bf16 v[32:35], v[192:195], v[64:67], v[32:35]
    ds_read_b128 v[56:59], v8 offset:8192
    v_fma_f32 v76, v76, v94, v94
    v_mfma_f32_16x16x32_bf16 v[36:39], v[196:199], v[64:67], v[36:39]
    s_add_u32 m0, s56, 87296
    v_rcp_f32 v76, v76
    v_mfma_f32_16x16x32_bf16 v[40:43], v[192:195], v[68:71], v[40:43]
    ds_read_b128 v[60:63], v8 offset:28672
    v_fmac_f32 v25, v92, v81
    v_mfma_f32_16x16x32_bf16 v[44:47], v[196:199], v[68:71], v[44:47]
    s_waitcnt lgkmcnt(2)
    buffer_load_dwordx4 v12, s[20:23], s53 offen offset:768 lds
    v_mul_f32 v76, v24, v76
    v_mfma_f32_16x16x32_bf16 v[32:35], v[200:203], a[240:243], v[32:35]
    ds_read_b128 v[64:67], v9 offset:8192
    v_mul_f32 v77, v93, v25
    v_mfma_f32_16x16x32_bf16 v[36:39], v[204:207], a[240:243], v[36:39]
    v_exp_f32 v77, v77
    v_mfma_f32_16x16x32_bf16 v[40:43], v[200:203], a[244:247], v[40:43]
    s_add_u32 m0, s56, 88192
    ds_read_b128 v[68:71], v9 offset:28672
    v_fmac_f32 v29, v92, v85
    v_mfma_f32_16x16x32_bf16 v[44:47], v[204:207], a[244:247], v[44:47]
    buffer_store_dwordx4 a[200:203], v2, s[40:43], s57 offen offset:0 sc1
    v_mfma_f32_16x16x32_bf16 v[32:35], v[208:211], a[248:251], v[32:35]
    ds_read_b128 a[240:243], v8 offset:9216
    v_mul_f32 v25, v25, v29
    v_mfma_f32_16x16x32_bf16 v[36:39], v[212:215], a[248:251], v[36:39]
    buffer_load_dwordx4 v12, s[20:23], s53 offen offset:896 lds
    v_fma_f32 v77, v77, v94, v94
    v_mfma_f32_16x16x32_bf16 v[40:43], v[208:211], a[252:255], v[40:43]
    s_add_u32 m0, s56, 89088
    ds_read_b128 a[244:247], v8 offset:29696
    v_rcp_f32 v77, v77
    v_mfma_f32_16x16x32_bf16 v[44:47], v[212:215], a[252:255], v[44:47]
    buffer_store_dwordx4 a[204:207], v2, s[40:43], s57 offen offset:1024 sc1
    v_mfma_f32_16x16x32_bf16 v[32:35], v[216:219], v[48:51], v[32:35]
    ds_read_b128 a[248:251], v9 offset:9216
    v_fmac_f32 v26, v92, v82
    v_mul_f32 v77, v25, v77
    v_mfma_f32_16x16x32_bf16 v[36:39], v[220:223], v[48:51], v[36:39]
    s_bitcmp1_b32 s15, 0
    s_cselect_b32 s57, 2146435072, s57
    buffer_load_dwordx4 v12, s[20:23], s53 offen offset:1024 lds
    v_mfma_f32_16x16x32_bf16 v[40:43], v[216:219], v[52:55], v[40:43]
    s_waitcnt lgkmcnt(3)
    ds_read_b128 a[252:255], v9 offset:29696
    v_add_u32 v8, 0xffff6000, v8
    v_mul_f32 v78, v93, v26
    v_mfma_f32_16x16x32_bf16 v[44:47], v[220:223], v[52:55], v[44:47]
    s_add_u32 m0, s56, 89984
    v_add_u32 v9, 0xffff6000, v9
    v_exp_f32 v78, v78
    v_mfma_f32_16x16x32_bf16 v[32:35], v[224:227], v[56:59], v[32:35]
    buffer_load_dwordx4 v12, s[20:23], s53 offen offset:1152 lds
    v_fmac_f32 v30, v92, v86
    v_mfma_f32_16x16x32_bf16 v[36:39], v[228:231], v[56:59], v[36:39]
    s_waitcnt vmcnt(12) lgkmcnt(0)
    s_barrier
    v_cvt_pk_bf16_f32 v74, v76, v77
    v_mfma_f32_16x16x32_bf16 v[40:43], v[224:227], v[60:63], v[40:43]
    ds_read_b128 v[48:51], v8 offset:0
    ds_read_b128 v[52:55], v8 offset:20480
    v_mul_f32 v26, v26, v30
    v_mfma_f32_16x16x32_bf16 v[44:47], v[228:231], v[60:63], v[44:47]
    s_add_u32 m0, s56, 40960
    buffer_store_dwordx4 a[208:211], v2, s[40:43], s57 offen offset:2048 sc1
    v_mfma_f32_16x16x32_bf16 v[32:35], v[232:235], v[64:67], v[32:35]
    ds_read_b128 v[56:59], v9 offset:0
    v_fma_f32 v78, v78, v94, v94
    v_mfma_f32_16x16x32_bf16 v[36:39], v[236:239], v[64:67], v[36:39]
    s_add_u32 s53, s53, 245760
    buffer_store_dwordx4 a[212:215], v2, s[40:43], s58 offen sc1
    s_add_u32 s58, s58, 5120
    v_mfma_f32_16x16x32_bf16 v[40:43], v[232:235], v[68:71], v[40:43]
    ds_read_b128 v[60:63], v9 offset:20480
    v_rcp_f32 v78, v78
    v_mfma_f32_16x16x32_bf16 v[44:47], v[236:239], v[68:71], v[44:47]
    v_fmac_f32 v27, v92, v83
    v_mul_f32 v78, v26, v78
    v_mfma_f32_16x16x32_bf16 v[32:35], v[240:243], a[240:243], v[32:35]
    ds_read_b128 v[64:67], v8 offset:1024
    ds_read_b96 v[88:90], v0 offset:512
    v_mfma_f32_16x16x32_bf16 v[36:39], v[244:247], a[240:243], v[36:39]
    buffer_store_dwordx4 a[216:219], v2, s[40:43], s58 offen sc1
    v_mfma_f32_16x16x32_bf16 v[40:43], v[240:243], a[244:247], v[40:43]
    ds_read_b128 v[68:71], v8 offset:21504
    v_mul_f32 v79, v93, v27
    v_mfma_f32_16x16x32_bf16 v[44:47], v[244:247], a[244:247], v[44:47]
    v_exp_f32 v79, v79
    v_mfma_f32_16x16x32_bf16 v[32:35], v[248:251], a[248:251], v[32:35]
    ds_read_b128 a[240:243], v9 offset:1024
    v_fmac_f32 v31, v92, v87
    v_mfma_f32_16x16x32_bf16 v[36:39], v[252:255], a[248:251], v[36:39]
    v_mul_f32 v27, v27, v31
    v_fma_f32 v79, v79, v94, v94
    v_mfma_f32_16x16x32_bf16 v[40:43], v[248:251], a[252:255], v[40:43]
    ds_read_b128 a[244:247], v9 offset:21504
    v_rcp_f32 v79, v79
    v_mfma_f32_16x16x32_bf16 v[44:47], v[252:255], a[252:255], v[44:47]
    s_waitcnt lgkmcnt(5)
    v_permlane16_swap_b32 v72, v74
    v_mul_f32 v79, v27, v79
    v_mfma_f32_16x16x32_bf16 v[16:19], v[96:99], v[48:51], 0
    ds_read_b128 a[248:251], v8 offset:2048
    v_mfma_f32_16x16x32_bf16 v[20:23], v[100:103], v[48:51], 0
    v_cvt_pk_bf16_f32 v75, v78, v79
    v_mfma_f32_16x16x32_bf16 v[24:27], v[96:99], v[52:55], 0
    ds_read_b128 a[252:255], v8 offset:22528
    ds_read_b96 v[92:94], v0 offset:768
    v_mfma_f32_16x16x32_bf16 v[28:31], v[100:103], v[52:55], 0
    buffer_load_dwordx4 v12, s[20:23], s53 offen offset:0 lds
    v_mfma_f32_16x16x32_bf16 v[16:19], v[104:107], v[56:59], v[16:19]
    s_waitcnt lgkmcnt(6)
    ds_read_b128 v[48:51], v9 offset:2048
    v_permlane16_swap_b32 v73, v75
    v_mfma_f32_16x16x32_bf16 v[20:23], v[108:111], v[56:59], v[20:23]
    s_add_u32 m0, s56, 41856
    buffer_store_dwordx4 v[72:75], v10, s[24:27], s54 offen sc1
    v_mfma_f32_16x16x32_bf16 v[24:27], v[104:107], v[60:63], v[24:27]
    ds_read_b128 v[52:55], v9 offset:22528
    v_fmac_f32 v32, v88, v80
    v_mul_f32 v76, v89, v32
    v_mfma_f32_16x16x32_bf16 v[28:31], v[108:111], v[60:63], v[28:31]
    s_waitcnt lgkmcnt(5)
    v_exp_f32 v76, v76
    v_mfma_f32_16x16x32_bf16 v[16:19], v[112:115], v[64:67], v[16:19]
    s_add_u32 s54, s54, 1155072
    ds_read_b128 v[56:59], v8 offset:3072
    v_fmac_f32 v36, v88, v84
    v_mfma_f32_16x16x32_bf16 v[20:23], v[116:119], v[64:67], v[20:23]
    buffer_load_dwordx4 v12, s[20:23], s53 offen offset:128 lds
    v_mul_f32 v32, v32, v36
    v_mfma_f32_16x16x32_bf16 v[24:27], v[112:115], v[68:71], v[24:27]
    ds_read_b128 v[60:63], v8 offset:23552
    v_fma_f32 v76, v76, v90, v90
    v_mfma_f32_16x16x32_bf16 v[28:31], v[116:119], v[68:71], v[28:31]
    v_rcp_f32 v76, v76
    v_mfma_f32_16x16x32_bf16 v[16:19], v[120:123], a[240:243], v[16:19]
    s_add_u32 m0, s56, 42752
    ds_read_b128 v[64:67], v9 offset:3072
    v_mfma_f32_16x16x32_bf16 v[20:23], v[124:127], a[240:243], v[20:23]
    v_fmac_f32 v33, v88, v81
    v_mul_f32 v76, v32, v76
    v_mfma_f32_16x16x32_bf16 v[24:27], v[120:123], a[244:247], v[24:27]
    ds_read_b128 v[68:71], v9 offset:23552
    v_mul_f32 v77, v89, v33
    v_mfma_f32_16x16x32_bf16 v[28:31], v[124:127], a[244:247], v[28:31]
    s_waitcnt lgkmcnt(4)
    buffer_load_dwordx4 v12, s[20:23], s53 offen offset:256 lds
    v_mfma_f32_16x16x32_bf16 v[16:19], v[128:131], a[248:251], v[16:19]
    ds_read_b128 a[240:243], v8 offset:4096
    v_exp_f32 v77, v77
    v_mfma_f32_16x16x32_bf16 v[20:23], v[132:135], a[248:251], v[20:23]
    v_fmac_f32 v37, v88, v85
    v_mul_f32 v33, v33, v37
    v_mfma_f32_16x16x32_bf16 v[24:27], v[128:131], a[252:255], v[24:27]
    s_add_u32 m0, s56, 43648
    ds_read_b128 a[244:247], v8 offset:24576
    v_fma_f32 v77, v77, v90, v90
    v_mfma_f32_16x16x32_bf16 v[28:31], v[132:135], a[252:255], v[28:31]
    v_rcp_f32 v77, v77
    v_mfma_f32_16x16x32_bf16 v[16:19], v[136:139], v[48:51], v[16:19]
    ds_read_b128 a[248:251], v9 offset:4096
    v_fmac_f32 v34, v88, v82
    v_mfma_f32_16x16x32_bf16 v[20:23], v[140:143], v[48:51], v[20:23]
    buffer_load_dwordx4 v12, s[20:23], s53 offen offset:384 lds
    v_mul_f32 v77, v33, v77
    v_mfma_f32_16x16x32_bf16 v[24:27], v[136:139], v[52:55], v[24:27]
    ds_read_b128 a[252:255], v9 offset:24576
    v_mul_f32 v78, v89, v34
    v_mfma_f32_16x16x32_bf16 v[28:31], v[140:143], v[52:55], v[28:31]
    s_waitcnt lgkmcnt(4)
    v_exp_f32 v78, v78
    v_mfma_f32_16x16x32_bf16 v[16:19], v[144:147], v[56:59], v[16:19]
    ds_read_b128 v[48:51], v8 offset:5120
    v_fmac_f32 v38, v88, v86
    v_mfma_f32_16x16x32_bf16 v[20:23], v[148:151], v[56:59], v[20:23]
    s_add_u32 m0, s56, 44544
    v_cvt_pk_bf16_f32 v72, v76, v77
    v_mul_f32 v34, v34, v38
    v_mfma_f32_16x16x32_bf16 v[24:27], v[144:147], v[60:63], v[24:27]
    ds_read_b128 v[52:55], v8 offset:25600
    v_fma_f32 v78, v78, v90, v90
    v_mfma_f32_16x16x32_bf16 v[28:31], v[148:151], v[60:63], v[28:31]
    v_rcp_f32 v78, v78
    v_mfma_f32_16x16x32_bf16 v[16:19], v[152:155], v[64:67], v[16:19]
    ds_read_b128 v[56:59], v9 offset:5120
    v_mfma_f32_16x16x32_bf16 v[20:23], v[156:159], v[64:67], v[20:23]
    buffer_load_dwordx4 v12, s[20:23], s53 offen offset:512 lds
    v_mfma_f32_16x16x32_bf16 v[24:27], v[152:155], v[68:71], v[24:27]
    ds_read_b128 v[60:63], v9 offset:25600
    v_fmac_f32 v35, v88, v83
    v_mfma_f32_16x16x32_bf16 v[28:31], v[156:159], v[68:71], v[28:31]
    s_add_u32 m0, s56, 45440
    s_waitcnt lgkmcnt(4)
    v_mul_f32 v78, v34, v78
    v_mfma_f32_16x16x32_bf16 v[16:19], v[160:163], a[240:243], v[16:19]
    ds_read_b128 v[64:67], v8 offset:6144
    v_mul_f32 v79, v89, v35
    v_mfma_f32_16x16x32_bf16 v[20:23], v[164:167], a[240:243], v[20:23]
    v_exp_f32 v79, v79
    v_mfma_f32_16x16x32_bf16 v[24:27], v[160:163], a[244:247], v[24:27]
    ds_read_b128 v[68:71], v8 offset:26624
    v_fmac_f32 v39, v88, v87
    v_mfma_f32_16x16x32_bf16 v[28:31], v[164:167], a[244:247], v[28:31]
    buffer_load_dwordx4 v12, s[20:23], s53 offen offset:640 lds
    v_mfma_f32_16x16x32_bf16 v[16:19], v[168:171], a[248:251], v[16:19]
    ds_read_b128 a[240:243], v9 offset:6144
    v_mul_f32 v35, v35, v39
    v_mfma_f32_16x16x32_bf16 v[20:23], v[172:175], a[248:251], v[20:23]
    s_waitcnt vmcnt(7)
    buffer_store_dword v13, v3, s[28:31], s51 offen sc1
    v_mfma_f32_16x16x32_bf16 v[24:27], v[168:171], a[252:255], v[24:27]
    s_add_u32 m0, s56, 46336
    ds_read_b128 a[244:247], v9 offset:26624
    v_fma_f32 v79, v79, v90, v90
    v_mfma_f32_16x16x32_bf16 v[28:31], v[172:175], a[252:255], v[28:31]
    s_waitcnt lgkmcnt(4)
    v_rcp_f32 v79, v79
    v_mfma_f32_16x16x32_bf16 v[16:19], v[176:179], v[48:51], v[16:19]
    ds_read_b128 a[248:251], v8 offset:7168
    v_fmac_f32 v40, v92, v80
    v_mfma_f32_16x16x32_bf16 v[20:23], v[180:183], v[48:51], v[20:23]
    buffer_load_dwordx4 v12, s[20:23], s53 offen offset:768 lds
    v_mul_f32 v79, v35, v79
    v_mfma_f32_16x16x32_bf16 v[24:27], v[176:179], v[52:55], v[24:27]
    ds_read_b128 a[252:255], v8 offset:27648
    v_mul_f32 v76, v93, v40
    v_mfma_f32_16x16x32_bf16 v[28:31], v[180:183], v[52:55], v[28:31]
    v_exp_f32 v76, v76
    v_mfma_f32_16x16x32_bf16 v[16:19], v[184:187], v[56:59], v[16:19]
    s_add_u32 m0, s56, 47232
    ds_read_b128 v[48:51], v9 offset:7168
    v_fmac_f32 v44, v92, v84
    v_mfma_f32_16x16x32_bf16 v[20:23], v[188:191], v[56:59], v[20:23]
    v_cvt_pk_bf16_f32 v73, v78, v79
    v_mfma_f32_16x16x32_bf16 v[24:27], v[184:187], v[60:63], v[24:27]
    ds_read_b128 v[52:55], v9 offset:27648
    v_mul_f32 v40, v40, v44
    v_mfma_f32_16x16x32_bf16 v[28:31], v[188:191], v[60:63], v[28:31]
    s_waitcnt lgkmcnt(4)
    buffer_load_dwordx4 v12, s[20:23], s53 offen offset:896 lds
    v_mfma_f32_16x16x32_bf16 v[16:19], v[192:195], v[64:67], v[16:19]
    ds_read_b128 v[56:59], v8 offset:8192
    v_fma_f32 v76, v76, v94, v94
    v_mfma_f32_16x16x32_bf16 v[20:23], v[196:199], v[64:67], v[20:23]
    v_rcp_f32 v76, v76
    v_mfma_f32_16x16x32_bf16 v[24:27], v[192:195], v[68:71], v[24:27]
    ds_read_b128 v[60:63], v8 offset:28672
    v_mfma_f32_16x16x32_bf16 v[28:31], v[196:199], v[68:71], v[28:31]
    s_add_u32 m0, s56, 48128
    v_fmac_f32 v41, v92, v81
    v_mul_f32 v76, v40, v76
    v_mfma_f32_16x16x32_bf16 v[16:19], v[200:203], a[240:243], v[16:19]
    ds_read_b128 v[64:67], v9 offset:8192
    v_mul_f32 v77, v93, v41
    v_mfma_f32_16x16x32_bf16 v[20:23], v[204:207], a[240:243], v[20:23]
    v_exp_f32 v77, v77
    v_mfma_f32_16x16x32_bf16 v[24:27], v[200:203], a[244:247], v[24:27]
    ds_read_b128 v[68:71], v9 offset:28672
    v_fmac_f32 v45, v92, v85
    v_mfma_f32_16x16x32_bf16 v[28:31], v[204:207], a[244:247], v[28:31]
    s_waitcnt lgkmcnt(4)
    buffer_load_dwordx4 v12, s[20:23], s53 offen offset:1024 lds
    v_mul_f32 v41, v41, v45
    v_mfma_f32_16x16x32_bf16 v[16:19], v[208:211], a[248:251], v[16:19]
    ds_read_b128 a[240:243], v8 offset:9216
    v_fma_f32 v77, v77, v94, v94
    v_mfma_f32_16x16x32_bf16 v[20:23], v[212:215], a[248:251], v[20:23]
    s_add_u32 m0, s56, 49024
    v_rcp_f32 v77, v77
    v_mfma_f32_16x16x32_bf16 v[24:27], v[208:211], a[252:255], v[24:27]
    ds_read_b128 a[244:247], v8 offset:29696
    v_fmac_f32 v42, v92, v82
    v_mfma_f32_16x16x32_bf16 v[28:31], v[212:215], a[252:255], v[28:31]
    v_mul_f32 v77, v41, v77
    v_mul_f32 v78, v93, v42
    v_mfma_f32_16x16x32_bf16 v[16:19], v[216:219], v[48:51], v[16:19]
    ds_read_b128 a[248:251], v9 offset:9216
    v_exp_f32 v78, v78
    v_mfma_f32_16x16x32_bf16 v[20:23], v[220:223], v[48:51], v[20:23]
    buffer_load_dwordx4 v12, s[20:23], s53 offen offset:1152 lds
    v_mfma_f32_16x16x32_bf16 v[24:27], v[216:219], v[52:55], v[24:27]
    ds_read_b128 a[252:255], v9 offset:29696
    v_add_u32 v8, 0x14000, v8
    v_mfma_f32_16x16x32_bf16 v[28:31], v[220:223], v[52:55], v[28:31]
    s_waitcnt lgkmcnt(4)
    v_add_u32 v9, 0x14000, v9
    v_fmac_f32 v46, v92, v86
    v_mfma_f32_16x16x32_bf16 v[16:19], v[224:227], v[56:59], v[16:19]
    s_add_u32 m0, s56, 0
    v_cvt_pk_bf16_f32 v74, v76, v77
    v_mul_f32 v42, v42, v46
    v_mfma_f32_16x16x32_bf16 v[20:23], v[228:231], v[56:59], v[20:23]
    s_waitcnt vmcnt(10) lgkmcnt(0)
    s_barrier
    v_fma_f32 v78, v78, v94, v94
    v_mfma_f32_16x16x32_bf16 v[24:27], v[224:227], v[60:63], v[24:27]
    ds_read_b128 v[48:51], v8 offset:0
    ds_read_b128 v[52:55], v8 offset:20480
    v_mfma_f32_16x16x32_bf16 v[28:31], v[228:231], v[60:63], v[28:31]
    s_add_u32 s53, s53, 243072
    v_rcp_f32 v78, v78
    v_mfma_f32_16x16x32_bf16 v[16:19], v[232:235], v[64:67], v[16:19]
    ds_read_b128 v[56:59], v9 offset:0
    v_fmac_f32 v43, v92, v83
    v_mfma_f32_16x16x32_bf16 v[20:23], v[236:239], v[64:67], v[20:23]
    buffer_store_dword v13, v11, s[28:31], s55 offen sc1
    v_mfma_f32_16x16x32_bf16 v[24:27], v[232:235], v[68:71], v[24:27]
    ds_read_b128 v[60:63], v9 offset:20480
    v_add_u32 v3, 2688, v12
    v_mfma_f32_16x16x32_bf16 v[28:31], v[236:239], v[68:71], v[28:31]
    v_mul_f32 v78, v42, v78
    v_mul_f32 v79, v93, v43
    v_mfma_f32_16x16x32_bf16 v[16:19], v[240:243], a[240:243], v[16:19]
    s_add_u32 s55, s55, 49152
    ds_read_b128 v[64:67], v8 offset:1024
    v_mfma_f32_16x16x32_bf16 v[20:23], v[244:247], a[240:243], v[20:23]
    v_exp_f32 v79, v79
    v_mfma_f32_16x16x32_bf16 v[24:27], v[240:243], a[244:247], v[24:27]
    ds_read_b128 v[68:71], v8 offset:21504
    v_add_u32 v4, 1792, v12
    v_mfma_f32_16x16x32_bf16 v[28:31], v[244:247], a[244:247], v[28:31]
    v_fmac_f32 v47, v92, v87
    v_mul_f32 v43, v43, v47
    v_mfma_f32_16x16x32_bf16 v[16:19], v[248:251], a[248:251], v[16:19]
    ds_read_b128 a[240:243], v9 offset:1024
    ds_read_b96 v[88:90], v0 offset:1024
    v_mfma_f32_16x16x32_bf16 v[20:23], v[252:255], a[248:251], v[20:23]
    v_add_u32 v5, 896, v12
    v_fma_f32 v79, v79, v94, v94
    v_mfma_f32_16x16x32_bf16 v[24:27], v[248:251], a[252:255], v[24:27]
    ds_read_b128 a[244:247], v9 offset:21504
    v_rcp_f32 v79, v79
    v_mfma_f32_16x16x32_bf16 v[28:31], v[252:255], a[252:255], v[28:31]
    s_waitcnt lgkmcnt(5)
    v_permlane16_swap_b32 v72, v74
    v_mul_f32 v79, v43, v79
    v_mfma_f32_16x16x32_bf16 v[32:35], v[96:99], v[48:51], 0
    ds_read_b128 a[248:251], v8 offset:2048
    v_mfma_f32_16x16x32_bf16 v[36:39], v[100:103], v[48:51], 0
    v_cvt_pk_bf16_f32 v75, v78, v79
    v_mfma_f32_16x16x32_bf16 v[40:43], v[96:99], v[52:55], 0
    ds_read_b128 a[252:255], v8 offset:22528
    ds_read_b96 v[92:94], v0 offset:1280
    v_mfma_f32_16x16x32_bf16 v[44:47], v[100:103], v[52:55], 0
    buffer_load_dwordx4 v3, s[20:23], s53 offen offset:0 lds
    v_mfma_f32_16x16x32_bf16 v[32:35], v[104:107], v[56:59], v[32:35]
    s_waitcnt lgkmcnt(4)
    ds_read_b128 v[48:51], v9 offset:2048
    v_permlane16_swap_b32 v73, v75
    v_mfma_f32_16x16x32_bf16 v[36:39], v[108:111], v[56:59], v[36:39]
    buffer_store_dwordx4 v[72:75], v10, s[24:27], s54 offen sc1
    v_mfma_f32_16x16x32_bf16 v[40:43], v[104:107], v[60:63], v[40:43]
    ds_read_b128 v[52:55], v9 offset:22528
    v_fmac_f32 v16, v88, v80
    v_mfma_f32_16x16x32_bf16 v[44:47], v[108:111], v[60:63], v[44:47]
    s_waitcnt lgkmcnt(5)
    buffer_load_dwordx4 v4, s[20:23], s53 offen offset:1024 lds
    v_mfma_f32_16x16x32_bf16 v[32:35], v[112:115], v[64:67], v[32:35]
    s_add_u32 s54, s54, 1155072
    ds_read_b128 v[56:59], v8 offset:3072
    v_mul_f32 v76, v89, v16
    v_mfma_f32_16x16x32_bf16 v[36:39], v[116:119], v[64:67], v[36:39]
    v_exp_f32 v76, v76
    v_mfma_f32_16x16x32_bf16 v[40:43], v[112:115], v[68:71], v[40:43]
    ds_read_b128 v[60:63], v8 offset:23552
    v_fmac_f32 v20, v88, v84
    v_mfma_f32_16x16x32_bf16 v[44:47], v[116:119], v[68:71], v[44:47]
    v_mul_f32 v16, v16, v20
    v_fma_f32 v76, v76, v90, v90
    v_mfma_f32_16x16x32_bf16 v[32:35], v[120:123], a[240:243], v[32:35]
    ds_read_b128 v[64:67], v9 offset:3072
    v_mfma_f32_16x16x32_bf16 v[36:39], v[124:127], a[240:243], v[36:39]
    buffer_load_dwordx4 v5, s[20:23], s53 offen offset:2048 lds
    v_mfma_f32_16x16x32_bf16 v[40:43], v[120:123], a[244:247], v[40:43]
    ds_read_b128 v[68:71], v9 offset:23552
    v_mfma_f32_16x16x32_bf16 v[44:47], v[124:127], a[244:247], v[44:47]
    s_waitcnt lgkmcnt(4)
    v_rcp_f32 v76, v76
    v_mfma_f32_16x16x32_bf16 v[32:35], v[128:131], a[248:251], v[32:35]
    ds_read_b128 a[240:243], v8 offset:4096
    v_fmac_f32 v17, v88, v81
    v_mfma_f32_16x16x32_bf16 v[36:39], v[132:135], a[248:251], v[36:39]
    buffer_load_dwordx4 v12, s[20:23], s53 offen offset:3072 lds
    v_mul_f32 v76, v16, v76
    v_mfma_f32_16x16x32_bf16 v[40:43], v[128:131], a[252:255], v[40:43]
    ds_read_b128 a[244:247], v8 offset:24576
    v_mul_f32 v77, v89, v17
    v_mfma_f32_16x16x32_bf16 v[44:47], v[132:135], a[252:255], v[44:47]
    v_exp_f32 v77, v77
    v_mfma_f32_16x16x32_bf16 v[32:35], v[136:139], v[48:51], v[32:35]
    ds_read_b128 a[248:251], v9 offset:4096
    v_fmac_f32 v21, v88, v85
    v_mfma_f32_16x16x32_bf16 v[36:39], v[140:143], v[48:51], v[36:39]
    v_mul_f32 v17, v17, v21
    v_fma_f32 v77, v77, v90, v90
    v_mfma_f32_16x16x32_bf16 v[40:43], v[136:139], v[52:55], v[40:43]
    s_add_u32 m0, s56, 4096
    ds_read_b128 a[252:255], v9 offset:24576
    v_mfma_f32_16x16x32_bf16 v[44:47], v[140:143], v[52:55], v[44:47]
    s_waitcnt lgkmcnt(4)
    v_rcp_f32 v77, v77
    v_mfma_f32_16x16x32_bf16 v[32:35], v[144:147], v[56:59], v[32:35]
    ds_read_b128 v[48:51], v8 offset:5120
    v_fmac_f32 v18, v88, v82
    v_mfma_f32_16x16x32_bf16 v[36:39], v[148:151], v[56:59], v[36:39]
    v_mul_f32 v77, v17, v77
    v_mul_f32 v78, v89, v18
    v_mfma_f32_16x16x32_bf16 v[40:43], v[144:147], v[60:63], v[40:43]
    ds_read_b128 v[52:55], v8 offset:25600
    v_mfma_f32_16x16x32_bf16 v[44:47], v[148:151], v[60:63], v[44:47]
    s_add_u32 s53, s53, 512
    v_exp_f32 v78, v78
    v_mfma_f32_16x16x32_bf16 v[32:35], v[152:155], v[64:67], v[32:35]
    ds_read_b128 v[56:59], v9 offset:5120
    v_fmac_f32 v22, v88, v86
    v_mfma_f32_16x16x32_bf16 v[36:39], v[156:159], v[64:67], v[36:39]
    v_cvt_pk_bf16_f32 v72, v76, v77
    v_mul_f32 v18, v18, v22
    v_mfma_f32_16x16x32_bf16 v[40:43], v[152:155], v[68:71], v[40:43]
    ds_read_b128 v[60:63], v9 offset:25600
    v_fma_f32 v78, v78, v90, v90
    v_mfma_f32_16x16x32_bf16 v[44:47], v[156:159], v[68:71], v[44:47]
    s_waitcnt lgkmcnt(4)
    v_rcp_f32 v78, v78
    v_mfma_f32_16x16x32_bf16 v[32:35], v[160:163], a[240:243], v[32:35]
    ds_read_b128 v[64:67], v8 offset:6144
    v_fmac_f32 v19, v88, v83
    v_mfma_f32_16x16x32_bf16 v[36:39], v[164:167], a[240:243], v[36:39]
    buffer_load_dwordx4 v3, s[20:23], s53 offen offset:0 lds
    v_mul_f32 v78, v18, v78
    v_mfma_f32_16x16x32_bf16 v[40:43], v[160:163], a[244:247], v[40:43]
    ds_read_b128 v[68:71], v8 offset:26624
    v_mul_f32 v79, v89, v19
    v_mfma_f32_16x16x32_bf16 v[44:47], v[164:167], a[244:247], v[44:47]
    v_exp_f32 v79, v79
    v_mfma_f32_16x16x32_bf16 v[32:35], v[168:171], a[248:251], v[32:35]
    ds_read_b128 a[240:243], v9 offset:6144
    v_fmac_f32 v23, v88, v87
    v_mfma_f32_16x16x32_bf16 v[36:39], v[172:175], a[248:251], v[36:39]
    buffer_load_dwordx4 v4, s[20:23], s53 offen offset:1024 lds
    v_mul_f32 v19, v19, v23
    v_mfma_f32_16x16x32_bf16 v[40:43], v[168:171], a[252:255], v[40:43]
    ds_read_b128 a[244:247], v9 offset:26624
L_chain5:
L_hk1736:
    s_cbranch_execz L_hk8304
    v_fma_f32 v79, v79, v90, v90
    v_mfma_f32_16x16x32_bf16 v[44:47], v[172:175], a[252:255], v[44:47]
    s_waitcnt lgkmcnt(4)
    v_rcp_f32 v79, v79
    v_mfma_f32_16x16x32_bf16 v[32:35], v[176:179], v[48:51], v[32:35]
    ds_read_b128 a[248:251], v8 offset:7168
    v_fmac_f32 v24, v92, v80
    v_mfma_f32_16x16x32_bf16 v[36:39], v[180:183], v[48:51], v[36:39]
    buffer_load_dwordx4 v5, s[20:23], s53 offen offset:2048 lds
    v_mul_f32 v79, v19, v79
    v_mfma_f32_16x16x32_bf16 v[40:43], v[176:179], v[52:55], v[40:43]
    ds_read_b128 a[252:255], v8 offset:27648
    v_mul_f32 v76, v93, v24
    v_mfma_f32_16x16x32_bf16 v[44:47], v[180:183], v[52:55], v[44:47]
    v_exp_f32 v76, v76
    v_mfma_f32_16x16x32_bf16 v[32:35], v[184:187], v[56:59], v[32:35]
    ds_read_b128 v[48:51], v9 offset:7168
    v_fmac_f32 v28, v92, v84
    v_mfma_f32_16x16x32_bf16 v[36:39], v[188:191], v[56:59], v[36:39]
    v_cvt_pk_bf16_f32 v73, v78, v79
    v_mfma_f32_16x16x32_bf16 v[40:43], v[184:187], v[60:63], v[40:43]
    ds_read_b128 v[52:55], v9 offset:27648
    v_mul_f32 v24, v24, v28
    v_mfma_f32_16x16x32_bf16 v[44:47], v[188:191], v[60:63], v[44:47]
    s_waitcnt lgkmcnt(4)
    buffer_load_dwordx4 v12, s[20:23], s53 offen offset:3072 lds
    v_mfma_f32_16x16x32_bf16 v[32:35], v[192:195], v[64:67], v[32:35]
    ds_read_b128 v[56:59], v8 offset:8192
    v_fma_f32 v76, v76, v94, v94
    v_mfma_f32_16x16x32_bf16 v[36:39], v[196:199], v[64:67], v[36:39]
    v_rcp_f32 v76, v76
    v_mfma_f32_16x16x32_bf16 v[40:43], v[192:195], v[68:71], v[40:43]
    ds_read_b128 v[60:63], v8 offset:28672
    v_mfma_f32_16x16x32_bf16 v[44:47], v[196:199], v[68:71], v[44:47]
    v_fmac_f32 v25, v92, v81
    v_mul_f32 v76, v24, v76
    v_mfma_f32_16x16x32_bf16 v[32:35], v[200:203], a[240:243], v[32:35]
    s_add_u32 m0, s56, 8192
    ds_read_b128 v[64:67], v9 offset:8192
    v_mul_f32 v77, v93, v25
    v_mfma_f32_16x16x32_bf16 v[36:39], v[204:207], a[240:243], v[36:39]
    v_exp_f32 v77, v77
    v_mfma_f32_16x16x32_bf16 v[40:43], v[200:203], a[244:247], v[40:43]
    ds_read_b128 v[68:71], v9 offset:28672
    v_mfma_f32_16x16x32_bf16 v[44:47], v[204:207], a[244:247], v[44:47]
    s_waitcnt lgkmcnt(4)
    v_fmac_f32 v29, v92, v85
    v_mul_f32 v25, v25, v29
    v_mfma_f32_16x16x32_bf16 v[32:35], v[208:211], a[248:251], v[32:35]
    ds_read_b128 a[240:243], v8 offset:9216
    v_fma_f32 v77, v77, v94, v94
    v_mfma_f32_16x16x32_bf16 v[36:39], v[212:215], a[248:251], v[36:39]
    s_add_u32 s53, s53, 512
    v_rcp_f32 v77, v77
    v_mfma_f32_16x16x32_bf16 v[40:43], v[208:211], a[252:255], v[40:43]
    ds_read_b128 a[244:247], v8 offset:29696
    v_mfma_f32_16x16x32_bf16 v[44:47], v[212:215], a[252:255], v[44:47]
    v_fmac_f32 v26, v92, v82
    v_mul_f32 v77, v25, v77
    v_mfma_f32_16x16x32_bf16 v[32:35], v[216:219], v[48:51], v[32:35]
    ds_read_b128 a[248:251], v9 offset:9216
    v_mul_f32 v78, v93, v26
    v_mfma_f32_16x16x32_bf16 v[36:39], v[220:223], v[48:51], v[36:39]
    buffer_load_dwordx4 v3, s[20:23], s53 offen offset:0 lds
    v_mfma_f32_16x16x32_bf16 v[40:43], v[216:219], v[52:55], v[40:43]
    ds_read_b128 a[252:255], v9 offset:29696
    v_add_u32 v8, 0xffff6000, v8
    v_mfma_f32_16x16x32_bf16 v[44:47], v[220:223], v[52:55], v[44:47]
    s_waitcnt lgkmcnt(4)
    v_add_u32 v9, 0xffff6000, v9
    v_mfma_f32_16x16x32_bf16 v[32:35], v[224:227], v[56:59], v[32:35]
    v_exp_f32 v78, v78
    v_mfma_f32_16x16x32_bf16 v[36:39], v[228:231], v[56:59], v[36:39]
    s_waitcnt vmcnt(8) lgkmcnt(0)
    s_barrier
    v_fmac_f32 v30, v92, v86
    v_mfma_f32_16x16x32_bf16 v[40:43], v[224:227], v[60:63], v[40:43]
    ds_read_b128 v[48:51], v8 offset:0
    ds_read_b128 v[52:55], v8 offset:20480
    v_mfma_f32_16x16x32_bf16 v[44:47], v[228:231], v[60:63], v[44:47]
    buffer_load_dwordx4 v4, s[20:23], s53 offen offset:1024 lds
    v_cvt_pk_bf16_f32 v74, v76, v77
    v_mfma_f32_16x16x32_bf16 v[32:35], v[232:235], v[64:67], v[32:35]
    ds_read_b128 v[56:59], v9 offset:0
    v_mul_f32 v26, v26, v30
    v_mfma_f32_16x16x32_bf16 v[36:39], v[236:239], v[64:67], v[36:39]
    buffer_store_dword v13, v11, s[28:31], s55 offen sc1
    v_fma_f32 v78, v78, v94, v94
    v_mfma_f32_16x16x32_bf16 v[40:43], v[232:235], v[68:71], v[40:43]
    ds_read_b128 v[60:63], v9 offset:20480
    v_rcp_f32 v78, v78
    v_mfma_f32_16x16x32_bf16 v[44:47], v[236:239], v[68:71], v[44:47]
    s_add_u32 m0, s56, 81920
    v_fmac_f32 v27, v92, v83
    v_mul_f32 v78, v26, v78
    v_mfma_f32_16x16x32_bf16 v[32:35], v[240:243], a[240:243], v[32:35]
    s_add_u32 s55, s55, 49152
    ds_read_b128 v[64:67], v8 offset:1024
    v_mul_f32 v79, v93, v27
    v_mfma_f32_16x16x32_bf16 v[36:39], v[244:247], a[240:243], v[36:39]
    v_exp_f32 v79, v79
    v_mfma_f32_16x16x32_bf16 v[40:43], v[240:243], a[244:247], v[40:43]
    ds_read_b128 v[68:71], v8 offset:21504
    v_fmac_f32 v31, v92, v87
    v_mfma_f32_16x16x32_bf16 v[44:47], v[244:247], a[244:247], v[44:47]
    v_mul_f32 v27, v27, v31
    v_fma_f32 v79, v79, v94, v94
    v_mfma_f32_16x16x32_bf16 v[32:35], v[248:251], a[248:251], v[32:35]
    s_add_u32 s53, s53, 244736
    ds_read_b128 a[240:243], v9 offset:1024
    ds_read_b96 v[88:90], v0 offset:1536
    v_mfma_f32_16x16x32_bf16 v[36:39], v[252:255], a[248:251], v[36:39]
    v_rcp_f32 v79, v79
    v_mfma_f32_16x16x32_bf16 v[40:43], v[248:251], a[252:255], v[40:43]
    ds_read_b128 a[244:247], v9 offset:21504
    v_permlane16_swap_b32 v72, v74
    v_mfma_f32_16x16x32_bf16 v[44:47], v[252:255], a[252:255], v[44:47]
    s_waitcnt lgkmcnt(5)
    v_mul_f32 v79, v27, v79
    v_mfma_f32_16x16x32_bf16 v[16:19], v[96:99], v[48:51], 0
    ds_read_b128 a[248:251], v8 offset:2048
    v_mfma_f32_16x16x32_bf16 v[20:23], v[100:103], v[48:51], 0
    v_cvt_pk_bf16_f32 v75, v78, v79
    v_mfma_f32_16x16x32_bf16 v[24:27], v[96:99], v[52:55], 0
    ds_read_b128 a[252:255], v8 offset:22528
    ds_read_b96 v[92:94], v0 offset:1792
    v_mfma_f32_16x16x32_bf16 v[28:31], v[100:103], v[52:55], 0
    buffer_load_dwordx4 v3, s[20:23], s53 offen offset:0 lds
    v_mfma_f32_16x16x32_bf16 v[16:19], v[104:107], v[56:59], v[16:19]
    s_waitcnt lgkmcnt(4)
    ds_read_b128 v[48:51], v9 offset:2048
    v_permlane16_swap_b32 v73, v75
    v_mfma_f32_16x16x32_bf16 v[20:23], v[108:111], v[56:59], v[20:23]
    buffer_store_dwordx4 v[72:75], v10, s[24:27], s54 offen sc1
    v_mfma_f32_16x16x32_bf16 v[24:27], v[104:107], v[60:63], v[24:27]
    ds_read_b128 v[52:55], v9 offset:22528
    v_fmac_f32 v32, v88, v80
    v_mfma_f32_16x16x32_bf16 v[28:31], v[108:111], v[60:63], v[28:31]
    s_waitcnt lgkmcnt(5)
    buffer_load_dwordx4 v4, s[20:23], s53 offen offset:1024 lds
    v_mfma_f32_16x16x32_bf16 v[16:19], v[112:115], v[64:67], v[16:19]
    s_add_u32 s54, s54, 1155072
    ds_read_b128 v[56:59], v8 offset:3072
    v_mul_f32 v76, v89, v32
    v_mfma_f32_16x16x32_bf16 v[20:23], v[116:119], v[64:67], v[20:23]
    v_exp_f32 v76, v76
    v_mfma_f32_16x16x32_bf16 v[24:27], v[112:115], v[68:71], v[24:27]
    ds_read_b128 v[60:63], v8 offset:23552
    v_fmac_f32 v36, v88, v84
    v_mfma_f32_16x16x32_bf16 v[28:31], v[116:119], v[68:71], v[28:31]
    v_mul_f32 v32, v32, v36
    v_fma_f32 v76, v76, v90, v90
    v_mfma_f32_16x16x32_bf16 v[16:19], v[120:123], a[240:243], v[16:19]
    ds_read_b128 v[64:67], v9 offset:3072
    v_mfma_f32_16x16x32_bf16 v[20:23], v[124:127], a[240:243], v[20:23]
    buffer_load_dwordx4 v5, s[20:23], s53 offen offset:2048 lds
    v_mfma_f32_16x16x32_bf16 v[24:27], v[120:123], a[244:247], v[24:27]
    ds_read_b128 v[68:71], v9 offset:23552
    v_mfma_f32_16x16x32_bf16 v[28:31], v[124:127], a[244:247], v[28:31]
    s_waitcnt lgkmcnt(4)
    v_rcp_f32 v76, v76
    v_mfma_f32_16x16x32_bf16 v[16:19], v[128:131], a[248:251], v[16:19]
    ds_read_b128 a[240:243], v8 offset:4096
    v_fmac_f32 v33, v88, v81
    v_mfma_f32_16x16x32_bf16 v[20:23], v[132:135], a[248:251], v[20:23]
    buffer_load_dwordx4 v12, s[20:23], s53 offen offset:3072 lds
    v_mul_f32 v76, v32, v76
    v_mfma_f32_16x16x32_bf16 v[24:27], v[128:131], a[252:255], v[24:27]
    ds_read_b128 a[244:247], v8 offset:24576
    v_mul_f32 v77, v89, v33
    v_mfma_f32_16x16x32_bf16 v[28:31], v[132:135], a[252:255], v[28:31]
    v_exp_f32 v77, v77
    v_mfma_f32_16x16x32_bf16 v[16:19], v[136:139], v[48:51], v[16:19]
    ds_read_b128 a[248:251], v9 offset:4096
    v_fmac_f32 v37, v88, v85
    v_mfma_f32_16x16x32_bf16 v[20:23], v[140:143], v[48:51], v[20:23]
    v_mul_f32 v33, v33, v37
    v_fma_f32 v77, v77, v90, v90
    v_mfma_f32_16x16x32_bf16 v[24:27], v[136:139], v[52:55], v[24:27]
    s_add_u32 m0, s56, 86016
    ds_read_b128 a[252:255], v9 offset:24576
    v_mfma_f32_16x16x32_bf16 v[28:31], v[140:143], v[52:55], v[28:31]
    s_waitcnt lgkmcnt(4)
    v_rcp_f32 v77, v77
    v_mfma_f32_16x16x32_bf16 v[16:19], v[144:147], v[56:59], v[16:19]
    ds_read_b128 v[48:51], v8 offset:5120
    v_fmac_f32 v34, v88, v82
    v_mfma_f32_16x16x32_bf16 v[20:23], v[148:151], v[56:59], v[20:23]
    v_mul_f32 v77, v33, v77
    v_mul_f32 v78, v89, v34
    v_mfma_f32_16x16x32_bf16 v[24:27], v[144:147], v[60:63], v[24:27]
    ds_read_b128 v[52:55], v8 offset:25600
    v_mfma_f32_16x16x32_bf16 v[28:31], v[148:151], v[60:63], v[28:31]
    s_add_u32 s53, s53, 512
    v_exp_f32 v78, v78
    v_mfma_f32_16x16x32_bf16 v[16:19], v[152:155], v[64:67], v[16:19]
    ds_read_b128 v[56:59], v9 offset:5120
    v_fmac_f32 v38, v88, v86
    v_mfma_f32_16x16x32_bf16 v[20:23], v[156:159], v[64:67], v[20:23]
    v_cvt_pk_bf16_f32 v72, v76, v77
    v_mul_f32 v34, v34, v38
    v_mfma_f32_16x16x32_bf16 v[24:27], v[152:155], v[68:71], v[24:27]
    ds_read_b128 v[60:63], v9 offset:25600
    v_fma_f32 v78, v78, v90, v90
    v_mfma_f32_16x16x32_bf16 v[28:31], v[156:159], v[68:71], v[28:31]
    s_waitcnt lgkmcnt(4)
    v_rcp_f32 v78, v78
    v_mfma_f32_16x16x32_bf16 v[16:19], v[160:163], a[240:243], v[16:19]
    ds_read_b128 v[64:67], v8 offset:6144
    v_fmac_f32 v35, v88, v83
    v_mfma_f32_16x16x32_bf16 v[20:23], v[164:167], a[240:243], v[20:23]
    buffer_load_dwordx4 v3, s[20:23], s53 offen offset:0 lds
    v_mul_f32 v78, v34, v78
    v_mfma_f32_16x16x32_bf16 v[24:27], v[160:163], a[244:247], v[24:27]
    ds_read_b128 v[68:71], v8 offset:26624
    v_mul_f32 v79, v89, v35
    v_mfma_f32_16x16x32_bf16 v[28:31], v[164:167], a[244:247], v[28:31]
    v_exp_f32 v79, v79
    v_mfma_f32_16x16x32_bf16 v[16:19], v[168:171], a[248:251], v[16:19]
    ds_read_b128 a[240:243], v9 offset:6144
    v_fmac_f32 v39, v88, v87
    v_mfma_f32_16x16x32_bf16 v[20:23], v[172:175], a[248:251], v[20:23]
    buffer_load_dwordx4 v4, s[20:23], s53 offen offset:1024 lds
    v_mul_f32 v35, v35, v39
    v_mfma_f32_16x16x32_bf16 v[24:27], v[168:171], a[252:255], v[24:27]
    ds_read_b128 a[244:247], v9 offset:26624
    v_fma_f32 v79, v79, v90, v90
    v_mfma_f32_16x16x32_bf16 v[28:31], v[172:175], a[252:255], v[28:31]
    s_waitcnt lgkmcnt(4)
    v_rcp_f32 v79, v79
    v_mfma_f32_16x16x32_bf16 v[16:19], v[176:179], v[48:51], v[16:19]
    ds_read_b128 a[248:251], v8 offset:7168
    v_fmac_f32 v40, v92, v80
    v_mfma_f32_16x16x32_bf16 v[20:23], v[180:183], v[48:51], v[20:23]
    buffer_load_dwordx4 v5, s[20:23], s53 offen offset:2048 lds
    v_mul_f32 v79, v35, v79
    v_mfma_f32_16x16x32_bf16 v[24:27], v[176:179], v[52:55], v[24:27]
    ds_read_b128 a[252:255], v8 offset:27648
    v_mul_f32 v76, v93, v40
    v_mfma_f32_16x16x32_bf16 v[28:31], v[180:183], v[52:55], v[28:31]
    v_exp_f32 v76, v76
    v_mfma_f32_16x16x32_bf16 v[16:19], v[184:187], v[56:59], v[16:19]
    ds_read_b128 v[48:51], v9 offset:7168
    v_fmac_f32 v44, v92, v84
    v_mfma_f32_16x16x32_bf16 v[20:23], v[188:191], v[56:59], v[20:23]
    buffer_load_dword v6, v7, s[28:31], s51 offen sc1
    v_mfma_f32_16x16x32_bf16 v[24:27], v[184:187], v[60:63], v[24:27]
    ds_read_b128 v[52:55], v9 offset:27648
    v_cvt_pk_bf16_f32 v73, v78, v79
    v_mfma_f32_16x16x32_bf16 v[28:31], v[188:191], v[60:63], v[28:31]
    s_waitcnt lgkmcnt(4)
    buffer_load_dwordx4 v12, s[20:23], s53 offen offset:3072 lds
    v_mul_f32 v40, v40, v44
    v_mfma_f32_16x16x32_bf16 v[16:19], v[192:195], v[64:67], v[16:19]
    ds_read_b128 v[56:59], v8 offset:8192
    v_fma_f32 v76, v76, v94, v94
    v_mfma_f32_16x16x32_bf16 v[20:23], v[196:199], v[64:67], v[20:23]
    v_rcp_f32 v76, v76
    v_mfma_f32_16x16x32_bf16 v[24:27], v[192:195], v[68:71], v[24:27]
    ds_read_b128 v[60:63], v8 offset:28672
    v_fmac_f32 v41, v92, v81
    v_mfma_f32_16x16x32_bf16 v[28:31], v[196:199], v[68:71], v[28:31]
    v_mul_f32 v76, v40, v76
    v_mul_f32 v77, v93, v41
    v_mfma_f32_16x16x32_bf16 v[16:19], v[200:203], a[240:243], v[16:19]
    s_add_u32 m0, s56, 90112
    ds_read_b128 v[64:67], v9 offset:8192
    v_exp_f32 v77, v77
    v_mfma_f32_16x16x32_bf16 v[20:23], v[204:207], a[240:243], v[20:23]
    v_fmac_f32 v45, v92, v85
    v_mul_f32 v41, v41, v45
    v_mfma_f32_16x16x32_bf16 v[24:27], v[200:203], a[244:247], v[24:27]
    ds_read_b128 v[68:71], v9 offset:28672
    v_fma_f32 v77, v77, v94, v94
    v_mfma_f32_16x16x32_bf16 v[28:31], v[204:207], a[244:247], v[28:31]
    s_waitcnt lgkmcnt(4)
    v_rcp_f32 v77, v77
    v_mfma_f32_16x16x32_bf16 v[16:19], v[208:211], a[248:251], v[16:19]
    ds_read_b128 a[240:243], v8 offset:9216
    v_fmac_f32 v42, v92, v82
    v_mfma_f32_16x16x32_bf16 v[20:23], v[212:215], a[248:251], v[20:23]
    s_add_u32 s53, s53, 512
    v_mul_f32 v77, v41, v77
    v_mul_f32 v78, v93, v42
    v_mfma_f32_16x16x32_bf16 v[24:27], v[208:211], a[252:255], v[24:27]
    ds_read_b128 a[244:247], v8 offset:29696
    v_exp_f32 v78, v78
    v_mfma_f32_16x16x32_bf16 v[28:31], v[212:215], a[252:255], v[28:31]
    v_fmac_f32 v46, v92, v86
    v_cvt_pk_bf16_f32 v74, v76, v77
    v_mfma_f32_16x16x32_bf16 v[16:19], v[216:219], v[48:51], v[16:19]
    ds_read_b128 a[248:251], v9 offset:9216
    v_mul_f32 v42, v42, v46
    v_mfma_f32_16x16x32_bf16 v[20:23], v[220:223], v[48:51], v[20:23]
    buffer_load_dwordx4 v3, s[20:23], s53 offen offset:0 lds
    v_mfma_f32_16x16x32_bf16 v[24:27], v[216:219], v[52:55], v[24:27]
    ds_read_b128 a[252:255], v9 offset:29696
    v_add_u32 v8, 0xffff6000, v8
    v_mfma_f32_16x16x32_bf16 v[28:31], v[220:223], v[52:55], v[28:31]
    s_waitcnt lgkmcnt(4)
    v_add_u32 v9, 0xffff6000, v9
    v_fma_f32 v78, v78, v94, v94
    v_mfma_f32_16x16x32_bf16 v[16:19], v[224:227], v[56:59], v[16:19]
    v_rcp_f32 v78, v78
    v_mfma_f32_16x16x32_bf16 v[20:23], v[228:231], v[56:59], v[20:23]
    s_waitcnt vmcnt(9) lgkmcnt(0)
    s_barrier
    v_fmac_f32 v43, v92, v83
    v_mfma_f32_16x16x32_bf16 v[24:27], v[224:227], v[60:63], v[24:27]
    ds_read_b128 v[48:51], v8 offset:0
    ds_read_b128 v[52:55], v8 offset:20480
    v_mfma_f32_16x16x32_bf16 v[28:31], v[228:231], v[60:63], v[28:31]
    buffer_load_dwordx4 v4, s[20:23], s53 offen offset:1024 lds
    v_mfma_f32_16x16x32_bf16 v[16:19], v[232:235], v[64:67], v[16:19]
    ds_read_b128 v[56:59], v9 offset:0
    v_mul_f32 v78, v42, v78
    v_mfma_f32_16x16x32_bf16 v[20:23], v[236:239], v[64:67], v[20:23]
    buffer_store_dword v13, v11, s[28:31], s55 offen sc1
    v_mfma_f32_16x16x32_bf16 v[24:27], v[232:235], v[68:71], v[24:27]
    ds_read_b128 v[60:63], v9 offset:20480
    v_mul_f32 v79, v93, v43
    v_mfma_f32_16x16x32_bf16 v[28:31], v[236:239], v[68:71], v[28:31]
    s_add_u32 m0, s56, 40960
    v_exp_f32 v79, v79
    v_mfma_f32_16x16x32_bf16 v[16:19], v[240:243], a[240:243], v[16:19]
    s_add_u32 s55, s55, 49152
    ds_read_b128 v[64:67], v8 offset:1024
    v_mfma_f32_16x16x32_bf16 v[20:23], v[244:247], a[240:243], v[20:23]
    v_fmac_f32 v47, v92, v87
    v_mul_f32 v43, v43, v47
    v_mfma_f32_16x16x32_bf16 v[24:27], v[240:243], a[244:247], v[24:27]
    ds_read_b128 v[68:71], v8 offset:21504
    v_fma_f32 v79, v79, v94, v94
    v_mfma_f32_16x16x32_bf16 v[28:31], v[244:247], a[244:247], v[28:31]
    v_rcp_f32 v79, v79
    v_mfma_f32_16x16x32_bf16 v[16:19], v[248:251], a[248:251], v[16:19]
    s_add_u32 s53, s53, 244736
    ds_read_b128 a[240:243], v9 offset:1024
    ds_read_b96 v[88:90], v0 offset:2048
    v_mfma_f32_16x16x32_bf16 v[20:23], v[252:255], a[248:251], v[20:23]
    s_waitcnt vmcnt(4)
    v_cmp_ne_u32 vcc, v6, v13
    s_cbranch_vccnz Lf6s_4
Lf6b_5:
    v_mfma_f32_16x16x32_bf16 v[24:27], v[248:251], a[252:255], v[24:27]
    ds_read_b128 a[244:247], v9 offset:21504
    v_permlane16_swap_b32 v72, v74
    v_mfma_f32_16x16x32_bf16 v[28:31], v[252:255], a[252:255], v[28:31]
    s_waitcnt lgkmcnt(5)
    v_mul_f32 v79, v43, v79
    v_mfma_f32_16x16x32_bf16 v[32:35], v[96:99], v[48:51], 0
    ds_read_b128 a[248:251], v8 offset:2048
    v_cvt_pk_bf16_f32 v75, v78, v79
    v_mfma_f32_16x16x32_bf16 v[36:39], v[100:103], v[48:51], 0
    buffer_load_dwordx4 v3, s[20:23], s53 offen offset:0 lds
    v_mfma_f32_16x16x32_bf16 v[40:43], v[96:99], v[52:55], 0
    ds_read_b128 a[252:255], v8 offset:22528
    ds_read_b96 v[92:94], v0 offset:2304
    v_mfma_f32_16x16x32_bf16 v[44:47], v[100:103], v[52:55], 0
    v_mfma_f32_16x16x32_bf16 v[32:35], v[104:107], v[56:59], v[32:35]
    s_add_u32 s50, s48, 0
    ds_read_b128 v[48:51], v9 offset:2048
    v_permlane16_swap_b32 v73, v75
    v_mfma_f32_16x16x32_bf16 v[36:39], v[108:111], v[56:59], v[36:39]
    s_waitcnt lgkmcnt(5)
    buffer_store_dwordx4 v[72:75], v10, s[24:27], s54 offen sc1
    v_mfma_f32_16x16x32_bf16 v[40:43], v[104:107], v[60:63], v[40:43]
    ds_read_b128 v[52:55], v9 offset:22528
    v_fmac_f32 v16, v88, v80
    v_mul_f32 v76, v89, v16
    v_mfma_f32_16x16x32_bf16 v[44:47], v[108:111], v[60:63], v[44:47]
    s_waitcnt lgkmcnt(5)
    buffer_load_dwordx4 a[0:3], v2, s[40:43], s50 offen offset:0
    v_exp_f32 v76, v76
    v_mfma_f32_16x16x32_bf16 v[32:35], v[112:115], v[64:67], v[32:35]
    s_add_u32 s54, s54, 1155072
    ds_read_b128 v[56:59], v8 offset:3072
    v_fmac_f32 v20, v88, v84
    v_mfma_f32_16x16x32_bf16 v[36:39], v[116:119], v[64:67], v[36:39]
    buffer_load_dwordx4 v4, s[20:23], s53 offen offset:1024 lds
    v_mul_f32 v16, v16, v20
    v_mfma_f32_16x16x32_bf16 v[40:43], v[112:115], v[68:71], v[40:43]
    ds_read_b128 v[60:63], v8 offset:23552
    v_fma_f32 v76, v76, v90, v90
    v_mfma_f32_16x16x32_bf16 v[44:47], v[116:119], v[68:71], v[44:47]
    v_rcp_f32 v76, v76
    v_mfma_f32_16x16x32_bf16 v[32:35], v[120:123], a[240:243], v[32:35]
    ds_read_b128 v[64:67], v9 offset:3072
    v_fmac_f32 v17, v88, v81
    v_mfma_f32_16x16x32_bf16 v[36:39], v[124:127], a[240:243], v[36:39]
    buffer_load_dwordx4 a[4:7], v2, s[40:43], s50 offen offset:1024
    v_mul_f32 v76, v16, v76
    v_mfma_f32_16x16x32_bf16 v[40:43], v[120:123], a[244:247], v[40:43]
    ds_read_b128 v[68:71], v9 offset:23552
    v_mul_f32 v77, v89, v17
    v_mfma_f32_16x16x32_bf16 v[44:47], v[124:127], a[244:247], v[44:47]
    s_waitcnt lgkmcnt(4)
    buffer_load_dwordx4 v5, s[20:23], s53 offen offset:2048 lds
    v_exp_f32 v77, v77
    v_mfma_f32_16x16x32_bf16 v[32:35], v[128:131], a[248:251], v[32:35]
    ds_read_b128 a[240:243], v8 offset:4096
    v_fmac_f32 v21, v88, v85
    v_mfma_f32_16x16x32_bf16 v[36:39], v[132:135], a[248:251], v[36:39]
    buffer_load_dwordx4 a[8:11], v2, s[40:43], s50 offen offset:2048
    v_mul_f32 v17, v17, v21
    v_mfma_f32_16x16x32_bf16 v[40:43], v[128:131], a[252:255], v[40:43]
    ds_read_b128 a[244:247], v8 offset:24576
    v_fma_f32 v77, v77, v90, v90
    v_mfma_f32_16x16x32_bf16 v[44:47], v[132:135], a[252:255], v[44:47]
    v_rcp_f32 v77, v77
    v_mfma_f32_16x16x32_bf16 v[32:35], v[136:139], v[48:51], v[32:35]
    ds_read_b128 a[248:251], v9 offset:4096
    v_mfma_f32_16x16x32_bf16 v[36:39], v[140:143], v[48:51], v[36:39]
    buffer_load_dwordx4 v12, s[20:23], s53 offen offset:3072 lds
    v_mfma_f32_16x16x32_bf16 v[40:43], v[136:139], v[52:55], v[40:43]
    ds_read_b128 a[252:255], v9 offset:24576
    v_fmac_f32 v18, v88, v82
    v_mfma_f32_16x16x32_bf16 v[44:47], v[140:143], v[52:55], v[44:47]
    s_add_u32 m0, s56, 45056
    s_waitcnt lgkmcnt(4)
    v_mul_f32 v77, v17, v77
    v_mfma_f32_16x16x32_bf16 v[32:35], v[144:147], v[56:59], v[32:35]
    ds_read_b128 v[48:51], v8 offset:5120
    v_mul_f32 v78, v89, v18
    v_mfma_f32_16x16x32_bf16 v[36:39], v[148:151], v[56:59], v[36:39]
    v_exp_f32 v78, v78
    v_mfma_f32_16x16x32_bf16 v[40:43], v[144:147], v[60:63], v[40:43]
    s_add_u32 s53, s53, 512
    ds_read_b128 v[52:55], v8 offset:25600
    v_fmac_f32 v22, v88, v86
    v_mfma_f32_16x16x32_bf16 v[44:47], v[148:151], v[60:63], v[44:47]
    v_cvt_pk_bf16_f32 v72, v76, v77
    v_mul_f32 v18, v18, v22
    v_mfma_f32_16x16x32_bf16 v[32:35], v[152:155], v[64:67], v[32:35]
    ds_read_b128 v[56:59], v9 offset:5120
    v_fma_f32 v78, v78, v90, v90
    v_mfma_f32_16x16x32_bf16 v[36:39], v[156:159], v[64:67], v[36:39]
    buffer_load_dwordx4 a[12:15], v2, s[40:43], s50 offen offset:3072
    v_rcp_f32 v78, v78
    v_mfma_f32_16x16x32_bf16 v[40:43], v[152:155], v[68:71], v[40:43]
    ds_read_b128 v[60:63], v9 offset:25600
    v_fmac_f32 v19, v88, v83
    v_mfma_f32_16x16x32_bf16 v[44:47], v[156:159], v[68:71], v[44:47]
    s_add_u32 s50, s48, 4096
    s_waitcnt lgkmcnt(4)
    v_mul_f32 v78, v18, v78
    v_mfma_f32_16x16x32_bf16 v[32:35], v[160:163], a[240:243], v[32:35]
    ds_read_b128 v[64:67], v8 offset:6144
    v_mul_f32 v79, v89, v19
    v_mfma_f32_16x16x32_bf16 v[36:39], v[164:167], a[240:243], v[36:39]
    v_exp_f32 v79, v79
    v_mfma_f32_16x16x32_bf16 v[40:43], v[160:163], a[244:247], v[40:43]
    ds_read_b128 v[68:71], v8 offset:26624
    v_fmac_f32 v23, v88, v87
    v_mfma_f32_16x16x32_bf16 v[44:47], v[164:167], a[244:247], v[44:47]
    buffer_load_dwordx4 v3, s[20:23], s53 offen offset:0 lds
    v_mul_f32 v19, v19, v23
    v_mfma_f32_16x16x32_bf16 v[32:35], v[168:171], a[248:251], v[32:35]
    ds_read_b128 a[240:243], v9 offset:6144
    v_fma_f32 v79, v79, v90, v90
    v_mfma_f32_16x16x32_bf16 v[36:39], v[172:175], a[248:251], v[36:39]
    buffer_load_dwordx4 a[16:19], v2, s[40:43], s50 offen offset:0
    v_rcp_f32 v79, v79
    v_mfma_f32_16x16x32_bf16 v[40:43], v[168:171], a[252:255], v[40:43]
    ds_read_b128 a[244:247], v9 offset:26624
    v_fmac_f32 v24, v92, v80
    v_mfma_f32_16x16x32_bf16 v[44:47], v[172:175], a[252:255], v[44:47]
    s_waitcnt lgkmcnt(4)
    buffer_load_dwordx4 v4, s[20:23], s53 offen offset:1024 lds
    v_mul_f32 v79, v19, v79
    v_mfma_f32_16x16x32_bf16 v[32:35], v[176:179], v[48:51], v[32:35]
    ds_read_b128 a[248:251], v8 offset:7168
    v_mul_f32 v76, v93, v24
    v_mfma_f32_16x16x32_bf16 v[36:39], v[180:183], v[48:51], v[36:39]
    v_exp_f32 v76, v76
    v_mfma_f32_16x16x32_bf16 v[40:43], v[176:179], v[52:55], v[40:43]
    ds_read_b128 a[252:255], v8 offset:27648
    v_fmac_f32 v28, v92, v84
    v_mfma_f32_16x16x32_bf16 v[44:47], v[180:183], v[52:55], v[44:47]
    buffer_load_dwordx4 a[20:23], v2, s[40:43], s50 offen offset:1024
    v_mfma_f32_16x16x32_bf16 v[32:35], v[184:187], v[56:59], v[32:35]
    ds_read_b128 v[48:51], v9 offset:7168
    v_cvt_pk_bf16_f32 v73, v78, v79
    v_mfma_f32_16x16x32_bf16 v[36:39], v[188:191], v[56:59], v[36:39]
    buffer_load_dwordx4 v5, s[20:23], s53 offen offset:2048 lds
    v_mfma_f32_16x16x32_bf16 v[40:43], v[184:187], v[60:63], v[40:43]
    ds_read_b128 v[52:55], v9 offset:27648
    v_mul_f32 v24, v24, v28
    v_mfma_f32_16x16x32_bf16 v[44:47], v[188:191], v[60:63], v[44:47]
    s_waitcnt lgkmcnt(4)
    buffer_load_dwordx4 a[24:27], v2, s[40:43], s50 offen offset:2048
    v_mfma_f32_16x16x32_bf16 v[32:35], v[192:195], v[64:67], v[32:35]
    ds_read_b128 v[56:59], v8 offset:8192
    v_fma_f32 v76, v76, v94, v94
    v_mfma_f32_16x16x32_bf16 v[36:39], v[196:199], v[64:67], v[36:39]
    v_rcp_f32 v76, v76
    v_mfma_f32_16x16x32_bf16 v[40:43], v[192:195], v[68:71], v[40:43]
    ds_read_b128 v[60:63], v8 offset:28672
    v_fmac_f32 v25, v92, v81
    v_mfma_f32_16x16x32_bf16 v[44:47], v[196:199], v[68:71], v[44:47]
    buffer_load_dwordx4 v12, s[20:23], s53 offen offset:3072 lds
    v_mul_f32 v76, v24, v76
    v_mfma_f32_16x16x32_bf16 v[32:35], v[200:203], a[240:243], v[32:35]
    ds_read_b128 v[64:67], v9 offset:8192
    v_mul_f32 v77, v93, v25
    v_mfma_f32_16x16x32_bf16 v[36:39], v[204:207], a[240:243], v[36:39]
    s_add_u32 m0, s56, 49152
    v_exp_f32 v77, v77
    v_mfma_f32_16x16x32_bf16 v[40:43], v[200:203], a[244:247], v[40:43]
    ds_read_b128 v[68:71], v9 offset:28672
    v_mfma_f32_16x16x32_bf16 v[44:47], v[204:207], a[244:247], v[44:47]
    s_waitcnt lgkmcnt(4)
    v_fmac_f32 v29, v92, v85
    v_mul_f32 v25, v25, v29
    v_mfma_f32_16x16x32_bf16 v[32:35], v[208:211], a[248:251], v[32:35]
    s_add_u32 s53, s53, 512
    ds_read_b128 a[240:243], v8 offset:9216
    v_fma_f32 v77, v77, v94, v94
    v_mfma_f32_16x16x32_bf16 v[36:39], v[212:215], a[248:251], v[36:39]
    v_rcp_f32 v77, v77
    v_mfma_f32_16x16x32_bf16 v[40:43], v[208:211], a[252:255], v[40:43]
    ds_read_b128 a[244:247], v8 offset:29696
    v_fmac_f32 v26, v92, v82
    v_mfma_f32_16x16x32_bf16 v[44:47], v[212:215], a[252:255], v[44:47]
    buffer_load_dwordx4 a[28:31], v2, s[40:43], s50 offen offset:3072
    v_mul_f32 v77, v25, v77
    v_mfma_f32_16x16x32_bf16 v[32:35], v[216:219], v[48:51], v[32:35]
    ds_read_b128 a[248:251], v9 offset:9216
    v_mul_f32 v78, v93, v26
    v_mfma_f32_16x16x32_bf16 v[36:39], v[220:223], v[48:51], v[36:39]
    s_add_u32 s50, s48, 8192
    v_exp_f32 v78, v78
    v_mfma_f32_16x16x32_bf16 v[40:43], v[216:219], v[52:55], v[40:43]
    ds_read_b128 a[252:255], v9 offset:29696
    v_add_u32 v8, 0x14000, v8
    v_mfma_f32_16x16x32_bf16 v[44:47], v[220:223], v[52:55], v[44:47]
    s_waitcnt lgkmcnt(4)
    v_add_u32 v9, 0x14000, v9
    v_fmac_f32 v30, v92, v86
    v_mfma_f32_16x16x32_bf16 v[32:35], v[224:227], v[56:59], v[32:35]
    buffer_load_dwordx4 v3, s[20:23], s53 offen offset:0 lds
    v_cvt_pk_bf16_f32 v74, v76, v77
    v_mfma_f32_16x16x32_bf16 v[36:39], v[228:231], v[56:59], v[36:39]
    s_waitcnt vmcnt(16) lgkmcnt(0)
    s_barrier
    v_mul_f32 v26, v26, v30
    v_mfma_f32_16x16x32_bf16 v[40:43], v[224:227], v[60:63], v[40:43]
    ds_read_b128 v[48:51], v8 offset:0
    ds_read_b128 v[52:55], v8 offset:20480
    v_mfma_f32_16x16x32_bf16 v[44:47], v[228:231], v[60:63], v[44:47]
    buffer_load_dwordx4 a[32:35], v2, s[40:43], s50 offen offset:0
    v_fma_f32 v78, v78, v94, v94
    v_mfma_f32_16x16x32_bf16 v[32:35], v[232:235], v[64:67], v[32:35]
    ds_read_b128 v[56:59], v9 offset:0
    v_rcp_f32 v78, v78
    v_mfma_f32_16x16x32_bf16 v[36:39], v[236:239], v[64:67], v[36:39]
    buffer_store_dword v13, v11, s[28:31], s55 offen sc1
    v_fmac_f32 v27, v92, v83
    v_mfma_f32_16x16x32_bf16 v[40:43], v[232:235], v[68:71], v[40:43]
    ds_read_b128 v[60:63], v9 offset:20480
    v_mul_f32 v78, v26, v78
    v_mfma_f32_16x16x32_bf16 v[44:47], v[236:239], v[68:71], v[44:47]
    buffer_load_dwordx4 v4, s[20:23], s53 offen offset:1024 lds
    v_mul_f32 v79, v93, v27
    v_mfma_f32_16x16x32_bf16 v[32:35], v[240:243], a[240:243], v[32:35]
    s_add_u32 s55, s55, 49152
    s_add_u32 m0, s56, 0
    ds_read_b128 v[64:67], v8 offset:1024
    v_mfma_f32_16x16x32_bf16 v[36:39], v[244:247], a[240:243], v[36:39]
    v_exp_f32 v79, v79
    v_mfma_f32_16x16x32_bf16 v[40:43], v[240:243], a[244:247], v[40:43]
    s_add_u32 s53, s53, 244736
    ds_read_b128 v[68:71], v8 offset:21504
    v_fmac_f32 v31, v92, v87
    v_mfma_f32_16x16x32_bf16 v[44:47], v[244:247], a[244:247], v[44:47]
    v_mul_f32 v27, v27, v31
    v_fma_f32 v79, v79, v94, v94
    v_mfma_f32_16x16x32_bf16 v[32:35], v[248:251], a[248:251], v[32:35]
    ds_read_b128 a[240:243], v9 offset:1024
    ds_read_b96 v[88:90], v0 offset:2560
    v_mfma_f32_16x16x32_bf16 v[36:39], v[252:255], a[248:251], v[36:39]
    buffer_load_dwordx4 a[36:39], v2, s[40:43], s50 offen offset:1024
    v_mfma_f32_16x16x32_bf16 v[40:43], v[248:251], a[252:255], v[40:43]
    ds_read_b128 a[244:247], v9 offset:21504
    v_rcp_f32 v79, v79
    v_mfma_f32_16x16x32_bf16 v[44:47], v[252:255], a[252:255], v[44:47]
    s_waitcnt lgkmcnt(5)
    v_permlane16_swap_b32 v72, v74
    v_mul_f32 v79, v27, v79
    v_mfma_f32_16x16x32_bf16 v[16:19], v[96:99], v[48:51], 0
    ds_read_b128 a[248:251], v8 offset:2048
    v_cvt_pk_bf16_f32 v75, v78, v79
    v_mfma_f32_16x16x32_bf16 v[20:23], v[100:103], v[48:51], 0
    buffer_load_dwordx4 v3, s[20:23], s53 offen offset:0 lds
    v_mfma_f32_16x16x32_bf16 v[24:27], v[96:99], v[52:55], 0
    ds_read_b128 a[252:255], v8 offset:22528
    ds_read_b96 v[92:94], v0 offset:2816
    v_mfma_f32_16x16x32_bf16 v[28:31], v[100:103], v[52:55], 0
    v_mfma_f32_16x16x32_bf16 v[16:19], v[104:107], v[56:59], v[16:19]
    s_waitcnt lgkmcnt(4)
    ds_read_b128 v[48:51], v9 offset:2048
    v_permlane16_swap_b32 v73, v75
    v_mfma_f32_16x16x32_bf16 v[20:23], v[108:111], v[56:59], v[20:23]
    buffer_load_dwordx4 a[40:43], v2, s[40:43], s50 offen offset:2048
    v_fmac_f32 v32, v88, v80
L_chain6:
L_hk2342:
    s_cbranch_execz L_hk7667
    v_mfma_f32_16x16x32_bf16 v[24:27], v[104:107], v[60:63], v[24:27]
    ds_read_b128 v[52:55], v9 offset:22528
    buffer_store_dwordx4 v[72:75], v10, s[24:27], s54 offen sc1
    v_mfma_f32_16x16x32_bf16 v[28:31], v[108:111], v[60:63], v[28:31]
    s_waitcnt lgkmcnt(5)
    buffer_load_dwordx4 v4, s[20:23], s53 offen offset:1024 lds
    v_mfma_f32_16x16x32_bf16 v[16:19], v[112:115], v[64:67], v[16:19]
    s_add_u32 s54, s54, 1155072
    ds_read_b128 v[56:59], v8 offset:3072
    v_mul_f32 v76, v89, v32
    v_mfma_f32_16x16x32_bf16 v[20:23], v[116:119], v[64:67], v[20:23]
    buffer_load_dwordx4 a[44:47], v2, s[40:43], s50 offen offset:3072
    v_mfma_f32_16x16x32_bf16 v[24:27], v[112:115], v[68:71], v[24:27]
    ds_read_b128 v[60:63], v8 offset:23552
    v_exp_f32 v76, v76
    v_mfma_f32_16x16x32_bf16 v[28:31], v[116:119], v[68:71], v[28:31]
    v_fmac_f32 v36, v88, v84
    v_mul_f32 v32, v32, v36
    v_mfma_f32_16x16x32_bf16 v[16:19], v[120:123], a[240:243], v[16:19]
    ds_read_b128 v[64:67], v9 offset:3072
    v_fma_f32 v76, v76, v90, v90
    v_mfma_f32_16x16x32_bf16 v[20:23], v[124:127], a[240:243], v[20:23]
    s_add_u32 s50, s48, 12288
    v_rcp_f32 v76, v76
    v_mfma_f32_16x16x32_bf16 v[24:27], v[120:123], a[244:247], v[24:27]
    ds_read_b128 v[68:71], v9 offset:23552
    v_fmac_f32 v33, v88, v81
    v_mfma_f32_16x16x32_bf16 v[28:31], v[124:127], a[244:247], v[28:31]
    s_waitcnt lgkmcnt(4)
    buffer_load_dwordx4 v5, s[20:23], s53 offen offset:2048 lds
    v_mul_f32 v76, v32, v76
    v_mfma_f32_16x16x32_bf16 v[16:19], v[128:131], a[248:251], v[16:19]
    ds_read_b128 a[240:243], v8 offset:4096
    v_mul_f32 v77, v89, v33
    v_mfma_f32_16x16x32_bf16 v[20:23], v[132:135], a[248:251], v[20:23]
    buffer_load_dwordx4 a[48:51], v2, s[40:43], s50 offen offset:0
    v_exp_f32 v77, v77
    v_mfma_f32_16x16x32_bf16 v[24:27], v[128:131], a[252:255], v[24:27]
    ds_read_b128 a[244:247], v8 offset:24576
    v_fmac_f32 v37, v88, v85
    v_mfma_f32_16x16x32_bf16 v[28:31], v[132:135], a[252:255], v[28:31]
    v_mul_f32 v33, v33, v37
    v_fma_f32 v77, v77, v90, v90
    v_mfma_f32_16x16x32_bf16 v[16:19], v[136:139], v[48:51], v[16:19]
    ds_read_b128 a[248:251], v9 offset:4096
    v_rcp_f32 v77, v77
    v_mfma_f32_16x16x32_bf16 v[20:23], v[140:143], v[48:51], v[20:23]
    buffer_load_dwordx4 v12, s[20:23], s53 offen offset:3072 lds
    v_mfma_f32_16x16x32_bf16 v[24:27], v[136:139], v[52:55], v[24:27]
    ds_read_b128 a[252:255], v9 offset:24576
    v_fmac_f32 v34, v88, v82
    v_mfma_f32_16x16x32_bf16 v[28:31], v[140:143], v[52:55], v[28:31]
    s_add_u32 m0, s56, 4096
    s_waitcnt lgkmcnt(4)
    v_mul_f32 v77, v33, v77
    v_mfma_f32_16x16x32_bf16 v[16:19], v[144:147], v[56:59], v[16:19]
    ds_read_b128 v[48:51], v8 offset:5120
    v_mul_f32 v78, v89, v34
    v_mfma_f32_16x16x32_bf16 v[20:23], v[148:151], v[56:59], v[20:23]
    v_exp_f32 v78, v78
    v_mfma_f32_16x16x32_bf16 v[24:27], v[144:147], v[60:63], v[24:27]
    s_add_u32 s53, s53, 512
    ds_read_b128 v[52:55], v8 offset:25600
    v_fmac_f32 v38, v88, v86
    v_mfma_f32_16x16x32_bf16 v[28:31], v[148:151], v[60:63], v[28:31]
    v_cvt_pk_bf16_f32 v72, v76, v77
    v_mul_f32 v34, v34, v38
    v_mfma_f32_16x16x32_bf16 v[16:19], v[152:155], v[64:67], v[16:19]
    ds_read_b128 v[56:59], v9 offset:5120
    v_fma_f32 v78, v78, v90, v90
    v_mfma_f32_16x16x32_bf16 v[20:23], v[156:159], v[64:67], v[20:23]
    buffer_load_dwordx4 a[52:55], v2, s[40:43], s50 offen offset:1024
    v_rcp_f32 v78, v78
    v_mfma_f32_16x16x32_bf16 v[24:27], v[152:155], v[68:71], v[24:27]
    ds_read_b128 v[60:63], v9 offset:25600
    v_fmac_f32 v35, v88, v83
    v_mfma_f32_16x16x32_bf16 v[28:31], v[156:159], v[68:71], v[28:31]
    s_waitcnt lgkmcnt(4)
    buffer_load_dwordx4 v3, s[20:23], s53 offen offset:0 lds
    v_mul_f32 v78, v34, v78
    v_mfma_f32_16x16x32_bf16 v[16:19], v[160:163], a[240:243], v[16:19]
    ds_read_b128 v[64:67], v8 offset:6144
    v_mul_f32 v79, v89, v35
    v_mfma_f32_16x16x32_bf16 v[20:23], v[164:167], a[240:243], v[20:23]
    v_exp_f32 v79, v79
    v_mfma_f32_16x16x32_bf16 v[24:27], v[160:163], a[244:247], v[24:27]
    ds_read_b128 v[68:71], v8 offset:26624
    v_fmac_f32 v39, v88, v87
    v_mfma_f32_16x16x32_bf16 v[28:31], v[164:167], a[244:247], v[28:31]
    buffer_load_dwordx4 a[56:59], v2, s[40:43], s50 offen offset:2048
    v_mul_f32 v35, v35, v39
    v_mfma_f32_16x16x32_bf16 v[16:19], v[168:171], a[248:251], v[16:19]
    ds_read_b128 a[240:243], v9 offset:6144
    v_fma_f32 v79, v79, v90, v90
    v_mfma_f32_16x16x32_bf16 v[20:23], v[172:175], a[248:251], v[20:23]
    buffer_load_dwordx4 v4, s[20:23], s53 offen offset:1024 lds
    v_rcp_f32 v79, v79
    v_mfma_f32_16x16x32_bf16 v[24:27], v[168:171], a[252:255], v[24:27]
    ds_read_b128 a[244:247], v9 offset:26624
    v_fmac_f32 v40, v92, v80
    v_mfma_f32_16x16x32_bf16 v[28:31], v[172:175], a[252:255], v[28:31]
    s_waitcnt lgkmcnt(4)
    buffer_load_dwordx4 a[60:63], v2, s[40:43], s50 offen offset:3072
    v_mul_f32 v79, v35, v79
    v_mfma_f32_16x16x32_bf16 v[16:19], v[176:179], v[48:51], v[16:19]
    ds_read_b128 a[248:251], v8 offset:7168
    v_mul_f32 v76, v93, v40
    v_mfma_f32_16x16x32_bf16 v[20:23], v[180:183], v[48:51], v[20:23]
    v_exp_f32 v76, v76
    v_mfma_f32_16x16x32_bf16 v[24:27], v[176:179], v[52:55], v[24:27]
    s_add_u32 s50, s48, 16384
    ds_read_b128 a[252:255], v8 offset:27648
    v_fmac_f32 v44, v92, v84
    v_mfma_f32_16x16x32_bf16 v[28:31], v[180:183], v[52:55], v[28:31]
    v_cvt_pk_bf16_f32 v73, v78, v79
    v_mul_f32 v40, v40, v44
    v_mfma_f32_16x16x32_bf16 v[16:19], v[184:187], v[56:59], v[16:19]
    ds_read_b128 v[48:51], v9 offset:7168
    v_fma_f32 v76, v76, v94, v94
    v_mfma_f32_16x16x32_bf16 v[20:23], v[188:191], v[56:59], v[20:23]
    buffer_load_dwordx4 v5, s[20:23], s53 offen offset:2048 lds
    v_rcp_f32 v76, v76
    v_mfma_f32_16x16x32_bf16 v[24:27], v[184:187], v[60:63], v[24:27]
    ds_read_b128 v[52:55], v9 offset:27648
    v_fmac_f32 v41, v92, v81
    v_mfma_f32_16x16x32_bf16 v[28:31], v[188:191], v[60:63], v[28:31]
    s_waitcnt lgkmcnt(4)
    buffer_load_dwordx4 a[64:67], v2, s[40:43], s50 offen offset:0
    v_mul_f32 v76, v40, v76
    v_mfma_f32_16x16x32_bf16 v[16:19], v[192:195], v[64:67], v[16:19]
    ds_read_b128 v[56:59], v8 offset:8192
    v_mul_f32 v77, v93, v41
    v_mfma_f32_16x16x32_bf16 v[20:23], v[196:199], v[64:67], v[20:23]
    v_exp_f32 v77, v77
    v_mfma_f32_16x16x32_bf16 v[24:27], v[192:195], v[68:71], v[24:27]
    ds_read_b128 v[60:63], v8 offset:28672
    v_fmac_f32 v45, v92, v85
    v_mfma_f32_16x16x32_bf16 v[28:31], v[196:199], v[68:71], v[28:31]
    buffer_load_dwordx4 v12, s[20:23], s53 offen offset:3072 lds
    v_mul_f32 v41, v41, v45
    v_mfma_f32_16x16x32_bf16 v[16:19], v[200:203], a[240:243], v[16:19]
    ds_read_b128 v[64:67], v9 offset:8192
    v_fma_f32 v77, v77, v94, v94
    v_mfma_f32_16x16x32_bf16 v[20:23], v[204:207], a[240:243], v[20:23]
    s_add_u32 m0, s56, 8192
    v_rcp_f32 v77, v77
    v_mfma_f32_16x16x32_bf16 v[24:27], v[200:203], a[244:247], v[24:27]
    ds_read_b128 v[68:71], v9 offset:28672
    v_mfma_f32_16x16x32_bf16 v[28:31], v[204:207], a[244:247], v[28:31]
    s_waitcnt lgkmcnt(4)
    v_fmac_f32 v42, v92, v82
    v_mul_f32 v77, v41, v77
    v_mfma_f32_16x16x32_bf16 v[16:19], v[208:211], a[248:251], v[16:19]
    s_add_u32 s53, s53, 512
    ds_read_b128 a[240:243], v8 offset:9216
    v_mul_f32 v78, v93, v42
    v_mfma_f32_16x16x32_bf16 v[20:23], v[212:215], a[248:251], v[20:23]
    v_exp_f32 v78, v78
    v_mfma_f32_16x16x32_bf16 v[24:27], v[208:211], a[252:255], v[24:27]
    ds_read_b128 a[244:247], v8 offset:29696
    v_fmac_f32 v46, v92, v86
    v_mfma_f32_16x16x32_bf16 v[28:31], v[212:215], a[252:255], v[28:31]
    buffer_load_dwordx4 a[68:71], v2, s[40:43], s50 offen offset:1024
    v_mfma_f32_16x16x32_bf16 v[16:19], v[216:219], v[48:51], v[16:19]
    ds_read_b128 a[248:251], v9 offset:9216
    v_cvt_pk_bf16_f32 v74, v76, v77
    v_mfma_f32_16x16x32_bf16 v[20:23], v[220:223], v[48:51], v[20:23]
    buffer_load_dwordx4 v3, s[20:23], s53 offen offset:0 lds
    v_mfma_f32_16x16x32_bf16 v[24:27], v[216:219], v[52:55], v[24:27]
    ds_read_b128 a[252:255], v9 offset:29696
    v_add_u32 v8, 0xffff6000, v8
    v_mfma_f32_16x16x32_bf16 v[28:31], v[220:223], v[52:55], v[28:31]
    s_waitcnt lgkmcnt(4)
    v_add_u32 v9, 0xffff6000, v9
    v_mul_f32 v42, v42, v46
    v_mfma_f32_16x16x32_bf16 v[16:19], v[224:227], v[56:59], v[16:19]
    buffer_load_dwordx4 a[72:75], v2, s[40:43], s50 offen offset:2048
    v_mfma_f32_16x16x32_bf16 v[20:23], v[228:231], v[56:59], v[20:23]
    s_waitcnt vmcnt(16) lgkmcnt(0)
    s_barrier
    v_fma_f32 v78, v78, v94, v94
    v_mfma_f32_16x16x32_bf16 v[24:27], v[224:227], v[60:63], v[24:27]
    ds_read_b128 v[48:51], v8 offset:0
    ds_read_b128 v[52:55], v8 offset:20480
    v_mfma_f32_16x16x32_bf16 v[28:31], v[228:231], v[60:63], v[28:31]
    buffer_load_dwordx4 v4, s[20:23], s53 offen offset:1024 lds
    v_rcp_f32 v78, v78
    v_mfma_f32_16x16x32_bf16 v[16:19], v[232:235], v[64:67], v[16:19]
    ds_read_b128 v[56:59], v9 offset:0
    v_fmac_f32 v43, v92, v83
    v_mfma_f32_16x16x32_bf16 v[20:23], v[236:239], v[64:67], v[20:23]
    s_add_u32 m0, s56, 81920
    buffer_store_dword v13, v11, s[28:31], s55 offen sc1
    v_mul_f32 v78, v42, v78
    v_mfma_f32_16x16x32_bf16 v[24:27], v[232:235], v[68:71], v[24:27]
    ds_read_b128 v[60:63], v9 offset:20480
    v_mul_f32 v79, v93, v43
    v_mfma_f32_16x16x32_bf16 v[28:31], v[236:239], v[68:71], v[28:31]
    v_exp_f32 v79, v79
    v_mfma_f32_16x16x32_bf16 v[16:19], v[240:243], a[240:243], v[16:19]
    s_add_u32 s55, s55, 49152
    s_add_u32 s53, s53, 244736
    ds_read_b128 v[64:67], v8 offset:1024
    v_mfma_f32_16x16x32_bf16 v[20:23], v[244:247], a[240:243], v[20:23]
    v_fmac_f32 v47, v92, v87
    v_mul_f32 v43, v43, v47
    v_mfma_f32_16x16x32_bf16 v[24:27], v[240:243], a[244:247], v[24:27]
    ds_read_b128 v[68:71], v8 offset:21504
    v_fma_f32 v79, v79, v94, v94
    v_mfma_f32_16x16x32_bf16 v[28:31], v[244:247], a[244:247], v[28:31]
    buffer_load_dwordx4 a[76:79], v2, s[40:43], s50 offen offset:3072
    v_mfma_f32_16x16x32_bf16 v[16:19], v[248:251], a[248:251], v[16:19]
    ds_read_b128 a[240:243], v9 offset:1024
    ds_read_b96 v[88:90], v0 offset:3072
    v_mfma_f32_16x16x32_bf16 v[20:23], v[252:255], a[248:251], v[20:23]
    s_add_u32 s50, s48, 20480
    v_rcp_f32 v79, v79
    v_mfma_f32_16x16x32_bf16 v[24:27], v[248:251], a[252:255], v[24:27]
    ds_read_b128 a[244:247], v9 offset:21504
    v_permlane16_swap_b32 v72, v74
    v_mfma_f32_16x16x32_bf16 v[28:31], v[252:255], a[252:255], v[28:31]
    s_waitcnt lgkmcnt(5)
    v_mul_f32 v79, v43, v79
    v_mfma_f32_16x16x32_bf16 v[32:35], v[96:99], v[48:51], 0
    ds_read_b128 a[248:251], v8 offset:2048
    v_cvt_pk_bf16_f32 v75, v78, v79
    v_mfma_f32_16x16x32_bf16 v[36:39], v[100:103], v[48:51], 0
    buffer_load_dwordx4 v3, s[20:23], s53 offen offset:0 lds
    v_mfma_f32_16x16x32_bf16 v[40:43], v[96:99], v[52:55], 0
    ds_read_b128 a[252:255], v8 offset:22528
    ds_read_b96 v[92:94], v0 offset:3328
    v_mfma_f32_16x16x32_bf16 v[44:47], v[100:103], v[52:55], 0
    v_mfma_f32_16x16x32_bf16 v[32:35], v[104:107], v[56:59], v[32:35]
    s_waitcnt lgkmcnt(4)
    ds_read_b128 v[48:51], v9 offset:2048
    v_permlane16_swap_b32 v73, v75
    v_mfma_f32_16x16x32_bf16 v[36:39], v[108:111], v[56:59], v[36:39]
    buffer_load_dwordx4 a[80:83], v2, s[40:43], s50 offen offset:0
    v_fmac_f32 v16, v88, v80
    v_mfma_f32_16x16x32_bf16 v[40:43], v[104:107], v[60:63], v[40:43]
    ds_read_b128 v[52:55], v9 offset:22528
    buffer_store_dwordx4 v[72:75], v10, s[24:27], s54 offen sc1
    v_mfma_f32_16x16x32_bf16 v[44:47], v[108:111], v[60:63], v[44:47]
    s_waitcnt lgkmcnt(5)
    buffer_load_dwordx4 v4, s[20:23], s53 offen offset:1024 lds
    v_mfma_f32_16x16x32_bf16 v[32:35], v[112:115], v[64:67], v[32:35]
    s_add_u32 s54, s54, 1155072
    ds_read_b128 v[56:59], v8 offset:3072
    v_mul_f32 v76, v89, v16
    v_mfma_f32_16x16x32_bf16 v[36:39], v[116:119], v[64:67], v[36:39]
    v_exp_f32 v76, v76
    v_mfma_f32_16x16x32_bf16 v[40:43], v[112:115], v[68:71], v[40:43]
    ds_read_b128 v[60:63], v8 offset:23552
    v_fmac_f32 v20, v88, v84
    v_mfma_f32_16x16x32_bf16 v[44:47], v[116:119], v[68:71], v[44:47]
    buffer_load_dwordx4 a[84:87], v2, s[40:43], s50 offen offset:1024
    v_mul_f32 v16, v16, v20
    v_mfma_f32_16x16x32_bf16 v[32:35], v[120:123], a[240:243], v[32:35]
    ds_read_b128 v[64:67], v9 offset:3072
    v_fma_f32 v76, v76, v90, v90
    v_mfma_f32_16x16x32_bf16 v[36:39], v[124:127], a[240:243], v[36:39]
    buffer_load_dwordx4 v5, s[20:23], s53 offen offset:2048 lds
    v_rcp_f32 v76, v76
    v_mfma_f32_16x16x32_bf16 v[40:43], v[120:123], a[244:247], v[40:43]
    ds_read_b128 v[68:71], v9 offset:23552
    v_fmac_f32 v17, v88, v81
    v_mfma_f32_16x16x32_bf16 v[44:47], v[124:127], a[244:247], v[44:47]
    s_waitcnt lgkmcnt(4)
    buffer_load_dwordx4 a[88:91], v2, s[40:43], s50 offen offset:2048
    v_mul_f32 v76, v16, v76
    v_mfma_f32_16x16x32_bf16 v[32:35], v[128:131], a[248:251], v[32:35]
    ds_read_b128 a[240:243], v8 offset:4096
    v_mul_f32 v77, v89, v17
    v_mfma_f32_16x16x32_bf16 v[36:39], v[132:135], a[248:251], v[36:39]
    v_exp_f32 v77, v77
    v_mfma_f32_16x16x32_bf16 v[40:43], v[128:131], a[252:255], v[40:43]
    ds_read_b128 a[244:247], v8 offset:24576
    v_fmac_f32 v21, v88, v85
    v_mfma_f32_16x16x32_bf16 v[44:47], v[132:135], a[252:255], v[44:47]
    buffer_load_dwordx4 v12, s[20:23], s53 offen offset:3072 lds
    v_mul_f32 v17, v17, v21
    v_mfma_f32_16x16x32_bf16 v[32:35], v[136:139], v[48:51], v[32:35]
    ds_read_b128 a[248:251], v9 offset:4096
    v_fma_f32 v77, v77, v90, v90
    v_mfma_f32_16x16x32_bf16 v[36:39], v[140:143], v[48:51], v[36:39]
    s_add_u32 m0, s56, 86016
    v_rcp_f32 v77, v77
    v_mfma_f32_16x16x32_bf16 v[40:43], v[136:139], v[52:55], v[40:43]
    ds_read_b128 a[252:255], v9 offset:24576
    v_fmac_f32 v18, v88, v82
    v_mfma_f32_16x16x32_bf16 v[44:47], v[140:143], v[52:55], v[44:47]
    s_waitcnt lgkmcnt(4)
    v_mul_f32 v77, v17, v77
    v_mfma_f32_16x16x32_bf16 v[32:35], v[144:147], v[56:59], v[32:35]
    s_add_u32 s53, s53, 512
    ds_read_b128 v[48:51], v8 offset:5120
    v_mul_f32 v78, v89, v18
    v_mfma_f32_16x16x32_bf16 v[36:39], v[148:151], v[56:59], v[36:39]
    v_exp_f32 v78, v78
    v_mfma_f32_16x16x32_bf16 v[40:43], v[144:147], v[60:63], v[40:43]
    ds_read_b128 v[52:55], v8 offset:25600
    v_fmac_f32 v22, v88, v86
    v_mfma_f32_16x16x32_bf16 v[44:47], v[148:151], v[60:63], v[44:47]
    buffer_load_dwordx4 a[92:95], v2, s[40:43], s50 offen offset:3072
    v_mfma_f32_16x16x32_bf16 v[32:35], v[152:155], v[64:67], v[32:35]
    ds_read_b128 v[56:59], v9 offset:5120
    v_cvt_pk_bf16_f32 v72, v76, v77
    v_mfma_f32_16x16x32_bf16 v[36:39], v[156:159], v[64:67], v[36:39]
    v_mul_f32 v18, v18, v22
    v_fma_f32 v78, v78, v90, v90
    v_mfma_f32_16x16x32_bf16 v[40:43], v[152:155], v[68:71], v[40:43]
    s_add_u32 s50, s48, 24576
    ds_read_b128 v[60:63], v9 offset:25600
    v_mfma_f32_16x16x32_bf16 v[44:47], v[156:159], v[68:71], v[44:47]
    s_waitcnt lgkmcnt(4)
    v_rcp_f32 v78, v78
    v_mfma_f32_16x16x32_bf16 v[32:35], v[160:163], a[240:243], v[32:35]
    ds_read_b128 v[64:67], v8 offset:6144
    v_fmac_f32 v19, v88, v83
    v_mfma_f32_16x16x32_bf16 v[36:39], v[164:167], a[240:243], v[36:39]
    buffer_load_dwordx4 v3, s[20:23], s53 offen offset:0 lds
    v_mfma_f32_16x16x32_bf16 v[40:43], v[160:163], a[244:247], v[40:43]
    ds_read_b128 v[68:71], v8 offset:26624
    v_mul_f32 v78, v18, v78
    v_mfma_f32_16x16x32_bf16 v[44:47], v[164:167], a[244:247], v[44:47]
    buffer_load_dwordx4 a[96:99], v2, s[40:43], s50 offen offset:0
    v_mfma_f32_16x16x32_bf16 v[32:35], v[168:171], a[248:251], v[32:35]
    ds_read_b128 a[240:243], v9 offset:6144
    v_mul_f32 v79, v89, v19
    v_mfma_f32_16x16x32_bf16 v[36:39], v[172:175], a[248:251], v[36:39]
    v_exp_f32 v79, v79
    v_mfma_f32_16x16x32_bf16 v[40:43], v[168:171], a[252:255], v[40:43]
    ds_read_b128 a[244:247], v9 offset:26624
    v_fmac_f32 v23, v88, v87
    v_mfma_f32_16x16x32_bf16 v[44:47], v[172:175], a[252:255], v[44:47]
    s_waitcnt lgkmcnt(4)
    buffer_load_dwordx4 v4, s[20:23], s53 offen offset:1024 lds
    v_mul_f32 v19, v19, v23
    v_mfma_f32_16x16x32_bf16 v[32:35], v[176:179], v[48:51], v[32:35]
    ds_read_b128 a[248:251], v8 offset:7168
    v_fma_f32 v79, v79, v90, v90
    v_mfma_f32_16x16x32_bf16 v[36:39], v[180:183], v[48:51], v[36:39]
    buffer_load_dwordx4 a[100:103], v2, s[40:43], s50 offen offset:1024
    v_rcp_f32 v79, v79
    v_mfma_f32_16x16x32_bf16 v[40:43], v[176:179], v[52:55], v[40:43]
    ds_read_b128 a[252:255], v8 offset:27648
    v_fmac_f32 v24, v92, v80
    v_mfma_f32_16x16x32_bf16 v[44:47], v[180:183], v[52:55], v[44:47]
    buffer_load_dwordx4 v5, s[20:23], s53 offen offset:2048 lds
    v_mul_f32 v79, v19, v79
    v_mfma_f32_16x16x32_bf16 v[32:35], v[184:187], v[56:59], v[32:35]
    ds_read_b128 v[48:51], v9 offset:7168
    v_mul_f32 v76, v93, v24
    v_mfma_f32_16x16x32_bf16 v[36:39], v[188:191], v[56:59], v[36:39]
    v_exp_f32 v76, v76
    v_mfma_f32_16x16x32_bf16 v[40:43], v[184:187], v[60:63], v[40:43]
    ds_read_b128 v[52:55], v9 offset:27648
    v_fmac_f32 v28, v92, v84
    v_mfma_f32_16x16x32_bf16 v[44:47], v[188:191], v[60:63], v[44:47]
    s_waitcnt lgkmcnt(4)
    buffer_load_dwordx4 a[104:107], v2, s[40:43], s50 offen offset:2048
    v_cvt_pk_bf16_f32 v73, v78, v79
    v_mfma_f32_16x16x32_bf16 v[32:35], v[192:195], v[64:67], v[32:35]
    ds_read_b128 v[56:59], v8 offset:8192
    v_mul_f32 v24, v24, v28
    v_mfma_f32_16x16x32_bf16 v[36:39], v[196:199], v[64:67], v[36:39]
    buffer_load_dwordx4 v12, s[20:23], s53 offen offset:3072 lds
    v_mfma_f32_16x16x32_bf16 v[40:43], v[192:195], v[68:71], v[40:43]
    ds_read_b128 v[60:63], v8 offset:28672
    v_fma_f32 v76, v76, v94, v94
    v_mfma_f32_16x16x32_bf16 v[44:47], v[196:199], v[68:71], v[44:47]
    v_rcp_f32 v76, v76
    v_mfma_f32_16x16x32_bf16 v[32:35], v[200:203], a[240:243], v[32:35]
    s_add_u32 m0, s56, 90112
    ds_read_b128 v[64:67], v9 offset:8192
    v_fmac_f32 v25, v92, v81
    v_mfma_f32_16x16x32_bf16 v[36:39], v[204:207], a[240:243], v[36:39]
    v_mul_f32 v76, v24, v76
    v_mul_f32 v77, v93, v25
    v_mfma_f32_16x16x32_bf16 v[40:43], v[200:203], a[244:247], v[40:43]
    ds_read_b128 v[68:71], v9 offset:28672
    v_exp_f32 v77, v77
    v_mfma_f32_16x16x32_bf16 v[44:47], v[204:207], a[244:247], v[44:47]
    s_add_u32 s53, s53, 512
    s_waitcnt lgkmcnt(4)
    v_fmac_f32 v29, v92, v85
    v_mfma_f32_16x16x32_bf16 v[32:35], v[208:211], a[248:251], v[32:35]
    ds_read_b128 a[240:243], v8 offset:9216
    v_mul_f32 v25, v25, v29
    v_mfma_f32_16x16x32_bf16 v[36:39], v[212:215], a[248:251], v[36:39]
    buffer_load_dwordx4 a[108:111], v2, s[40:43], s50 offen offset:3072
    v_fma_f32 v77, v77, v94, v94
    v_mfma_f32_16x16x32_bf16 v[40:43], v[208:211], a[252:255], v[40:43]
    ds_read_b128 a[244:247], v8 offset:29696
    v_rcp_f32 v77, v77
    v_mfma_f32_16x16x32_bf16 v[44:47], v[212:215], a[252:255], v[44:47]
    v_fmac_f32 v26, v92, v82
    v_mul_f32 v77, v25, v77
    v_mfma_f32_16x16x32_bf16 v[32:35], v[216:219], v[48:51], v[32:35]
    s_add_u32 s50, s48, 28672
    ds_read_b128 a[248:251], v9 offset:9216
    v_mul_f32 v78, v93, v26
    v_mfma_f32_16x16x32_bf16 v[36:39], v[220:223], v[48:51], v[36:39]
    v_exp_f32 v78, v78
    v_mfma_f32_16x16x32_bf16 v[40:43], v[216:219], v[52:55], v[40:43]
    ds_read_b128 a[252:255], v9 offset:29696
    v_add_u32 v8, 0xffff6000, v8
    v_mfma_f32_16x16x32_bf16 v[44:47], v[220:223], v[52:55], v[44:47]
    s_waitcnt lgkmcnt(4)
    v_add_u32 v9, 0xffff6000, v9
    v_fmac_f32 v30, v92, v86
    v_mfma_f32_16x16x32_bf16 v[32:35], v[224:227], v[56:59], v[32:35]
    buffer_load_dwordx4 v3, s[20:23], s53 offen offset:0 lds
    v_cvt_pk_bf16_f32 v74, v76, v77
    v_mfma_f32_16x16x32_bf16 v[36:39], v[228:231], v[56:59], v[36:39]
    s_waitcnt vmcnt(15) lgkmcnt(0)
    s_barrier
    v_mul_f32 v26, v26, v30
    v_mfma_f32_16x16x32_bf16 v[40:43], v[224:227], v[60:63], v[40:43]
    ds_read_b128 v[48:51], v8 offset:0
    ds_read_b128 v[52:55], v8 offset:20480
    v_mfma_f32_16x16x32_bf16 v[44:47], v[228:231], v[60:63], v[44:47]
    buffer_load_dwordx4 a[112:115], v2, s[40:43], s50 offen offset:0
    v_fma_f32 v78, v78, v94, v94
    v_mfma_f32_16x16x32_bf16 v[32:35], v[232:235], v[64:67], v[32:35]
    ds_read_b128 v[56:59], v9 offset:0
    v_rcp_f32 v78, v78
    v_mfma_f32_16x16x32_bf16 v[36:39], v[236:239], v[64:67], v[36:39]
    buffer_store_dword v13, v11, s[28:31], s55 offen sc1
    v_fmac_f32 v27, v92, v83
    v_mfma_f32_16x16x32_bf16 v[40:43], v[232:235], v[68:71], v[40:43]
    ds_read_b128 v[60:63], v9 offset:20480
    v_mul_f32 v78, v26, v78
    v_mfma_f32_16x16x32_bf16 v[44:47], v[236:239], v[68:71], v[44:47]
    buffer_load_dwordx4 v4, s[20:23], s53 offen offset:1024 lds
    v_mul_f32 v79, v93, v27
    v_mfma_f32_16x16x32_bf16 v[32:35], v[240:243], a[240:243], v[32:35]
    s_add_u32 s55, s55, 49152
    s_add_u32 m0, s56, 40960
    ds_read_b128 v[64:67], v8 offset:1024
    v_mfma_f32_16x16x32_bf16 v[36:39], v[244:247], a[240:243], v[36:39]
    v_exp_f32 v79, v79
    v_mfma_f32_16x16x32_bf16 v[40:43], v[240:243], a[244:247], v[40:43]
    s_add_u32 s53, s53, 244736
    ds_read_b128 v[68:71], v8 offset:21504
    v_fmac_f32 v31, v92, v87
    v_mfma_f32_16x16x32_bf16 v[44:47], v[244:247], a[244:247], v[44:47]
    v_mul_f32 v27, v27, v31
    v_fma_f32 v79, v79, v94, v94
    v_mfma_f32_16x16x32_bf16 v[32:35], v[248:251], a[248:251], v[32:35]
    ds_read_b128 a[240:243], v9 offset:1024
    ds_read_b96 v[88:90], v0 offset:3584
    v_mfma_f32_16x16x32_bf16 v[36:39], v[252:255], a[248:251], v[36:39]
    buffer_load_dwordx4 a[116:119], v2, s[40:43], s50 offen offset:1024
    v_mfma_f32_16x16x32_bf16 v[40:43], v[248:251], a[252:255], v[40:43]
    ds_read_b128 a[244:247], v9 offset:21504
    v_rcp_f32 v79, v79
    v_mfma_f32_16x16x32_bf16 v[44:47], v[252:255], a[252:255], v[44:47]
    s_waitcnt lgkmcnt(5)
    v_permlane16_swap_b32 v72, v74
    v_mul_f32 v79, v27, v79
    v_mfma_f32_16x16x32_bf16 v[16:19], v[96:99], v[48:51], 0
    ds_read_b128 a[248:251], v8 offset:2048
    v_cvt_pk_bf16_f32 v75, v78, v79
    v_mfma_f32_16x16x32_bf16 v[20:23], v[100:103], v[48:51], 0
    buffer_load_dwordx4 v3, s[20:23], s53 offen offset:0 lds
    v_mfma_f32_16x16x32_bf16 v[24:27], v[96:99], v[52:55], 0
    ds_read_b128 a[252:255], v8 offset:22528
    ds_read_b96 v[92:94], v0 offset:3840
    v_mfma_f32_16x16x32_bf16 v[28:31], v[100:103], v[52:55], 0
    v_mfma_f32_16x16x32_bf16 v[16:19], v[104:107], v[56:59], v[16:19]
    s_waitcnt lgkmcnt(4)
    ds_read_b128 v[48:51], v9 offset:2048
    v_permlane16_swap_b32 v73, v75
    v_mfma_f32_16x16x32_bf16 v[20:23], v[108:111], v[56:59], v[20:23]
    buffer_load_dwordx4 a[120:123], v2, s[40:43], s50 offen offset:2048
    v_fmac_f32 v32, v88, v80
    v_mfma_f32_16x16x32_bf16 v[24:27], v[104:107], v[60:63], v[24:27]
    ds_read_b128 v[52:55], v9 offset:22528
    buffer_store_dwordx4 v[72:75], v10, s[24:27], s54 offen sc1
    v_mfma_f32_16x16x32_bf16 v[28:31], v[108:111], v[60:63], v[28:31]
    s_waitcnt lgkmcnt(5)
    buffer_load_dwordx4 v4, s[20:23], s53 offen offset:1024 lds
    v_mfma_f32_16x16x32_bf16 v[16:19], v[112:115], v[64:67], v[16:19]
    s_add_u32 s54, s54, 1155072
    ds_read_b128 v[56:59], v8 offset:3072
    v_mul_f32 v76, v89, v32
    v_mfma_f32_16x16x32_bf16 v[20:23], v[116:119], v[64:67], v[20:23]
    buffer_load_dwordx4 a[124:127], v2, s[40:43], s50 offen offset:3072
    v_mfma_f32_16x16x32_bf16 v[24:27], v[112:115], v[68:71], v[24:27]
    ds_read_b128 v[60:63], v8 offset:23552
    v_exp_f32 v76, v76
    v_mfma_f32_16x16x32_bf16 v[28:31], v[116:119], v[68:71], v[28:31]
    v_fmac_f32 v36, v88, v84
    v_mul_f32 v32, v32, v36
    v_mfma_f32_16x16x32_bf16 v[16:19], v[120:123], a[240:243], v[16:19]
    ds_read_b128 v[64:67], v9 offset:3072
    v_fma_f32 v76, v76, v90, v90
    v_mfma_f32_16x16x32_bf16 v[20:23], v[124:127], a[240:243], v[20:23]
    s_add_u32 s50, s48, 32768
    v_rcp_f32 v76, v76
    v_mfma_f32_16x16x32_bf16 v[24:27], v[120:123], a[244:247], v[24:27]
    ds_read_b128 v[68:71], v9 offset:23552
    v_fmac_f32 v33, v88, v81
    v_mfma_f32_16x16x32_bf16 v[28:31], v[124:127], a[244:247], v[28:31]
    s_waitcnt lgkmcnt(4)
    buffer_load_dwordx4 v5, s[20:23], s53 offen offset:2048 lds
    v_mul_f32 v76, v32, v76
    v_mfma_f32_16x16x32_bf16 v[16:19], v[128:131], a[248:251], v[16:19]
    ds_read_b128 a[240:243], v8 offset:4096
    v_mul_f32 v77, v89, v33
    v_mfma_f32_16x16x32_bf16 v[20:23], v[132:135], a[248:251], v[20:23]
    buffer_load_dwordx4 a[128:131], v2, s[40:43], s50 offen offset:0
    v_exp_f32 v77, v77
    v_mfma_f32_16x16x32_bf16 v[24:27], v[128:131], a[252:255], v[24:27]
    ds_read_b128 a[244:247], v8 offset:24576
    v_fmac_f32 v37, v88, v85
    v_mfma_f32_16x16x32_bf16 v[28:31], v[132:135], a[252:255], v[28:31]
    v_mul_f32 v33, v33, v37
    v_fma_f32 v77, v77, v90, v90
    v_mfma_f32_16x16x32_bf16 v[16:19], v[136:139], v[48:51], v[16:19]
    ds_read_b128 a[248:251], v9 offset:4096
    v_rcp_f32 v77, v77
    v_mfma_f32_16x16x32_bf16 v[20:23], v[140:143], v[48:51], v[20:23]
    buffer_load_dwordx4 v12, s[20:23], s53 offen offset:3072 lds
    v_mfma_f32_16x16x32_bf16 v[24:27], v[136:139], v[52:55], v[24:27]
    ds_read_b128 a[252:255], v9 offset:24576
    v_fmac_f32 v34, v88, v82
    v_mfma_f32_16x16x32_bf16 v[28:31], v[140:143], v[52:55], v[28:31]
    s_add_u32 m0, s56, 45056
    s_waitcnt lgkmcnt(4)
    v_mul_f32 v77, v33, v77
    v_mfma_f32_16x16x32_bf16 v[16:19], v[144:147], v[56:59], v[16:19]
    ds_read_b128 v[48:51], v8 offset:5120
    v_mul_f32 v78, v89, v34
    v_mfma_f32_16x16x32_bf16 v[20:23], v[148:151], v[56:59], v[20:23]
    v_exp_f32 v78, v78
    v_mfma_f32_16x16x32_bf16 v[24:27], v[144:147], v[60:63], v[24:27]
    s_add_u32 s53, s53, 512
    ds_read_b128 v[52:55], v8 offset:25600
    v_fmac_f32 v38, v88, v86
    v_mfma_f32_16x16x32_bf16 v[28:31], v[148:151], v[60:63], v[28:31]
    v_cvt_pk_bf16_f32 v72, v76, v77
    v_mul_f32 v34, v34, v38
    v_mfma_f32_16x16x32_bf16 v[16:19], v[152:155], v[64:67], v[16:19]
    ds_read_b128 v[56:59], v9 offset:5120
    v_fma_f32 v78, v78, v90, v90
    v_mfma_f32_16x16x32_bf16 v[20:23], v[156:159], v[64:67], v[20:23]
    buffer_load_dwordx4 a[132:135], v2, s[40:43], s50 offen offset:1024
    v_rcp_f32 v78, v78
    v_mfma_f32_16x16x32_bf16 v[24:27], v[152:155], v[68:71], v[24:27]
    ds_read_b128 v[60:63], v9 offset:25600
    v_fmac_f32 v35, v88, v83
    v_mfma_f32_16x16x32_bf16 v[28:31], v[156:159], v[68:71], v[28:31]
    s_waitcnt lgkmcnt(4)
    buffer_load_dwordx4 v3, s[20:23], s53 offen offset:0 lds
    v_mul_f32 v78, v34, v78
    v_mfma_f32_16x16x32_bf16 v[16:19], v[160:163], a[240:243], v[16:19]
    ds_read_b128 v[64:67], v8 offset:6144
    v_mul_f32 v79, v89, v35
    v_mfma_f32_16x16x32_bf16 v[20:23], v[164:167], a[240:243], v[20:23]
    v_exp_f32 v79, v79
    v_mfma_f32_16x16x32_bf16 v[24:27], v[160:163], a[244:247], v[24:27]
    ds_read_b128 v[68:71], v8 offset:26624
    v_fmac_f32 v39, v88, v87
    v_mfma_f32_16x16x32_bf16 v[28:31], v[164:167], a[244:247], v[28:31]
    buffer_load_dwordx4 a[136:139], v2, s[40:43], s50 offen offset:2048
    v_mul_f32 v35, v35, v39
    v_mfma_f32_16x16x32_bf16 v[16:19], v[168:171], a[248:251], v[16:19]
    ds_read_b128 a[240:243], v9 offset:6144
    v_fma_f32 v79, v79, v90, v90
    v_mfma_f32_16x16x32_bf16 v[20:23], v[172:175], a[248:251], v[20:23]
    buffer_load_dwordx4 v4, s[20:23], s53 offen offset:1024 lds
    v_rcp_f32 v79, v79
    v_mfma_f32_16x16x32_bf16 v[24:27], v[168:171], a[252:255], v[24:27]
    ds_read_b128 a[244:247], v9 offset:26624
    v_fmac_f32 v40, v92, v80
    v_mfma_f32_16x16x32_bf16 v[28:31], v[172:175], a[252:255], v[28:31]
    s_waitcnt lgkmcnt(4)
    buffer_load_dwordx4 a[140:143], v2, s[40:43], s50 offen offset:3072
    v_mul_f32 v79, v35, v79
    v_mfma_f32_16x16x32_bf16 v[16:19], v[176:179], v[48:51], v[16:19]
    ds_read_b128 a[248:251], v8 offset:7168
    v_mul_f32 v76, v93, v40
    v_mfma_f32_16x16x32_bf16 v[20:23], v[180:183], v[48:51], v[20:23]
    v_exp_f32 v76, v76
    v_mfma_f32_16x16x32_bf16 v[24:27], v[176:179], v[52:55], v[24:27]
    s_add_u32 s50, s48, 36864
    ds_read_b128 a[252:255], v8 offset:27648
    v_fmac_f32 v44, v92, v84
    v_mfma_f32_16x16x32_bf16 v[28:31], v[180:183], v[52:55], v[28:31]
    v_cvt_pk_bf16_f32 v73, v78, v79
    v_mul_f32 v40, v40, v44
    v_mfma_f32_16x16x32_bf16 v[16:19], v[184:187], v[56:59], v[16:19]
    ds_read_b128 v[48:51], v9 offset:7168
    v_fma_f32 v76, v76, v94, v94
    v_mfma_f32_16x16x32_bf16 v[20:23], v[188:191], v[56:59], v[20:23]
    buffer_load_dwordx4 v5, s[20:23], s53 offen offset:2048 lds
    v_rcp_f32 v76, v76
    v_mfma_f32_16x16x32_bf16 v[24:27], v[184:187], v[60:63], v[24:27]
    ds_read_b128 v[52:55], v9 offset:27648
L_chain7:
L_hk2944:
    s_cbranch_execz L_hk7079
    v_fmac_f32 v41, v92, v81
    v_mfma_f32_16x16x32_bf16 v[28:31], v[188:191], v[60:63], v[28:31]
    s_waitcnt lgkmcnt(4)
    buffer_load_dwordx4 a[144:147], v2, s[40:43], s50 offen offset:0
    v_mul_f32 v76, v40, v76
    v_mfma_f32_16x16x32_bf16 v[16:19], v[192:195], v[64:67], v[16:19]
    ds_read_b128 v[56:59], v8 offset:8192
    v_mul_f32 v77, v93, v41
    v_mfma_f32_16x16x32_bf16 v[20:23], v[196:199], v[64:67], v[20:23]
    v_exp_f32 v77, v77
    v_mfma_f32_16x16x32_bf16 v[24:27], v[192:195], v[68:71], v[24:27]
    ds_read_b128 v[60:63], v8 offset:28672
    v_fmac_f32 v45, v92, v85
    v_mfma_f32_16x16x32_bf16 v[28:31], v[196:199], v[68:71], v[28:31]
    buffer_load_dwordx4 v12, s[20:23], s53 offen offset:3072 lds
    v_mul_f32 v41, v41, v45
    v_mfma_f32_16x16x32_bf16 v[16:19], v[200:203], a[240:243], v[16:19]
    ds_read_b128 v[64:67], v9 offset:8192
    v_fma_f32 v77, v77, v94, v94
    v_mfma_f32_16x16x32_bf16 v[20:23], v[204:207], a[240:243], v[20:23]
    s_add_u32 m0, s56, 49152
    v_rcp_f32 v77, v77
    v_mfma_f32_16x16x32_bf16 v[24:27], v[200:203], a[244:247], v[24:27]
    ds_read_b128 v[68:71], v9 offset:28672
    v_mfma_f32_16x16x32_bf16 v[28:31], v[204:207], a[244:247], v[28:31]
    s_waitcnt lgkmcnt(4)
    v_fmac_f32 v42, v92, v82
    v_mul_f32 v77, v41, v77
    v_mfma_f32_16x16x32_bf16 v[16:19], v[208:211], a[248:251], v[16:19]
    s_add_u32 s53, s53, 512
    ds_read_b128 a[240:243], v8 offset:9216
    v_mul_f32 v78, v93, v42
    v_mfma_f32_16x16x32_bf16 v[20:23], v[212:215], a[248:251], v[20:23]
    v_exp_f32 v78, v78
    v_mfma_f32_16x16x32_bf16 v[24:27], v[208:211], a[252:255], v[24:27]
    ds_read_b128 a[244:247], v8 offset:29696
    v_fmac_f32 v46, v92, v86
    v_mfma_f32_16x16x32_bf16 v[28:31], v[212:215], a[252:255], v[28:31]
    buffer_load_dwordx4 a[148:151], v2, s[40:43], s50 offen offset:1024
    v_mfma_f32_16x16x32_bf16 v[16:19], v[216:219], v[48:51], v[16:19]
    ds_read_b128 a[248:251], v9 offset:9216
    v_cvt_pk_bf16_f32 v74, v76, v77
    v_mfma_f32_16x16x32_bf16 v[20:23], v[220:223], v[48:51], v[20:23]
    buffer_load_dwordx4 v3, s[20:23], s53 offen offset:0 lds
    v_mfma_f32_16x16x32_bf16 v[24:27], v[216:219], v[52:55], v[24:27]
    ds_read_b128 a[252:255], v9 offset:29696
    v_add_u32 v8, 0x14000, v8
    v_mfma_f32_16x16x32_bf16 v[28:31], v[220:223], v[52:55], v[28:31]
    s_waitcnt lgkmcnt(4)
    v_add_u32 v9, 0x14000, v9
    v_mul_f32 v42, v42, v46
    v_mfma_f32_16x16x32_bf16 v[16:19], v[224:227], v[56:59], v[16:19]
    buffer_load_dwordx4 a[152:155], v2, s[40:43], s50 offen offset:2048
    v_mfma_f32_16x16x32_bf16 v[20:23], v[228:231], v[56:59], v[20:23]
    s_waitcnt vmcnt(16) lgkmcnt(0)
    s_barrier
    v_fma_f32 v78, v78, v94, v94
    v_mfma_f32_16x16x32_bf16 v[24:27], v[224:227], v[60:63], v[24:27]
    ds_read_b128 v[48:51], v8 offset:0
    ds_read_b128 v[52:55], v8 offset:20480
    v_mfma_f32_16x16x32_bf16 v[28:31], v[228:231], v[60:63], v[28:31]
    buffer_load_dwordx4 v4, s[20:23], s53 offen offset:1024 lds
    v_rcp_f32 v78, v78
    v_mfma_f32_16x16x32_bf16 v[16:19], v[232:235], v[64:67], v[16:19]
    ds_read_b128 v[56:59], v9 offset:0
    v_fmac_f32 v43, v92, v83
    v_mfma_f32_16x16x32_bf16 v[20:23], v[236:239], v[64:67], v[20:23]
    s_add_u32 m0, s56, 0
    buffer_store_dword v13, v11, s[28:31], s55 offen sc1
    v_mul_f32 v78, v42, v78
    v_mfma_f32_16x16x32_bf16 v[24:27], v[232:235], v[68:71], v[24:27]
    ds_read_b128 v[60:63], v9 offset:20480
    v_mul_f32 v79, v93, v43
    v_mfma_f32_16x16x32_bf16 v[28:31], v[236:239], v[68:71], v[28:31]
    v_exp_f32 v79, v79
    v_mfma_f32_16x16x32_bf16 v[16:19], v[240:243], a[240:243], v[16:19]
    s_add_u32 s55, s55, 49152
    s_add_u32 s53, s53, 244736
    ds_read_b128 v[64:67], v8 offset:1024
    v_mfma_f32_16x16x32_bf16 v[20:23], v[244:247], a[240:243], v[20:23]
    v_fmac_f32 v47, v92, v87
    v_mul_f32 v43, v43, v47
    v_mfma_f32_16x16x32_bf16 v[24:27], v[240:243], a[244:247], v[24:27]
    ds_read_b128 v[68:71], v8 offset:21504
    v_fma_f32 v79, v79, v94, v94
    v_mfma_f32_16x16x32_bf16 v[28:31], v[244:247], a[244:247], v[28:31]
    buffer_load_dwordx4 a[156:159], v2, s[40:43], s50 offen offset:3072
    v_mfma_f32_16x16x32_bf16 v[16:19], v[248:251], a[248:251], v[16:19]
    ds_read_b128 a[240:243], v9 offset:1024
    ds_read_b96 v[88:90], v0 offset:4096
    v_mfma_f32_16x16x32_bf16 v[20:23], v[252:255], a[248:251], v[20:23]
    s_add_u32 s50, s48, 40960
    v_rcp_f32 v79, v79
    v_mfma_f32_16x16x32_bf16 v[24:27], v[248:251], a[252:255], v[24:27]
    ds_read_b128 a[244:247], v9 offset:21504
    v_permlane16_swap_b32 v72, v74
    v_mfma_f32_16x16x32_bf16 v[28:31], v[252:255], a[252:255], v[28:31]
    s_waitcnt lgkmcnt(5)
    v_mul_f32 v79, v43, v79
    v_mfma_f32_16x16x32_bf16 v[32:35], v[96:99], v[48:51], 0
    ds_read_b128 a[248:251], v8 offset:2048
    v_mfma_f32_16x16x32_bf16 v[36:39], v[100:103], v[48:51], 0
    v_cvt_pk_bf16_f32 v75, v78, v79
    v_mfma_f32_16x16x32_bf16 v[40:43], v[96:99], v[52:55], 0
    ds_read_b128 a[252:255], v8 offset:22528
    ds_read_b96 v[92:94], v0 offset:4352
    v_mfma_f32_16x16x32_bf16 v[44:47], v[100:103], v[52:55], 0
    buffer_load_dwordx4 a[160:163], v2, s[40:43], s50 offen offset:0
    v_mfma_f32_16x16x32_bf16 v[32:35], v[104:107], v[56:59], v[32:35]
    s_waitcnt lgkmcnt(4)
    ds_read_b128 v[48:51], v9 offset:2048
    v_permlane16_swap_b32 v73, v75
    v_mfma_f32_16x16x32_bf16 v[36:39], v[108:111], v[56:59], v[36:39]
    buffer_store_dwordx4 v[72:75], v10, s[24:27], s54 offen sc1
    v_mfma_f32_16x16x32_bf16 v[40:43], v[104:107], v[60:63], v[40:43]
    ds_read_b128 v[52:55], v9 offset:22528
    v_fmac_f32 v16, v88, v80
    v_mfma_f32_16x16x32_bf16 v[44:47], v[108:111], v[60:63], v[44:47]
    s_waitcnt lgkmcnt(5)
    buffer_load_dwordx4 a[164:167], v2, s[40:43], s50 offen offset:1024
    v_mfma_f32_16x16x32_bf16 v[32:35], v[112:115], v[64:67], v[32:35]
    s_add_u32 s54, s54, 1155072
    ds_read_b128 v[56:59], v8 offset:3072
    v_mul_f32 v76, v89, v16
    v_mfma_f32_16x16x32_bf16 v[36:39], v[116:119], v[64:67], v[36:39]
    buffer_load_dwordx4 a[168:171], v2, s[40:43], s50 offen offset:2048
    v_mfma_f32_16x16x32_bf16 v[40:43], v[112:115], v[68:71], v[40:43]
    ds_read_b128 v[60:63], v8 offset:23552
    v_mfma_f32_16x16x32_bf16 v[44:47], v[116:119], v[68:71], v[44:47]
    v_exp_f32 v76, v76
    v_mfma_f32_16x16x32_bf16 v[32:35], v[120:123], a[240:243], v[32:35]
    ds_read_b128 v[64:67], v9 offset:3072
    v_fmac_f32 v20, v88, v84
    v_mfma_f32_16x16x32_bf16 v[36:39], v[124:127], a[240:243], v[36:39]
    buffer_load_dwordx4 a[172:175], v2, s[40:43], s50 offen offset:3072
    v_mul_f32 v16, v16, v20
    v_mfma_f32_16x16x32_bf16 v[40:43], v[120:123], a[244:247], v[40:43]
    ds_read_b128 v[68:71], v9 offset:23552
    v_fma_f32 v76, v76, v90, v90
    v_mfma_f32_16x16x32_bf16 v[44:47], v[124:127], a[244:247], v[44:47]
    s_waitcnt lgkmcnt(4)
    v_rcp_f32 v76, v76
    v_mfma_f32_16x16x32_bf16 v[32:35], v[128:131], a[248:251], v[32:35]
    ds_read_b128 a[240:243], v8 offset:4096
    v_fmac_f32 v17, v88, v81
    v_mfma_f32_16x16x32_bf16 v[36:39], v[132:135], a[248:251], v[36:39]
    s_add_u32 s50, s48, 45056
    v_mul_f32 v76, v16, v76
    v_mul_f32 v77, v89, v17
    v_mfma_f32_16x16x32_bf16 v[40:43], v[128:131], a[252:255], v[40:43]
    ds_read_b128 a[244:247], v8 offset:24576
    v_mfma_f32_16x16x32_bf16 v[44:47], v[132:135], a[252:255], v[44:47]
    v_exp_f32 v77, v77
    v_mfma_f32_16x16x32_bf16 v[32:35], v[136:139], v[48:51], v[32:35]
    ds_read_b128 a[248:251], v9 offset:4096
    v_fmac_f32 v21, v88, v85
    v_mfma_f32_16x16x32_bf16 v[36:39], v[140:143], v[48:51], v[36:39]
    buffer_load_dwordx4 a[176:179], v2, s[40:43], s50 offen offset:0
    v_mul_f32 v17, v17, v21
    v_mfma_f32_16x16x32_bf16 v[40:43], v[136:139], v[52:55], v[40:43]
    ds_read_b128 a[252:255], v9 offset:24576
    v_fma_f32 v77, v77, v90, v90
    v_mfma_f32_16x16x32_bf16 v[44:47], v[140:143], v[52:55], v[44:47]
    s_waitcnt lgkmcnt(4)
    v_rcp_f32 v77, v77
    v_mfma_f32_16x16x32_bf16 v[32:35], v[144:147], v[56:59], v[32:35]
    ds_read_b128 v[48:51], v8 offset:5120
    v_fmac_f32 v18, v88, v82
    v_mfma_f32_16x16x32_bf16 v[36:39], v[148:151], v[56:59], v[36:39]
    buffer_load_dwordx4 a[180:183], v2, s[40:43], s50 offen offset:1024
    v_mul_f32 v77, v17, v77
    v_mfma_f32_16x16x32_bf16 v[40:43], v[144:147], v[60:63], v[40:43]
    ds_read_b128 v[52:55], v8 offset:25600
    v_mul_f32 v78, v89, v18
    v_mfma_f32_16x16x32_bf16 v[44:47], v[148:151], v[60:63], v[44:47]
    v_exp_f32 v78, v78
    v_mfma_f32_16x16x32_bf16 v[32:35], v[152:155], v[64:67], v[32:35]
    ds_read_b128 v[56:59], v9 offset:5120
    v_fmac_f32 v22, v88, v86
    v_mfma_f32_16x16x32_bf16 v[36:39], v[156:159], v[64:67], v[36:39]
    buffer_load_dwordx4 a[184:187], v2, s[40:43], s50 offen offset:2048
    v_mfma_f32_16x16x32_bf16 v[40:43], v[152:155], v[68:71], v[40:43]
    ds_read_b128 v[60:63], v9 offset:25600
    v_cvt_pk_bf16_f32 v72, v76, v77
    v_mfma_f32_16x16x32_bf16 v[44:47], v[156:159], v[68:71], v[44:47]
    s_waitcnt lgkmcnt(4)
    v_mul_f32 v18, v18, v22
    v_fma_f32 v78, v78, v90, v90
    v_mfma_f32_16x16x32_bf16 v[32:35], v[160:163], a[240:243], v[32:35]
    ds_read_b128 v[64:67], v8 offset:6144
    v_rcp_f32 v78, v78
    v_mfma_f32_16x16x32_bf16 v[36:39], v[164:167], a[240:243], v[36:39]
    buffer_load_dwordx4 a[188:191], v2, s[40:43], s50 offen offset:3072
    v_mfma_f32_16x16x32_bf16 v[40:43], v[160:163], a[244:247], v[40:43]
    ds_read_b128 v[68:71], v8 offset:26624
    v_fmac_f32 v19, v88, v83
    v_mfma_f32_16x16x32_bf16 v[44:47], v[164:167], a[244:247], v[44:47]
    v_mul_f32 v78, v18, v78
    v_mul_f32 v79, v89, v19
    v_mfma_f32_16x16x32_bf16 v[32:35], v[168:171], a[248:251], v[32:35]
    s_add_u32 s50, s48, 49152
    ds_read_b128 a[240:243], v9 offset:6144
    v_mfma_f32_16x16x32_bf16 v[36:39], v[172:175], a[248:251], v[36:39]
    v_exp_f32 v79, v79
    v_mfma_f32_16x16x32_bf16 v[40:43], v[168:171], a[252:255], v[40:43]
    ds_read_b128 a[244:247], v9 offset:26624
    v_fmac_f32 v23, v88, v87
    v_mfma_f32_16x16x32_bf16 v[44:47], v[172:175], a[252:255], v[44:47]
    s_waitcnt lgkmcnt(4)
    buffer_load_dwordx4 a[192:195], v2, s[40:43], s50 offen offset:0
    v_mul_f32 v19, v19, v23
    v_mfma_f32_16x16x32_bf16 v[32:35], v[176:179], v[48:51], v[32:35]
    ds_read_b128 a[248:251], v8 offset:7168
    v_fma_f32 v79, v79, v90, v90
    v_mfma_f32_16x16x32_bf16 v[36:39], v[180:183], v[48:51], v[36:39]
    v_rcp_f32 v79, v79
    v_mfma_f32_16x16x32_bf16 v[40:43], v[176:179], v[52:55], v[40:43]
    ds_read_b128 a[252:255], v8 offset:27648
    v_fmac_f32 v24, v92, v80
    v_mfma_f32_16x16x32_bf16 v[44:47], v[180:183], v[52:55], v[44:47]
    buffer_load_dwordx4 a[196:199], v2, s[40:43], s50 offen offset:1024
    v_mul_f32 v79, v19, v79
    v_mfma_f32_16x16x32_bf16 v[32:35], v[184:187], v[56:59], v[32:35]
    ds_read_b128 v[48:51], v9 offset:7168
    v_mul_f32 v76, v93, v24
    v_mfma_f32_16x16x32_bf16 v[36:39], v[188:191], v[56:59], v[36:39]
    v_exp_f32 v76, v76
    v_fmac_f32 v28, v92, v84
    v_mfma_f32_16x16x32_bf16 v[40:43], v[184:187], v[60:63], v[40:43]
    ds_read_b128 v[52:55], v9 offset:27648
    v_cvt_pk_bf16_f32 v73, v78, v79
    v_mfma_f32_16x16x32_bf16 v[44:47], v[188:191], v[60:63], v[44:47]
    s_add_u32 s50, s49, 0
    s_waitcnt lgkmcnt(4)
    v_mul_f32 v24, v24, v28
    v_mfma_f32_16x16x32_bf16 v[32:35], v[192:195], v[64:67], v[32:35]
    ds_read_b128 v[56:59], v8 offset:8192
    v_fma_f32 v76, v76, v94, v94
    v_mfma_f32_16x16x32_bf16 v[36:39], v[196:199], v[64:67], v[36:39]
    v_rcp_f32 v76, v76
    v_mfma_f32_16x16x32_bf16 v[40:43], v[192:195], v[68:71], v[40:43]
    ds_read_b128 v[60:63], v8 offset:28672
    v_fmac_f32 v25, v92, v81
    v_mfma_f32_16x16x32_bf16 v[44:47], v[196:199], v[68:71], v[44:47]
    buffer_load_dwordx4 a[200:203], v2, s[40:43], s50 offen offset:0
    v_mul_f32 v76, v24, v76
    v_mfma_f32_16x16x32_bf16 v[32:35], v[200:203], a[240:243], v[32:35]
    ds_read_b128 v[64:67], v9 offset:8192
    v_mul_f32 v77, v93, v25
    v_mfma_f32_16x16x32_bf16 v[36:39], v[204:207], a[240:243], v[36:39]
    v_exp_f32 v77, v77
    v_mfma_f32_16x16x32_bf16 v[40:43], v[200:203], a[244:247], v[40:43]
    ds_read_b128 v[68:71], v9 offset:28672
    v_fmac_f32 v29, v92, v85
    v_mfma_f32_16x16x32_bf16 v[44:47], v[204:207], a[244:247], v[44:47]
    s_waitcnt lgkmcnt(4)
    buffer_load_dwordx4 a[204:207], v2, s[40:43], s50 offen offset:1024
    v_mul_f32 v25, v25, v29
    v_mfma_f32_16x16x32_bf16 v[32:35], v[208:211], a[248:251], v[32:35]
    ds_read_b128 a[240:243], v8 offset:9216
    v_fma_f32 v77, v77, v94, v94
    v_mfma_f32_16x16x32_bf16 v[36:39], v[212:215], a[248:251], v[36:39]
    v_rcp_f32 v77, v77
    v_mfma_f32_16x16x32_bf16 v[40:43], v[208:211], a[252:255], v[40:43]
    ds_read_b128 a[244:247], v8 offset:29696
    v_fmac_f32 v26, v92, v82
    v_mfma_f32_16x16x32_bf16 v[44:47], v[212:215], a[252:255], v[44:47]
    buffer_load_dwordx4 a[208:211], v2, s[40:43], s50 offen offset:2048
    v_mfma_f32_16x16x32_bf16 v[32:35], v[216:219], v[48:51], v[32:35]
    ds_read_b128 a[248:251], v9 offset:9216
    v_mul_f32 v77, v25, v77
    v_mfma_f32_16x16x32_bf16 v[36:39], v[220:223], v[48:51], v[36:39]
    buffer_load_dwordx4 a[212:215], v2, s[40:43], s50 offen offset:3072
    v_mfma_f32_16x16x32_bf16 v[40:43], v[216:219], v[52:55], v[40:43]
    ds_read_b128 a[252:255], v9 offset:29696
    v_add_u32 v8, 0xffff6000, v8
    v_mfma_f32_16x16x32_bf16 v[44:47], v[220:223], v[52:55], v[44:47]
    s_waitcnt lgkmcnt(4)
    v_add_u32 v9, 0xffff6000, v9
    v_mul_f32 v78, v93, v26
    v_mfma_f32_16x16x32_bf16 v[32:35], v[224:227], v[56:59], v[32:35]
    v_exp_f32 v78, v78
    v_mfma_f32_16x16x32_bf16 v[36:39], v[228:231], v[56:59], v[36:39]
    s_waitcnt vmcnt(13) lgkmcnt(0)
    s_barrier
    v_fmac_f32 v30, v92, v86
    v_mfma_f32_16x16x32_bf16 v[40:43], v[224:227], v[60:63], v[40:43]
    s_add_u32 s50, s49, 4096
    ds_read_b128 v[48:51], v8 offset:0
    ds_read_b128 v[52:55], v8 offset:20480
    v_mfma_f32_16x16x32_bf16 v[44:47], v[228:231], v[60:63], v[44:47]
    v_cvt_pk_bf16_f32 v74, v76, v77
    v_mul_f32 v26, v26, v30
    v_mfma_f32_16x16x32_bf16 v[32:35], v[232:235], v[64:67], v[32:35]
    ds_read_b128 v[56:59], v9 offset:0
    v_fma_f32 v78, v78, v94, v94
    v_mfma_f32_16x16x32_bf16 v[36:39], v[236:239], v[64:67], v[36:39]
    buffer_store_dword v13, v11, s[28:31], s55 offen sc1
    v_rcp_f32 v78, v78
    v_mfma_f32_16x16x32_bf16 v[40:43], v[232:235], v[68:71], v[40:43]
    ds_read_b128 v[60:63], v9 offset:20480
    v_fmac_f32 v27, v92, v83
    v_mfma_f32_16x16x32_bf16 v[44:47], v[236:239], v[68:71], v[44:47]
    buffer_load_dwordx4 a[216:219], v2, s[40:43], s50 offen offset:0
    v_mul_f32 v78, v26, v78
    v_mfma_f32_16x16x32_bf16 v[32:35], v[240:243], a[240:243], v[32:35]
    s_add_u32 s55, s55, 49152
    ds_read_b128 v[64:67], v8 offset:1024
    v_mul_f32 v79, v93, v27
    v_mfma_f32_16x16x32_bf16 v[36:39], v[244:247], a[240:243], v[36:39]
    s_add_u32 s50, s84, 0
    v_exp_f32 v79, v79
    v_mfma_f32_16x16x32_bf16 v[40:43], v[240:243], a[244:247], v[40:43]
    ds_read_b128 v[68:71], v8 offset:21504
    v_fmac_f32 v31, v92, v87
    v_mfma_f32_16x16x32_bf16 v[44:47], v[244:247], a[244:247], v[44:47]
    v_mul_f32 v27, v27, v31
    v_fma_f32 v79, v79, v94, v94
    v_mfma_f32_16x16x32_bf16 v[32:35], v[248:251], a[248:251], v[32:35]
    ds_read_b128 a[240:243], v9 offset:1024
    ds_read_b96 v[88:90], v0 offset:4608
    v_mfma_f32_16x16x32_bf16 v[36:39], v[252:255], a[248:251], v[36:39]
    buffer_load_dwordx4 a[220:223], v2, s[40:43], s50 offen offset:0
    v_mfma_f32_16x16x32_bf16 v[40:43], v[248:251], a[252:255], v[40:43]
    ds_read_b128 a[244:247], v9 offset:21504
    v_rcp_f32 v79, v79
    v_mfma_f32_16x16x32_bf16 v[44:47], v[252:255], a[252:255], v[44:47]
    s_waitcnt lgkmcnt(5)
    v_permlane16_swap_b32 v72, v74
    v_mul_f32 v79, v27, v79
    s_cmp_ge_u32 s7, 4
    s_cbranch_scc1 L_fin9
    v_mfma_f32_16x16x32_bf16 v[16:19], v[96:99], v[48:51], 0
    s_mul_i32 s16, s15, 6
    s_add_u32 s17, s15, 23
    ds_read_b128 a[248:251], v8 offset:2048
    v_cvt_pk_bf16_f32 v75, v78, v79
    v_mfma_f32_16x16x32_bf16 v[20:23], v[100:103], v[48:51], 0
    s_cmp_eq_u32 s8, 0
    s_cselect_b32 s16, s16, s17
    s_cselect_b32 s17, 5, 1
    s_cselect_b32 s18, 64, 2
    v_mfma_f32_16x16x32_bf16 v[24:27], v[96:99], v[52:55], 0
    ds_read_b128 a[252:255], v8 offset:22528
    ds_read_b96 v[92:94], v0 offset:4864
    v_and_b32 v6, 7, v1
    v_mfma_f32_16x16x32_bf16 v[28:31], v[100:103], v[52:55], 0
    v_min_u32 v7, s17, v6
    v_add_u32 v7, s16, v7
    v_mfma_f32_16x16x32_bf16 v[16:19], v[104:107], v[56:59], v[16:19]
    s_waitcnt lgkmcnt(4)
    ds_read_b128 v[48:51], v9 offset:2048
    v_min_u32 v7, 26, v7
    v_mfma_f32_16x16x32_bf16 v[20:23], v[108:111], v[56:59], v[20:23]
    s_and_b32 s16, s15, 1
    buffer_load_dwordx4 a[224:227], v2, s[40:43], s50 offen offset:1024
    v_permlane16_swap_b32 v73, v75
    v_mfma_f32_16x16x32_bf16 v[24:27], v[104:107], v[60:63], v[24:27]
    s_mul_i32 s16, s16, 5
    ds_read_b128 v[52:55], v9 offset:22528
    buffer_store_dwordx4 v[72:75], v10, s[24:27], s54 offen sc1
    v_mfma_f32_16x16x32_bf16 v[28:31], v[108:111], v[60:63], v[28:31]
    s_add_u32 s16, s16, 25
    s_waitcnt lgkmcnt(5)
    v_cmp_gt_u32 vcc, s18, v6
    v_min_u32 v6, 6, v6
    v_add_u32 v6, s16, v6
    v_cndmask_b32 v7, v6, v7, vcc
    v_mfma_f32_16x16x32_bf16 v[16:19], v[112:115], v[64:67], v[16:19]
    s_add_u32 s54, s54, 1155072
    ds_read_b128 v[56:59], v8 offset:3072
    v_and_b32 v6, 8, v1
    v_mfma_f32_16x16x32_bf16 v[20:23], v[116:119], v[64:67], v[20:23]
    v_lshl_add_u32 v7, v6, 3, v7
    v_fmac_f32 v32, v88, v80
    v_mfma_f32_16x16x32_bf16 v[24:27], v[112:115], v[68:71], v[24:27]
    ds_read_b128 v[60:63], v8 offset:23552
    v_lshlrev_b32 v7, 7, v7
    v_mfma_f32_16x16x32_bf16 v[28:31], v[116:119], v[68:71], v[28:31]
    s_xor_b32 s16, s92, 0
    s_mul_i32 s11, s16, 192512
    s_lshl_b32 s87, s9, 14
    s_add_u32 s87, s87, 8320
    v_add_u32 v4, 96256, v2
    v_mfma_f32_16x16x32_bf16 v[16:19], v[120:123], a[240:243], v[16:19]
    ds_read_b128 v[64:67], v9 offset:3072
    v_mul_f32 v76, v89, v32
    v_mfma_f32_16x16x32_bf16 v[20:23], v[124:127], a[240:243], v[20:23]
    buffer_load_dword v6, v7, s[28:31], s87 offen sc1
    v_exp_f32 v76, v76
    v_mfma_f32_16x16x32_bf16 v[24:27], v[120:123], a[244:247], v[24:27]
    ds_read_b128 v[68:71], v9 offset:23552
    v_fmac_f32 v36, v88, v84
    v_mfma_f32_16x16x32_bf16 v[28:31], v[124:127], a[244:247], v[28:31]
    s_waitcnt lgkmcnt(4)
    buffer_load_dwordx4 a[228:231], v2, s[40:43], s50 offen offset:2048
    v_mul_f32 v32, v32, v36
    v_mfma_f32_16x16x32_bf16 v[16:19], v[128:131], a[248:251], v[16:19]
    ds_read_b128 a[240:243], v8 offset:4096
    v_fma_f32 v76, v76, v90, v90
    v_mfma_f32_16x16x32_bf16 v[20:23], v[132:135], a[248:251], v[20:23]
    buffer_load_dwordx4 a[232:235], v2, s[40:43], s50 offen offset:3072
    v_mfma_f32_16x16x32_bf16 v[24:27], v[128:131], a[252:255], v[24:27]
    ds_read_b128 a[244:247], v8 offset:24576
    v_rcp_f32 v76, v76
    v_mfma_f32_16x16x32_bf16 v[28:31], v[132:135], a[252:255], v[28:31]
    v_fmac_f32 v33, v88, v81
    v_mul_f32 v76, v32, v76
    v_mfma_f32_16x16x32_bf16 v[16:19], v[136:139], v[48:51], v[16:19]
    ds_read_b128 a[248:251], v9 offset:4096
    v_mul_f32 v77, v89, v33
    v_mfma_f32_16x16x32_bf16 v[20:23], v[140:143], v[48:51], v[20:23]
    v_exp_f32 v77, v77
    v_mfma_f32_16x16x32_bf16 v[24:27], v[136:139], v[52:55], v[24:27]
    ds_read_b128 a[252:255], v9 offset:24576
    v_fmac_f32 v37, v88, v85
    v_mfma_f32_16x16x32_bf16 v[28:31], v[140:143], v[52:55], v[28:31]
    s_waitcnt lgkmcnt(4)
    v_mul_f32 v33, v33, v37
    v_fma_f32 v77, v77, v90, v90
    v_mfma_f32_16x16x32_bf16 v[16:19], v[144:147], v[56:59], v[16:19]
    s_add_u32 s50, s84, 4096
    ds_read_b128 v[48:51], v8 offset:5120
    v_rcp_f32 v77, v77
    v_mfma_f32_16x16x32_bf16 v[20:23], v[148:151], v[56:59], v[20:23]
    v_fmac_f32 v34, v88, v82
    v_mul_f32 v77, v33, v77
    v_mfma_f32_16x16x32_bf16 v[24:27], v[144:147], v[60:63], v[24:27]
    ds_read_b128 v[52:55], v8 offset:25600
    v_mul_f32 v78, v89, v34
    v_mfma_f32_16x16x32_bf16 v[28:31], v[148:151], v[60:63], v[28:31]
    v_exp_f32 v78, v78
    v_mfma_f32_16x16x32_bf16 v[16:19], v[152:155], v[64:67], v[16:19]
    ds_read_b128 v[56:59], v9 offset:5120
    v_fmac_f32 v38, v88, v86
    v_mfma_f32_16x16x32_bf16 v[20:23], v[156:159], v[64:67], v[20:23]
    v_cvt_pk_bf16_f32 v72, v76, v77
    v_mul_f32 v34, v34, v38
    v_mfma_f32_16x16x32_bf16 v[24:27], v[152:155], v[68:71], v[24:27]
    ds_read_b128 v[60:63], v9 offset:25600
    v_fma_f32 v78, v78, v90, v90
    v_mfma_f32_16x16x32_bf16 v[28:31], v[156:159], v[68:71], v[28:31]
    s_waitcnt lgkmcnt(4)
    buffer_load_dwordx4 a[236:239], v2, s[40:43], s50 offen offset:0
    v_mfma_f32_16x16x32_bf16 v[16:19], v[160:163], a[240:243], v[16:19]
    ds_read_b128 v[64:67], v8 offset:6144
    v_rcp_f32 v78, v78
    v_mfma_f32_16x16x32_bf16 v[20:23], v[164:167], a[240:243], v[20:23]
    v_fmac_f32 v35, v88, v83
    v_mul_f32 v78, v34, v78
    v_mfma_f32_16x16x32_bf16 v[24:27], v[160:163], a[244:247], v[24:27]
    ds_read_b128 v[68:71], v8 offset:26624
    v_mul_f32 v79, v89, v35
    v_mfma_f32_16x16x32_bf16 v[28:31], v[164:167], a[244:247], v[28:31]
    v_exp_f32 v79, v79
    v_mfma_f32_16x16x32_bf16 v[16:19], v[168:171], a[248:251], v[16:19]
    ds_read_b128 a[240:243], v9 offset:6144
    v_fmac_f32 v39, v88, v87
    v_mfma_f32_16x16x32_bf16 v[20:23], v[172:175], a[248:251], v[20:23]
    s_waitcnt vmcnt(3)
    v_cmp_ne_u32 vcc, v6, v13
    s_cbranch_vccnz Lq0s_6
Lq0b_7:
    v_mfma_f32_16x16x32_bf16 v[24:27], v[168:171], a[252:255], v[24:27]
    ds_read_b128 a[244:247], v9 offset:26624
    v_mul_f32 v35, v35, v39
    v_mfma_f32_16x16x32_bf16 v[28:31], v[172:175], a[252:255], v[28:31]
    s_add_u32 s19, s11, s93
    s_waitcnt lgkmcnt(4)
    v_fma_f32 v79, v79, v90, v90
    v_mfma_f32_16x16x32_bf16 v[16:19], v[176:179], v[48:51], v[16:19]
    ds_read_b128 a[248:251], v8 offset:7168
    v_rcp_f32 v79, v79
    v_mfma_f32_16x16x32_bf16 v[20:23], v[180:183], v[48:51], v[20:23]
    buffer_load_dwordx4 v[96:99], v2, s[24:27], s19 offen offset:0 sc1
    v_mfma_f32_16x16x32_bf16 v[24:27], v[176:179], v[52:55], v[24:27]
    ds_read_b128 a[252:255], v8 offset:27648
    v_fmac_f32 v40, v92, v80
    v_mfma_f32_16x16x32_bf16 v[28:31], v[180:183], v[52:55], v[28:31]
    buffer_load_dwordx4 v[100:103], v4, s[24:27], s19 offen offset:0 sc1
    v_mfma_f32_16x16x32_bf16 v[16:19], v[184:187], v[56:59], v[16:19]
    ds_read_b128 v[48:51], v9 offset:7168
    v_mul_f32 v79, v35, v79
    v_mfma_f32_16x16x32_bf16 v[20:23], v[188:191], v[56:59], v[20:23]
    buffer_load_dwordx4 v[104:107], v2, s[24:27], s19 offen offset:1024 sc1
    v_mfma_f32_16x16x32_bf16 v[24:27], v[184:187], v[60:63], v[24:27]
    ds_read_b128 v[52:55], v9 offset:27648
    v_mul_f32 v76, v93, v40
    v_mfma_f32_16x16x32_bf16 v[28:31], v[188:191], v[60:63], v[28:31]
    s_waitcnt lgkmcnt(4)
    v_exp_f32 v76, v76
    v_mfma_f32_16x16x32_bf16 v[16:19], v[192:195], v[64:67], v[16:19]
    ds_read_b128 v[56:59], v8 offset:8192
    v_fmac_f32 v44, v92, v84
    v_mfma_f32_16x16x32_bf16 v[20:23], v[196:199], v[64:67], v[20:23]
    buffer_load_dwordx4 v[108:111], v4, s[24:27], s19 offen offset:1024 sc1
    v_cvt_pk_bf16_f32 v73, v78, v79
    v_mfma_f32_16x16x32_bf16 v[24:27], v[192:195], v[68:71], v[24:27]
    ds_read_b128 v[60:63], v8 offset:28672
    v_mul_f32 v40, v40, v44
    v_mfma_f32_16x16x32_bf16 v[28:31], v[196:199], v[68:71], v[28:31]
    buffer_load_dwordx4 v[112:115], v2, s[24:27], s19 offen offset:2048 sc1
    v_fma_f32 v76, v76, v94, v94
    v_mfma_f32_16x16x32_bf16 v[16:19], v[200:203], a[240:243], v[16:19]
    ds_read_b128 v[64:67], v9 offset:8192
    v_rcp_f32 v76, v76
    v_mfma_f32_16x16x32_bf16 v[20:23], v[204:207], a[240:243], v[20:23]
    buffer_load_dwordx4 v[116:119], v4, s[24:27], s19 offen offset:2048 sc1
    v_fmac_f32 v41, v92, v81
    v_mfma_f32_16x16x32_bf16 v[24:27], v[200:203], a[244:247], v[24:27]
    ds_read_b128 v[68:71], v9 offset:28672
    v_mul_f32 v76, v40, v76
    v_mfma_f32_16x16x32_bf16 v[28:31], v[204:207], a[244:247], v[28:31]
    s_waitcnt lgkmcnt(4)
    buffer_load_dwordx4 v[120:123], v2, s[24:27], s19 offen offset:3072 sc1
    v_mfma_f32_16x16x32_bf16 v[16:19], v[208:211], a[248:251], v[16:19]
    ds_read_b128 a[240:243], v8 offset:9216
    v_mul_f32 v77, v93, v41
    v_mfma_f32_16x16x32_bf16 v[20:23], v[212:215], a[248:251], v[20:23]
    buffer_load_dwordx4 v[124:127], v4, s[24:27], s19 offen offset:3072 sc1
    v_mfma_f32_16x16x32_bf16 v[24:27], v[208:211], a[252:255], v[24:27]
    ds_read_b128 a[244:247], v8 offset:29696
    v_exp_f32 v77, v77
    v_mfma_f32_16x16x32_bf16 v[28:31], v[212:215], a[252:255], v[28:31]
    v_fmac_f32 v45, v92, v85
    v_mul_f32 v41, v41, v45
    v_mfma_f32_16x16x32_bf16 v[16:19], v[216:219], v[48:51], v[16:19]
    s_add_u32 s19, s19, 4096
    ds_read_b128 a[248:251], v9 offset:9216
    v_fma_f32 v77, v77, v94, v94
    v_mfma_f32_16x16x32_bf16 v[20:23], v[220:223], v[48:51], v[20:23]
    v_rcp_f32 v77, v77
    v_mfma_f32_16x16x32_bf16 v[24:27], v[216:219], v[52:55], v[24:27]
    ds_read_b128 a[252:255], v9 offset:29696
    v_fmac_f32 v42, v92, v82
    v_mfma_f32_16x16x32_bf16 v[28:31], v[220:223], v[52:55], v[28:31]
    s_waitcnt lgkmcnt(4)
    buffer_load_dwordx4 v[128:131], v2, s[24:27], s19 offen offset:0 sc1
    v_mul_f32 v77, v41, v77
    v_mfma_f32_16x16x32_bf16 v[16:19], v[224:227], v[56:59], v[16:19]
    buffer_load_dwordx4 v[132:135], v4, s[24:27], s19 offen offset:0 sc1
    v_mfma_f32_16x16x32_bf16 v[20:23], v[228:231], v[56:59], v[20:23]
    s_waitcnt lgkmcnt(0)
    s_barrier
    v_mul_f32 v78, v93, v42
    v_mfma_f32_16x16x32_bf16 v[24:27], v[224:227], v[60:63], v[24:27]
    v_exp_f32 v78, v78
    v_mfma_f32_16x16x32_bf16 v[28:31], v[228:231], v[60:63], v[28:31]
    buffer_load_dwordx4 v[136:139], v2, s[24:27], s19 offen offset:1024 sc1
    v_fmac_f32 v46, v92, v86
    v_mfma_f32_16x16x32_bf16 v[16:19], v[232:235], v[64:67], v[16:19]
    v_cvt_pk_bf16_f32 v74, v76, v77
    v_mul_f32 v42, v42, v46
    v_mfma_f32_16x16x32_bf16 v[20:23], v[236:239], v[64:67], v[20:23]
    buffer_store_dword v13, v11, s[28:31], s55 offen sc1
    v_fma_f32 v78, v78, v94, v94
    v_mfma_f32_16x16x32_bf16 v[24:27], v[232:235], v[68:71], v[24:27]
    buffer_load_dwordx4 v[140:143], v4, s[24:27], s19 offen offset:1024 sc1
    v_rcp_f32 v78, v78
    v_mfma_f32_16x16x32_bf16 v[28:31], v[236:239], v[68:71], v[28:31]
    buffer_load_dwordx4 v[144:147], v2, s[24:27], s19 offen offset:2048 sc1
    v_fmac_f32 v43, v92, v83
    v_mfma_f32_16x16x32_bf16 v[16:19], v[240:243], a[240:243], v[16:19]
    v_mul_f32 v78, v42, v78
    v_mul_f32 v79, v93, v43
    v_mfma_f32_16x16x32_bf16 v[20:23], v[244:247], a[240:243], v[20:23]
    s_add_u32 s55, s55, 49152
    v_exp_f32 v79, v79
    v_mfma_f32_16x16x32_bf16 v[24:27], v[240:243], a[244:247], v[24:27]
    buffer_load_dwordx4 v[148:151], v4, s[24:27], s19 offen offset:2048 sc1
    v_fmac_f32 v47, v92, v87
    v_mfma_f32_16x16x32_bf16 v[28:31], v[244:247], a[244:247], v[28:31]
    v_mul_f32 v43, v43, v47
    v_fma_f32 v79, v79, v94, v94
    v_mfma_f32_16x16x32_bf16 v[16:19], v[248:251], a[248:251], v[16:19]
    buffer_load_dwordx4 v[152:155], v2, s[24:27], s19 offen offset:3072 sc1
    v_mfma_f32_16x16x32_bf16 v[20:23], v[252:255], a[248:251], v[20:23]
    ds_read_b96 v[88:90], v0 offset:5120
    v_rcp_f32 v79, v79
    v_mfma_f32_16x16x32_bf16 v[24:27], v[248:251], a[252:255], v[24:27]
    buffer_load_dwordx4 v[156:159], v4, s[24:27], s19 offen offset:3072 sc1
    v_mfma_f32_16x16x32_bf16 v[28:31], v[252:255], a[252:255], v[28:31]
    v_permlane16_swap_b32 v72, v74
    v_mul_f32 v79, v43, v79
    v_cvt_pk_bf16_f32 v75, v78, v79
    ds_read_b96 v[92:94], v0 offset:5376
    s_nop 0
    v_permlane16_swap_b32 v73, v75
    buffer_store_dwordx4 v[72:75], v10, s[24:27], s54 offen sc1
    s_add_u32 s54, s54, 1155072
    s_waitcnt lgkmcnt(0)
    v_fmac_f32 v16, v88, v80
    v_mul_f32 v76, v89, v16
    v_exp_f32 v76, v76
    v_fmac_f32 v20, v88, v84
    v_mul_f32 v16, v16, v20
    v_fma_f32 v76, v76, v90, v90
    v_rcp_f32 v76, v76
    v_fmac_f32 v17, v88, v81
    v_mul_f32 v76, v16, v76
    v_mul_f32 v77, v89, v17
    v_exp_f32 v77, v77
    v_fmac_f32 v21, v88, v85
    v_mul_f32 v17, v17, v21
    v_fma_f32 v77, v77, v90, v90
    v_rcp_f32 v77, v77
    v_fmac_f32 v18, v88, v82
    v_mul_f32 v77, v17, v77
    v_mul_f32 v78, v89, v18
    v_exp_f32 v78, v78
    v_fmac_f32 v22, v88, v86
    v_cvt_pk_bf16_f32 v72, v76, v77
    v_mul_f32 v18, v18, v22
    v_fma_f32 v78, v78, v90, v90
    v_rcp_f32 v78, v78
    v_fmac_f32 v19, v88, v83
    v_mul_f32 v78, v18, v78
    v_mul_f32 v79, v89, v19
    v_exp_f32 v79, v79
    v_fmac_f32 v23, v88, v87
    v_mul_f32 v19, v19, v23
    v_fma_f32 v79, v79, v90, v90
    v_rcp_f32 v79, v79
    v_fmac_f32 v24, v92, v80
    v_mul_f32 v79, v19, v79
    v_mul_f32 v76, v93, v24
    v_exp_f32 v76, v76
    v_fmac_f32 v28, v92, v84
    v_cvt_pk_bf16_f32 v73, v78, v79
L_hk3574:
    s_cbranch_execz L_hback
    v_mul_f32 v24, v24, v28
    v_fma_f32 v76, v76, v94, v94
    v_rcp_f32 v76, v76
    v_fmac_f32 v25, v92, v81
    v_mul_f32 v76, v24, v76
    v_mul_f32 v77, v93, v25
    v_exp_f32 v77, v77
    v_fmac_f32 v29, v92, v85
    v_mul_f32 v25, v25, v29
    v_fma_f32 v77, v77, v94, v94
    v_rcp_f32 v77, v77
    v_fmac_f32 v26, v92, v82
    v_mul_f32 v77, v25, v77
    v_mul_f32 v78, v93, v26
    v_exp_f32 v78, v78
    v_fmac_f32 v30, v92, v86
    v_cvt_pk_bf16_f32 v74, v76, v77
    v_mul_f32 v26, v26, v30
    v_fma_f32 v78, v78, v94, v94
    v_rcp_f32 v78, v78
    v_fmac_f32 v27, v92, v83
    v_mul_f32 v78, v26, v78
    v_mul_f32 v79, v93, v27
    v_exp_f32 v79, v79
    v_fmac_f32 v31, v92, v87
    v_mul_f32 v27, v27, v31
    v_fma_f32 v79, v79, v94, v94
    v_rcp_f32 v79, v79
    v_permlane16_swap_b32 v72, v74
    v_mul_f32 v79, v27, v79
    v_cvt_pk_bf16_f32 v75, v78, v79
    s_nop 1
    v_permlane16_swap_b32 v73, v75
    buffer_store_dwordx4 v[72:75], v10, s[24:27], s54 offen sc1
    s_branch L_p2
L_fin9:
    v_cvt_pk_bf16_f32 v75, v78, v79
    ds_read_b96 v[92:94], v0 offset:4864
    s_nop 0
    v_permlane16_swap_b32 v73, v75
    buffer_store_dwordx4 v[72:75], v10, s[24:27], s54 offen sc1
    s_add_u32 s54, s54, 1155072
    s_waitcnt lgkmcnt(0)
    s_mul_i32 s16, s15, 6
    s_add_u32 s17, s15, 23
    s_cmp_eq_u32 s8, 0
    s_cselect_b32 s16, s16, s17
    s_cselect_b32 s17, 5, 1
    s_cselect_b32 s18, 64, 2
    v_and_b32 v6, 7, v1
    v_min_u32 v7, s17, v6
    v_add_u32 v7, s16, v7
    v_min_u32 v7, 26, v7
    s_and_b32 s16, s15, 1
    s_mul_i32 s16, s16, 5
    s_add_u32 s16, s16, 25
    v_cmp_gt_u32 vcc, s18, v6
    v_min_u32 v6, 6, v6
    v_add_u32 v6, s16, v6
    v_cndmask_b32 v7, v6, v7, vcc
    v_and_b32 v6, 8, v1
    v_lshl_add_u32 v7, v6, 3, v7
    v_lshlrev_b32 v7, 7, v7
    s_xor_b32 s16, s92, 0
    s_mul_i32 s11, s16, 192512
    s_lshl_b32 s87, s9, 14
    s_add_u32 s87, s87, 8320
    v_add_u32 v4, 96256, v2
    buffer_load_dword v6, v7, s[28:31], s87 offen sc1
    v_fmac_f32 v32, v88, v80
    v_mul_f32 v76, v89, v32
    v_exp_f32 v76, v76
    v_fmac_f32 v36, v88, v84
    v_mul_f32 v32, v32, v36
    v_fma_f32 v76, v76, v90, v90
    v_rcp_f32 v76, v76
    v_fmac_f32 v33, v88, v81
    v_mul_f32 v76, v32, v76
    v_mul_f32 v77, v89, v33
    v_exp_f32 v77, v77
    v_fmac_f32 v37, v88, v85
    v_mul_f32 v33, v33, v37
    v_fma_f32 v77, v77, v90, v90
    v_rcp_f32 v77, v77
    v_fmac_f32 v34, v88, v82
    v_mul_f32 v77, v33, v77
    buffer_load_dwordx4 a[224:227], v2, s[40:43], s50 offen offset:1024
    v_mul_f32 v78, v89, v34
    v_exp_f32 v78, v78
    v_fmac_f32 v38, v88, v86
    v_cvt_pk_bf16_f32 v72, v76, v77
    v_mul_f32 v34, v34, v38
    v_fma_f32 v78, v78, v90, v90
    v_rcp_f32 v78, v78
    v_fmac_f32 v35, v88, v83
    v_mul_f32 v78, v34, v78
    v_mul_f32 v79, v89, v35
    v_exp_f32 v79, v79
    v_fmac_f32 v39, v88, v87
    v_mul_f32 v35, v35, v39
    v_fma_f32 v79, v79, v90, v90
    v_rcp_f32 v79, v79
    v_fmac_f32 v40, v92, v80
    v_mul_f32 v79, v35, v79
    buffer_load_dwordx4 a[228:231], v2, s[40:43], s50 offen offset:2048
    v_mul_f32 v76, v93, v40
    v_exp_f32 v76, v76
    v_fmac_f32 v44, v92, v84
    v_cvt_pk_bf16_f32 v73, v78, v79
    v_mul_f32 v40, v40, v44
    v_fma_f32 v76, v76, v94, v94
    v_rcp_f32 v76, v76
    v_fmac_f32 v41, v92, v81
    v_mul_f32 v76, v40, v76
    v_mul_f32 v77, v93, v41
    v_exp_f32 v77, v77
    v_fmac_f32 v45, v92, v85
    v_mul_f32 v41, v41, v45
    v_fma_f32 v77, v77, v94, v94
    v_rcp_f32 v77, v77
    v_fmac_f32 v42, v92, v82
    v_mul_f32 v77, v41, v77
    v_mul_f32 v78, v93, v42
    buffer_load_dwordx4 a[232:235], v2, s[40:43], s50 offen offset:3072
    s_add_u32 s50, s84, 4096
    v_exp_f32 v78, v78
    v_fmac_f32 v46, v92, v86
    v_cvt_pk_bf16_f32 v74, v76, v77
    v_mul_f32 v42, v42, v46
    v_fma_f32 v78, v78, v94, v94
    v_rcp_f32 v78, v78
    v_fmac_f32 v43, v92, v83
    v_mul_f32 v78, v42, v78
    v_mul_f32 v79, v93, v43
    v_exp_f32 v79, v79
    v_fmac_f32 v47, v92, v87
    v_mul_f32 v43, v43, v47
    v_fma_f32 v79, v79, v94, v94
    v_rcp_f32 v79, v79
    v_permlane16_swap_b32 v72, v74
    v_mul_f32 v79, v43, v79
    v_cvt_pk_bf16_f32 v75, v78, v79
    s_nop 1
    v_permlane16_swap_b32 v73, v75
    buffer_load_dwordx4 a[236:239], v2, s[40:43], s50 offen offset:0
    s_waitcnt vmcnt(4)
    v_cmp_ne_u32 vcc, v6, v13
    s_cbranch_vccnz Lq0s_8
Lq0b_9:
    s_add_u32 s19, s11, s93
    buffer_load_dwordx4 v[96:99], v2, s[24:27], s19 offen offset:0 sc1
    buffer_load_dwordx4 v[100:103], v4, s[24:27], s19 offen offset:0 sc1
    buffer_load_dwordx4 v[104:107], v2, s[24:27], s19 offen offset:1024 sc1
    buffer_load_dwordx4 v[108:111], v4, s[24:27], s19 offen offset:1024 sc1
    buffer_load_dwordx4 v[112:115], v2, s[24:27], s19 offen offset:2048 sc1
    buffer_load_dwordx4 v[116:119], v4, s[24:27], s19 offen offset:2048 sc1
    buffer_load_dwordx4 v[120:123], v2, s[24:27], s19 offen offset:3072 sc1
    buffer_load_dwordx4 v[124:127], v4, s[24:27], s19 offen offset:3072 sc1
    s_add_u32 s19, s19, 4096
    buffer_load_dwordx4 v[128:131], v2, s[24:27], s19 offen offset:0 sc1
    buffer_load_dwordx4 v[132:135], v4, s[24:27], s19 offen offset:0 sc1
    buffer_load_dwordx4 v[136:139], v2, s[24:27], s19 offen offset:1024 sc1
    buffer_load_dwordx4 v[140:143], v4, s[24:27], s19 offen offset:1024 sc1
    buffer_load_dwordx4 v[144:147], v2, s[24:27], s19 offen offset:2048 sc1
    buffer_load_dwordx4 v[148:151], v4, s[24:27], s19 offen offset:2048 sc1
    buffer_load_dwordx4 v[152:155], v2, s[24:27], s19 offen offset:3072 sc1
    buffer_load_dwordx4 v[156:159], v4, s[24:27], s19 offen offset:3072 sc1
    buffer_store_dwordx4 v[72:75], v10, s[24:27], s54 offen sc1
    s_mov_b32 s16, 2146435072
    buffer_store_dword v13, v2, s[28:31], s16 offen
    s_branch L_p2
.p2align 12
L_ssm:
L_chain0:
L_hk3748:
    s_cbranch_execz L_hk6350
    v_mul_u32_u24 v17, 163840, v14
    v_sub_u32 v17, 122880, v17
    v_lshlrev_b32 v14, 31, v14
    ds_read_b128 a[112:115], v36 offset:0
    v_lshlrev_b32 v88, 16, v88
    v_lshrrev_b32 v16, 4, v1
    v_lshlrev_b32 v89, 16, v89
    ds_read_b128 a[116:119], v37 offset:0
    v_lshlrev_b32 v90, 16, v90
    v_xor_b32 v16, v16, v1
    v_mul_f32 v90, 0x3fb8aa3b, v90
    ds_read_b128 a[120:123], v38 offset:0
    v_exp_f32 v90, v90
    s_nop 0
    v_cvt_pk_bf16_f32 v90, v90, v90
    s_add_u32 m0, s56, 122880
    s_add_u32 s62, s62, s61
    s_mov_b32 s63, s62
    buffer_load_dwordx4 v32, s[32:35], s63 offen lds
    v_and_b32 v16, 1, v16
    v_and_b32 v90, 0xffff0000, v90
    ds_read_b128 a[124:127], v39 offset:0
    v_mul_f32 v91, v90, v88
    v_cmp_eq_u32 vcc, 0, v16
    s_nop 1
    v_cndmask_b32 v176, 0, v44, vcc
    v_mul_f32 v92, v90, v89
    ds_read_b128 a[128:131], v36 offset:1024
    v_mul_f32 v174, 0x3fb8aa3b, v91
    v_exp_f32 v91, v174
    v_mov_b32 v177, v176
    s_add_u32 m0, s56, 123904
    s_add_u32 s63, s63, s59
    buffer_load_dwordx4 v33, s[32:35], s63 offen lds
    v_mul_f32 v92, 0.15915494, v92
    ds_read_b128 a[132:135], v37 offset:1024
    v_xor_b32 v175, v14, v92
    v_mov_b32 v178, v176
    v_fract_f32 v92, v92
    ds_read_b128 a[136:139], v38 offset:1024
    v_cos_f32 v93, v92
    v_sin_f32 v94, v92
    v_mov_b32 v179, v176
    v_mul_f32 v93, v91, v93
    ds_read_b128 a[140:143], v39 offset:1024
    s_add_u32 m0, s56, 124928
    s_add_u32 s63, s63, s59
    buffer_load_dwordx4 v32, s[32:35], s63 offen lds
    v_mul_f32 v94, v91, v94
    ds_read_b128 a[144:147], v36 offset:2048
    v_add_f32 v91, -1.0, v93
    ds_read_b128 a[148:151], v37 offset:2048
    v_mul_f32 v92, v88, v88
    ds_read_b128 a[152:155], v38 offset:2048
    v_fmac_f32 v92, v89, v89
    v_rcp_f32 v92, v92
    s_waitcnt lgkmcnt(10)
    v_mul_f32 v95, v91, v88
    s_add_u32 m0, s56, 125952
    s_add_u32 s63, s63, s59
    buffer_load_dwordx4 v33, s[32:35], s63 offen lds
    v_mfma_f32_16x16x32_bf16 v[56:59], v[176:179], a[112:115], 0
    v_fmac_f32 v95, v94, v89
    ds_read_b128 a[156:159], v39 offset:2048
    v_mul_f32 v90, v94, v88
    s_waitcnt lgkmcnt(10)
    v_fma_f32 v90, -v91, v89, v90
    v_add_f32 v92, v92, v92
    v_mfma_f32_16x16x32_bf16 v[56:59], v[176:179], a[116:119], v[56:59]
    v_mul_f32 v95, v95, v92
    ds_read_b128 a[160:163], v36 offset:3072
    v_mul_f32 v90, v90, v92
    s_add_u32 m0, s56, 126976
    s_add_u32 s63, s63, s59
    buffer_load_dwordx4 v32, s[32:35], s63 offen lds
    s_waitcnt lgkmcnt(10)
    v_xor_b32 v48, v14, v95
    v_mfma_f32_16x16x32_bf16 v[56:59], v[176:179], a[120:123], v[56:59]
    v_sub_f32 v49, 0, v90
    v_mov_b32 v224, v93
    ds_read_b128 a[164:167], v37 offset:3072
    v_xor_b32 v240, v14, v94
    s_waitcnt lgkmcnt(10)
    v_mov_b32 v53, 0
    v_mfma_f32_16x16x32_bf16 v[56:59], v[176:179], a[124:127], v[56:59]
    s_add_u32 m0, s56, 128000
    s_add_u32 s63, s62, s60
    buffer_load_dwordx4 v33, s[32:35], s63 offen lds
    v_mul_f32 v225, v224, v224
    ds_read_b128 a[168:171], v38 offset:3072
    v_mul_f32 v241, v224, v240
    v_fma_f32 v225, -v240, v240, v225
    s_waitcnt lgkmcnt(10)
    v_fmac_f32 v241, v240, v224
    v_mfma_f32_16x16x32_bf16 v[56:59], v[176:179], a[128:131], v[56:59]
    v_mul_f32 v226, v225, v224
    ds_read_b128 a[172:175], v39 offset:3072
    v_mul_f32 v242, v225, v240
    s_waitcnt lgkmcnt(10)
    s_add_u32 m0, s56, 129024
    s_add_u32 s63, s63, s59
    buffer_load_dwordx4 v32, s[32:35], s63 offen lds
    v_fma_f32 v226, -v241, v240, v226
    v_mfma_f32_16x16x32_bf16 v[56:59], v[176:179], a[132:135], v[56:59]
    v_fmac_f32 v242, v241, v224
    v_mul_f32 v227, v226, v224
    ds_read_b128 a[176:179], v36 offset:4096
    v_mul_f32 v243, v226, v240
    s_waitcnt lgkmcnt(10)
    v_fma_f32 v227, -v242, v240, v227
    v_mfma_f32_16x16x32_bf16 v[56:59], v[176:179], a[136:139], v[56:59]
    v_fmac_f32 v243, v242, v224
    s_add_u32 m0, s56, 130048
    s_add_u32 s63, s63, s59
    buffer_load_dwordx4 v33, s[32:35], s63 offen lds
    ds_read_b128 a[180:183], v37 offset:4096
    v_mul_f32 v228, v227, v224
    v_mul_f32 v244, v227, v240
    s_waitcnt lgkmcnt(10)
    v_fma_f32 v228, -v243, v240, v228
    v_mfma_f32_16x16x32_bf16 v[56:59], v[176:179], a[140:143], v[56:59]
    v_fmac_f32 v244, v243, v224
    ds_read_b128 a[184:187], v38 offset:4096
    v_mul_f32 v229, v228, v224
    s_waitcnt lgkmcnt(10)
    v_mul_f32 v245, v228, v240
    s_add_u32 m0, s56, 131072
    s_add_u32 s63, s63, s59
    buffer_load_dwordx4 v32, s[32:35], s63 offen lds
    v_fma_f32 v229, -v244, v240, v229
    v_mfma_f32_16x16x32_bf16 v[56:59], v[176:179], a[144:147], v[56:59]
    v_fmac_f32 v245, v244, v224
    ds_read_b128 a[188:191], v39 offset:4096
    v_mul_f32 v230, v229, v224
    s_waitcnt lgkmcnt(10)
    v_mul_f32 v246, v229, v240
    v_mfma_f32_16x16x32_bf16 v[56:59], v[176:179], a[148:151], v[56:59]
    v_fma_f32 v230, -v245, v240, v230
    v_fmac_f32 v246, v245, v224
    s_add_u32 m0, s56, 132096
    s_add_u32 s63, s63, s59
    buffer_load_dwordx4 v33, s[32:35], s63 offen lds
    s_waitcnt lgkmcnt(0)
    v_mov_b32 v55, v13
    v_mfma_f32_16x16x32_bf16 v[56:59], v[176:179], a[152:155], v[56:59]
    v_mul_f32 v231, v230, v224
    v_mul_f32 v247, v230, v240
    v_fma_f32 v231, -v246, v240, v231
    v_mfma_f32_16x16x32_bf16 v[56:59], v[176:179], a[156:159], v[56:59]
    v_fmac_f32 v247, v246, v224
    v_mul_f32 v232, v231, v224
    v_mul_f32 v248, v231, v240
    v_mfma_f32_16x16x32_bf16 v[56:59], v[176:179], a[160:163], v[56:59]
    v_fma_f32 v232, -v247, v240, v232
    v_fmac_f32 v248, v247, v224
    v_mul_f32 v233, v232, v224
    v_mfma_f32_16x16x32_bf16 v[56:59], v[176:179], a[164:167], v[56:59]
    v_mul_f32 v249, v232, v240
    s_add_u32 m0, s56, 0
    s_mov_b32 s63, s62
    buffer_load_dwordx4 v34, s[36:39], s63 offen lds
    v_fma_f32 v233, -v248, v240, v233
    v_fmac_f32 v249, v248, v224
    v_mfma_f32_16x16x32_bf16 v[56:59], v[176:179], a[168:171], v[56:59]
    v_mul_f32 v234, v233, v224
    v_mul_f32 v250, v233, v240
    v_fma_f32 v234, -v249, v240, v234
    v_fmac_f32 v250, v249, v224
    v_mfma_f32_16x16x32_bf16 v[56:59], v[176:179], a[172:175], v[56:59]
    v_mul_f32 v235, v234, v224
    v_mul_f32 v251, v234, v240
    v_fma_f32 v235, -v250, v240, v235
    v_mfma_f32_16x16x32_bf16 v[56:59], v[176:179], a[176:179], v[56:59]
    v_fmac_f32 v251, v250, v224
    v_mul_f32 v236, v235, v224
    s_add_u32 m0, s56, 1024
    s_add_u32 s63, s63, s59
    buffer_load_dwordx4 v35, s[36:39], s63 offen lds
    v_mul_f32 v252, v235, v240
    v_mfma_f32_16x16x32_bf16 v[56:59], v[176:179], a[180:183], v[56:59]
    v_fma_f32 v236, -v251, v240, v236
    v_fmac_f32 v252, v251, v224
    v_mul_f32 v237, v236, v224
    v_mfma_f32_16x16x32_bf16 v[56:59], v[176:179], a[184:187], v[56:59]
    v_mul_f32 v253, v236, v240
    v_fma_f32 v237, -v252, v240, v237
    v_fmac_f32 v253, v252, v224
    v_mfma_f32_16x16x32_bf16 v[56:59], v[176:179], a[188:191], v[56:59]
    v_mul_f32 v238, v237, v224
    v_mul_f32 v254, v237, v240
    v_fma_f32 v238, -v253, v240, v238
    v_fmac_f32 v254, v253, v224
    s_add_u32 m0, s56, 2048
    s_add_u32 s63, s63, s59
    buffer_load_dwordx4 v34, s[36:39], s63 offen lds
    v_add_u32 v36, v17, v36
    v_add_u32 v37, v17, v37
    v_add_u32 v38, v17, v38
    v_add_u32 v39, v17, v39
    s_waitcnt vmcnt(14)
    s_barrier
    ds_read_b128 a[224:227], v8 offset:0
    ds_read_b128 a[228:231], v9 offset:0
    ds_read_b128 a[232:235], v10 offset:0
    ds_read_b128 a[236:239], v11 offset:0
    ds_read_b128 a[240:243], v8 offset:1024
    ds_read_b128 a[244:247], v9 offset:1024
    ds_read_b128 a[248:251], v10 offset:1024
    s_waitcnt lgkmcnt(5)
    v_mfma_f32_32x32x16_bf16 v[144:159], a[224:227], a[112:115], 0
    ds_read_b128 a[252:255], v11 offset:1024
    s_add_u32 m0, s56, 3072
    s_add_u32 s63, s63, s59
    buffer_load_dwordx4 v35, s[36:39], s63 offen lds
    v_mfma_f32_32x32x16_bf16 v[144:159], a[228:231], a[116:119], v[144:159]
    ds_read_b128 a[224:227], v8 offset:2048
    s_waitcnt lgkmcnt(4)
    s_add_u32 m0, s56, 4096
    s_add_u32 s63, s63, s59
    buffer_load_dwordx4 v34, s[36:39], s63 offen lds
    v_mfma_f32_32x32x16_bf16 v[144:159], a[232:235], a[120:123], v[144:159]
    ds_read_b128 a[228:231], v9 offset:2048
    s_add_u32 m0, s56, 5120
    s_add_u32 s63, s62, s60
    buffer_load_dwordx4 v35, s[36:39], s63 offen lds
    s_add_u32 s52, s6, 27
    s_lshl_b32 s52, s52, 7
    s_cmp_eq_u32 s15, 0
    s_cselect_b32 s52, s52, 2146435072
    v_lshlrev_b32 v14, 25, v1
    v_and_b32 v14, 0x40000000, v14
    v_lshl_add_u32 v14, v1, 2, v14
    v_add_u32 v14, s52, v14
    v_mfma_f32_32x32x16_bf16 v[144:159], a[236:239], a[124:127], v[144:159]
    ds_read_b128 a[232:235], v10 offset:2048
    s_add_u32 m0, s56, 6144
    s_add_u32 s63, s63, s59
    buffer_load_dwordx4 v34, s[36:39], s63 offen lds
    v_lshrrev_b32 v92, 5, v1
    v_cvt_f32_u32 v92, v92
    v_cvt_f32_u32 v93, s7
    v_mfma_f32_32x32x16_bf16 v[144:159], a[240:243], a[128:131], v[144:159]
    ds_read_b128 a[236:239], v11 offset:2048
    s_waitcnt lgkmcnt(4)
    s_add_u32 m0, s56, 7168
    s_add_u32 s63, s63, s59
    buffer_load_dwordx4 v35, s[36:39], s63 offen lds
    v_mul_f32 v93, 0x42000000, v93
    v_mul_f32 v94, 0xc3000000, v92
    v_mfma_f32_32x32x16_bf16 v[144:159], a[244:247], a[132:135], v[144:159]
    ds_read_b128 a[240:243], v8 offset:3072
    s_add_u32 m0, s56, 8192
    s_add_u32 s63, s63, s59
    buffer_load_dwordx4 v34, s[36:39], s63 offen lds
    v_add_f32 v88, 0x43600000, v94
    v_mul_f32 v90, v88, v174
    v_mfma_f32_32x32x16_bf16 v[144:159], a[248:251], a[136:139], v[144:159]
    ds_read_b128 a[244:247], v9 offset:3072
    s_add_u32 m0, s56, 9216
    s_add_u32 s63, s63, s59
    buffer_load_dwordx4 v35, s[36:39], s63 offen lds
    v_mul_f32 v91, v88, v175
    v_exp_f32 v90, v90
    v_mfma_f32_32x32x16_bf16 v[144:159], a[252:255], a[140:143], v[144:159]
    ds_read_b128 a[248:251], v10 offset:3072
    s_waitcnt lgkmcnt(4)
    s_mov_b64 s[32:33], s[88:89]
    s_mov_b32 s34, 2211840
    s_mov_b32 s35, 0x20000
    s_mov_b64 s[36:37], s[74:75]
    s_mov_b32 s38, 819200
    s_mov_b32 s39, 0x20000
    v_mfma_f32_32x32x16_bf16 v[144:159], a[224:227], a[144:147], v[144:159]
    ds_read_b128 a[252:255], v11 offset:3072
    s_add_u32 m0, s56, 40960
    s_nop 0
    buffer_load_dwordx4 v12, s[20:23], s53 offen offset:0 lds
    s_add_u32 m0, s56, 41856
    v_fract_f32 v91, v91
    v_cos_f32 v72, v91
    v_mfma_f32_32x32x16_bf16 v[144:159], a[228:231], a[148:151], v[144:159]
    ds_read_b128 a[224:227], v8 offset:4096
    buffer_load_dwordx4 v12, s[20:23], s53 offen offset:128 lds
    s_add_u32 m0, s56, 42752
    v_sin_f32 v76, v91
    v_mul_f32 v72, v90, v72
    v_mul_f32 v76, v90, v76
    v_add_f32 v88, 0xc2000000, v94
    v_mfma_f32_32x32x16_bf16 v[144:159], a[232:235], a[152:155], v[144:159]
    ds_read_b128 a[228:231], v9 offset:4096
    s_waitcnt lgkmcnt(4)
    buffer_load_dwordx4 v12, s[20:23], s53 offen offset:256 lds
    s_add_u32 m0, s56, 43648
    v_add_f32 v88, v88, v93
    v_mul_f32 v90, v88, v174
    v_mul_f32 v91, v88, v175
    v_mfma_f32_32x32x16_bf16 v[144:159], a[236:239], a[156:159], v[144:159]
    ds_read_b128 a[232:235], v10 offset:4096
    buffer_load_dwordx4 v12, s[20:23], s53 offen offset:384 lds
    s_add_u32 m0, s56, 44544
    v_exp_f32 v90, v90
    v_fract_f32 v91, v91
    v_cos_f32 v80, v91
    v_mfma_f32_32x32x16_bf16 v[144:159], a[240:243], a[160:163], v[144:159]
    ds_read_b128 a[236:239], v11 offset:4096
    buffer_load_dwordx4 v12, s[20:23], s53 offen offset:512 lds
    s_add_u32 m0, s56, 45440
    v_sin_f32 v84, v91
    v_cmp_le_f32 vcc, 0, v88
    s_nop 1
    v_cndmask_b32 v90, 0, v90, vcc
    v_mfma_f32_32x32x16_bf16 v[144:159], a[244:247], a[164:167], v[144:159]
    ds_read_b128 a[240:243], v8 offset:5120
    s_waitcnt lgkmcnt(4)
    buffer_load_dwordx4 v12, s[20:23], s53 offen offset:640 lds
    s_add_u32 m0, s56, 46336
    v_mul_f32 v80, v90, v80
    v_mul_f32 v84, v90, v84
    v_add_f32 v88, 0x43400000, v94
    v_mfma_f32_32x32x16_bf16 v[144:159], a[248:251], a[168:171], v[144:159]
    ds_read_b128 a[244:247], v9 offset:5120
    buffer_load_dwordx4 v12, s[20:23], s53 offen offset:768 lds
    s_add_u32 m0, s56, 47232
    v_mul_f32 v90, v88, v174
    v_mul_f32 v91, v88, v175
    v_exp_f32 v90, v90
    v_mfma_f32_32x32x16_bf16 v[144:159], a[252:255], a[172:175], v[144:159]
    ds_read_b128 a[248:251], v10 offset:5120
    buffer_load_dwordx4 v12, s[20:23], s53 offen offset:896 lds
    s_add_u32 m0, s56, 48128
    v_fract_f32 v91, v91
    v_cos_f32 v73, v91
    v_sin_f32 v77, v91
    v_mul_f32 v73, v90, v73
    v_mfma_f32_32x32x16_bf16 v[144:159], a[224:227], a[176:179], v[144:159]
    ds_read_b128 a[252:255], v11 offset:5120
    s_waitcnt lgkmcnt(4)
    buffer_load_dwordx4 v12, s[20:23], s53 offen offset:1024 lds
    s_add_u32 m0, s56, 49024
    v_mul_f32 v77, v90, v77
    v_add_f32 v88, 0xc2800000, v94
    v_mfma_f32_32x32x16_bf16 v[144:159], a[228:231], a[180:183], v[144:159]
    ds_read_b128 a[224:227], v8 offset:6144
    buffer_load_dwordx4 v12, s[20:23], s53 offen offset:1152 lds
    s_add_u32 m0, s56, 0
    s_add_u32 s53, s53, 324992
    v_add_f32 v88, v88, v93
    v_mul_f32 v90, v88, v174
    v_mul_f32 v91, v88, v175
    v_mfma_f32_32x32x16_bf16 v[144:159], a[232:235], a[184:187], v[144:159]
    ds_read_b128 a[228:231], v9 offset:6144
    buffer_load_dwordx2 v[28:29], v30, s[28:31], 0 offen sc1
    v_exp_f32 v90, v90
    v_fract_f32 v91, v91
    v_cos_f32 v81, v91
    v_sin_f32 v85, v91
    v_mfma_f32_32x32x16_bf16 v[144:159], a[236:239], a[188:191], v[144:159]
    ds_read_b128 a[232:235], v10 offset:6144
    s_waitcnt lgkmcnt(4)
    v_cmp_le_f32 vcc, 0, v88
    s_nop 1
    v_cndmask_b32 v90, 0, v90, vcc
    v_mul_f32 v81, v90, v81
    v_mul_f32 v85, v90, v85
    s_waitcnt vmcnt(11)
    ds_read_b128 a[192:195], v36 offset:0
    ds_read_b128 a[196:199], v37 offset:0
    ds_read_b128 a[200:203], v38 offset:0
    ds_read_b128 a[204:207], v39 offset:0
    ds_read_b128 a[208:211], v36 offset:1024
    ds_read_b128 a[212:215], v37 offset:1024
    v_mul_f32 v239, v238, v224
    v_mul_f32 v255, v238, v240
    v_fma_f32 v239, -v254, v240, v239
    v_fmac_f32 v255, v254, v224
    s_waitcnt lgkmcnt(4)
    v_mfma_f32_32x32x16_bf16 v[144:159], a[240:243], a[192:195], v[144:159]
    ds_read_b128 a[236:239], v11 offset:6144
    ds_read_b128 a[216:219], v38 offset:1024
    ds_read_b128 a[220:223], v39 offset:1024
    v_mfma_f32_16x16x32_bf16 v[56:59], v[176:179], a[192:195], v[56:59]
    v_mfma_f32_16x16x32_bf16 v[56:59], v[176:179], a[196:199], v[56:59]
    v_mfma_f32_32x32x16_bf16 v[144:159], a[244:247], a[196:199], v[144:159]
    ds_read_b128 a[240:243], v8 offset:7168
    ds_read_b128 v[96:99], v36 offset:2048
    ds_read_b128 v[100:103], v37 offset:2048
    s_waitcnt lgkmcnt(8)
    v_mfma_f32_16x16x32_bf16 v[56:59], v[176:179], a[200:203], v[56:59]
    v_mfma_f32_16x16x32_bf16 v[56:59], v[176:179], a[204:207], v[56:59]
    v_mfma_f32_32x32x16_bf16 v[144:159], a[248:251], a[200:203], v[144:159]
    ds_read_b128 a[244:247], v9 offset:7168
    ds_read_b128 v[104:107], v38 offset:2048
    ds_read_b128 v[108:111], v39 offset:2048
    s_waitcnt lgkmcnt(9)
    v_mfma_f32_16x16x32_bf16 v[56:59], v[176:179], a[208:211], v[56:59]
    v_mfma_f32_16x16x32_bf16 v[56:59], v[176:179], a[212:215], v[56:59]
    v_mfma_f32_32x32x16_bf16 v[144:159], a[252:255], a[204:207], v[144:159]
    ds_read_b128 a[248:251], v10 offset:7168
    ds_read_b128 v[112:115], v36 offset:3072
    ds_read_b128 v[116:119], v37 offset:3072
    s_waitcnt lgkmcnt(9)
    v_mfma_f32_16x16x32_bf16 v[56:59], v[176:179], a[216:219], v[56:59]
    v_mfma_f32_16x16x32_bf16 v[56:59], v[176:179], a[220:223], v[56:59]
    v_mfma_f32_32x32x16_bf16 v[144:159], a[224:227], a[208:211], v[144:159]
    ds_read_b128 a[252:255], v11 offset:7168
    ds_read_b128 v[120:123], v38 offset:3072
    ds_read_b128 v[124:127], v39 offset:3072
    s_waitcnt lgkmcnt(9)
    v_mfma_f32_16x16x32_bf16 v[56:59], v[176:179], v[96:99], v[56:59]
    v_mfma_f32_16x16x32_bf16 v[56:59], v[176:179], v[100:103], v[56:59]
    v_mfma_f32_32x32x16_bf16 v[144:159], a[228:231], a[212:215], v[144:159]
    ds_read_b128 a[224:227], v8 offset:8192
    ds_read_b128 v[128:131], v36 offset:4096
    ds_read_b128 v[132:135], v37 offset:4096
    s_waitcnt lgkmcnt(9)
    v_mfma_f32_16x16x32_bf16 v[56:59], v[176:179], v[104:107], v[56:59]
    v_mfma_f32_16x16x32_bf16 v[56:59], v[176:179], v[108:111], v[56:59]
    v_mfma_f32_32x32x16_bf16 v[144:159], a[232:235], a[216:219], v[144:159]
    ds_read_b128 a[228:231], v9 offset:8192
    ds_read_b128 v[136:139], v38 offset:4096
    ds_read_b128 v[140:143], v39 offset:4096
    s_waitcnt lgkmcnt(9)
    v_mfma_f32_16x16x32_bf16 v[56:59], v[176:179], v[112:115], v[56:59]
    v_mfma_f32_16x16x32_bf16 v[56:59], v[176:179], v[116:119], v[56:59]
    v_mfma_f32_32x32x16_bf16 v[144:159], a[236:239], a[220:223], v[144:159]
    ds_read_b128 a[232:235], v10 offset:8192
    s_waitcnt lgkmcnt(7)
    v_mfma_f32_16x16x32_bf16 v[56:59], v[176:179], v[120:123], v[56:59]
    v_mfma_f32_16x16x32_bf16 v[56:59], v[176:179], v[124:127], v[56:59]
    v_mfma_f32_32x32x16_bf16 v[144:159], a[240:243], v[96:99], v[144:159]
    ds_read_b128 a[236:239], v11 offset:8192
    s_waitcnt lgkmcnt(5)
    v_mfma_f32_16x16x32_bf16 v[56:59], v[176:179], v[128:131], v[56:59]
    v_mfma_f32_16x16x32_bf16 v[56:59], v[176:179], v[132:135], v[56:59]
    v_mfma_f32_32x32x16_bf16 v[144:159], a[244:247], v[100:103], v[144:159]
    ds_read_b128 a[240:243], v8 offset:9216
    s_waitcnt lgkmcnt(3)
    v_mfma_f32_16x16x32_bf16 v[56:59], v[176:179], v[136:139], v[56:59]
    v_mfma_f32_16x16x32_bf16 v[56:59], v[176:179], v[140:143], v[56:59]
    v_mfma_f32_32x32x16_bf16 v[144:159], a[248:251], v[104:107], v[144:159]
    ds_read_b128 a[244:247], v9 offset:9216
    s_waitcnt lgkmcnt(0)
    s_barrier
    s_mov_b32 m0, s86
    v_mfma_f32_32x32x16_bf16 v[144:159], a[252:255], v[108:111], v[144:159]
    ds_read_b128 a[248:251], v10 offset:9216
    s_waitcnt vmcnt(0)
    v_cmp_ne_u32 vcc, v29, v13
    s_cbranch_vccnz Lgrss_10
Lgrsb_11:
    v_and_b32 v29, 0xffff0000, v28
    buffer_load_dwordx4 v40, s[32:35], s85 offen lds
    s_add_u32 m0, s86, 1024
    v_mov_b32 v17, 0
    v_mov_b32 v18, 0
    v_mfma_f32_32x32x16_bf16 v[144:159], a[224:227], v[112:115], v[144:159]
    ds_read_b128 a[252:255], v11 offset:9216
    v_and_b32 v28, 0xffff, v28
    v_rcp_f32 v29, v29
    buffer_load_dwordx4 v41, s[32:35], s85 offen lds
    s_add_u32 m0, s86, 2048
    v_mov_b32 v19, 0
    v_mov_b32 v21, 0
    v_mfma_f32_32x32x16_bf16 v[144:159], a[228:231], v[116:119], v[144:159]
    v_add_u32 v8, 0xffff6000, v8
    v_add_u32 v9, 0xffff6000, v9
    v_lshl_or_b32 v28, v28, 16, v28
    ds_write_b32 v31, v29
    buffer_load_dwordx4 v42, s[32:35], s85 offen lds
    s_add_u32 m0, s86, 3072
    v_mov_b32 v22, 0
    v_mov_b32 v23, 0
    v_mfma_f32_32x32x16_bf16 v[144:159], a[232:235], v[120:123], v[144:159]
    v_add_u32 v10, 0xffff6000, v10
    v_add_u32 v11, 0xffff6000, v11
    ds_write_b32 v31, v28 offset:1024
    buffer_load_dwordx4 v43, s[36:39], s87 offen lds
    s_add_u32 m0, s86, 4096
    s_add_u32 s87, s87, 10240
    v_and_b32 v51, 16, v1
    v_cmp_eq_u32 vcc, 0, v51
    s_nop 1
    v_cndmask_b32 v56, v57, v56, vcc
    v_cvt_pk_bf16_f32 v51, v56, v56
    v_mfma_f32_32x32x16_bf16 v[144:159], a[236:239], v[124:127], v[144:159]
    s_waitcnt lgkmcnt(0)
    s_barrier
    ds_read_b32 v16, v27 offset:0
    ds_read_b128 a[224:227], v8 offset:0
    ds_read_b128 a[228:231], v9 offset:0
    ds_read_b128 a[232:235], v10 offset:0
    buffer_load_dwordx4 v43, s[36:39], s87 offen lds
    s_add_u32 m0, s56, 0
    v_and_b32 v52, 0xffff0000, v51
    v_sub_f32 v52, v56, v52
    v_mfma_f32_32x32x16_bf16 v[144:159], a[240:243], v[128:131], v[144:159]
    ds_read_b128 a[236:239], v11 offset:0
    buffer_load_dwordx4 v24, s[20:23], s53 offen offset:0 lds
    v_cvt_pk_bf16_f32 v51, v56, v52
    v_cndmask_b32 v20, v51, 0, s[82:83]
    v_mfma_f32_32x32x16_bf16 v[144:159], a[244:247], v[132:135], v[144:159]
    ds_read_b128 v[32:35], v0 offset:0
    ds_read_b128 a[240:243], v8 offset:1024
    buffer_load_dwordx4 v25, s[20:23], s53 offen offset:1024 lds
    v_mfma_f32_32x32x16_bf16 v[144:159], a[248:251], v[136:139], v[144:159]
    ds_read_b128 v[36:39], v0 offset:16
    ds_read_b128 v[40:43], v0 offset:32
    ds_read_b128 a[244:247], v9 offset:1024
    buffer_load_dwordx4 v26, s[20:23], s53 offen offset:2048 lds
    v_mfma_f32_32x32x16_bf16 v[144:159], a[252:255], v[140:143], v[144:159]
    ds_read_b128 v[44:47], v0 offset:48
    ds_read_b128 a[248:251], v10 offset:1024
    s_waitcnt lgkmcnt(9)
    v_mfma_f32_32x32x16_bf16 v[144:159], v[16:19], v[20:23], v[144:159]
    v_mfma_f32_32x32x16_bf16 v[56:71], a[224:227], a[112:115], 0
    ds_read_b128 a[252:255], v11 offset:1024
    buffer_load_dwordx4 v12, s[20:23], s53 offen offset:3072 lds
    s_add_u32 m0, s56, 4096
    s_add_u32 s53, s53, 512
    v_mfma_f32_32x32x16_bf16 v[56:71], a[228:231], a[116:119], v[56:71]
    s_waitcnt lgkmcnt(6)
    ds_read_b128 a[224:227], v8 offset:2048
    buffer_load_dwordx4 v24, s[20:23], s53 offen offset:0 lds
    v_mfma_f32_32x32x16_bf16 v[56:71], a[232:235], a[120:123], v[56:71]
    ds_read_b128 a[228:231], v9 offset:2048
    buffer_load_dwordx4 v25, s[20:23], s53 offen offset:1024 lds
    v_mfma_f32_32x32x16_bf16 v[56:71], a[236:239], a[124:127], v[56:71]
    s_waitcnt lgkmcnt(4)
    ds_read_b128 a[232:235], v10 offset:2048
    buffer_load_dwordx4 v26, s[20:23], s53 offen offset:2048 lds
    v_mul_f32 v144, v144, v32
    v_mul_f32 v145, v145, v33
    v_mul_f32 v146, v146, v34
    v_mul_f32_dpp v176, v144, v49 quad_perm:[1,0,3,2] row_mask:0xf bank_mask:0xf
    v_fmac_f32 v176, v48, v144
    v_mul_f32 v147, v147, v35
    v_mul_f32_dpp v177, v145, v49 quad_perm:[1,0,3,2] row_mask:0xf bank_mask:0xf
    v_mfma_f32_32x32x16_bf16 v[56:71], a[240:243], a[128:131], v[56:71]
    s_waitcnt lgkmcnt(3)
    ds_read_b128 a[236:239], v11 offset:2048
    buffer_load_dwordx4 v12, s[20:23], s53 offen offset:3072 lds
    s_add_u32 m0, s56, 8192
    s_add_u32 s53, s53, 512
    v_fmac_f32 v177, v48, v145
    v_mul_f32_dpp v178, v146, v49 quad_perm:[1,0,3,2] row_mask:0xf bank_mask:0xf
    v_fmac_f32 v178, v48, v146
    v_fmac_f32_dpp v177, v176, v240 quad_perm:[1,0,3,2] row_mask:0xf bank_mask:0xf
    v_fmac_f32 v177, v224, v176
    v_mfma_f32_32x32x16_bf16 v[56:71], a[244:247], a[132:135], v[56:71]
    ds_read_b128 a[240:243], v8 offset:3072
    buffer_load_dwordx4 v24, s[20:23], s53 offen offset:0 lds
    v_mul_f32_dpp v179, v147, v49 quad_perm:[1,0,3,2] row_mask:0xf bank_mask:0xf
    v_fmac_f32 v179, v48, v147
    v_mul_f32 v148, v148, v36
    v_fmac_f32_dpp v178, v177, v240 quad_perm:[1,0,3,2] row_mask:0xf bank_mask:0xf
    v_fmac_f32 v178, v224, v177
    v_mul_f32_dpp v180, v148, v49 quad_perm:[1,0,3,2] row_mask:0xf bank_mask:0xf
    v_fmac_f32 v180, v48, v148
    v_mfma_f32_32x32x16_bf16 v[56:71], a[248:251], a[136:139], v[56:71]
    ds_read_b128 a[244:247], v9 offset:3072
    s_waitcnt vmcnt(9)
    ds_read_b64_tr_b16 a[0:1], v4 offset:0
    buffer_load_dwordx4 v25, s[20:23], s53 offen offset:1024 lds
    s_add_u32 m0, s56, 81920
    s_add_u32 s53, s53, 326656
    v_mfma_f32_32x32x16_bf16 v[56:71], a[252:255], a[140:143], v[56:71]
    s_waitcnt lgkmcnt(4)
    ds_read_b128 a[248:251], v10 offset:3072
    ds_read_b64_tr_b16 a[2:3], v4 offset:384
    ds_read_b64_tr_b16 a[4:5], v4 offset:32
    v_mul_f32 v149, v149, v37
    v_fmac_f32_dpp v179, v178, v240 quad_perm:[1,0,3,2] row_mask:0xf bank_mask:0xf
    v_fmac_f32 v179, v224, v178
    v_mul_f32_dpp v181, v149, v49 quad_perm:[1,0,3,2] row_mask:0xf bank_mask:0xf
    v_fmac_f32 v181, v48, v149
    v_mul_f32 v150, v150, v38
    v_fmac_f32_dpp v180, v179, v240 quad_perm:[1,0,3,2] row_mask:0xf bank_mask:0xf
    v_mfma_f32_32x32x16_bf16 v[56:71], a[224:227], a[144:147], v[56:71]
    ds_read_b128 a[252:255], v11 offset:3072
    ds_read_b64_tr_b16 a[6:7], v4 offset:416
    ds_read_b64_tr_b16 a[8:9], v4 offset:64
    v_fmac_f32 v180, v224, v179
    v_mul_f32_dpp v182, v150, v49 quad_perm:[1,0,3,2] row_mask:0xf bank_mask:0xf
    v_fmac_f32 v182, v48, v150
    v_mul_f32 v151, v151, v39
    v_fmac_f32_dpp v181, v180, v240 quad_perm:[1,0,3,2] row_mask:0xf bank_mask:0xf
    v_fmac_f32 v181, v224, v180
    v_mul_f32_dpp v183, v151, v49 quad_perm:[1,0,3,2] row_mask:0xf bank_mask:0xf
    v_mfma_f32_32x32x16_bf16 v[56:71], a[228:231], a[148:151], v[56:71]
    ds_read_b128 a[224:227], v8 offset:4096
    ds_read_b64_tr_b16 a[10:11], v4 offset:448
    ds_read_b128 a[12:15], v5 offset:3072
    v_fmac_f32 v183, v48, v151
    v_mul_f32 v152, v152, v40
    v_fmac_f32_dpp v182, v181, v240 quad_perm:[1,0,3,2] row_mask:0xf bank_mask:0xf
    v_fmac_f32 v182, v224, v181
    v_mul_f32_dpp v184, v152, v49 quad_perm:[1,0,3,2] row_mask:0xf bank_mask:0xf
    v_fmac_f32 v184, v48, v152
    v_mul_f32 v153, v153, v41
    v_mfma_f32_32x32x16_bf16 v[56:71], a[232:235], a[152:155], v[56:71]
    s_waitcnt lgkmcnt(10)
    ds_read_b128 a[228:231], v9 offset:4096
    ds_read_b128 a[16:19], v5 offset:3136
    v_fmac_f32_dpp v183, v182, v240 quad_perm:[1,0,3,2] row_mask:0xf bank_mask:0xf
    v_fmac_f32 v183, v224, v182
    v_mul_f32_dpp v185, v153, v49 quad_perm:[1,0,3,2] row_mask:0xf bank_mask:0xf
    v_fmac_f32 v185, v48, v153
    v_mul_f32 v154, v154, v42
    v_fmac_f32_dpp v184, v183, v240 quad_perm:[1,0,3,2] row_mask:0xf bank_mask:0xf
    v_fmac_f32 v184, v224, v183
    v_mul_f32_dpp v186, v154, v49 quad_perm:[1,0,3,2] row_mask:0xf bank_mask:0xf
    v_mfma_f32_32x32x16_bf16 v[56:71], a[236:239], a[156:159], v[56:71]
    ds_read_b128 a[232:235], v10 offset:4096
    v_fmac_f32 v186, v48, v154
    v_mul_f32 v155, v155, v43
    v_fmac_f32_dpp v185, v184, v240 quad_perm:[1,0,3,2] row_mask:0xf bank_mask:0xf
    v_fmac_f32 v185, v224, v184
    v_mul_f32_dpp v187, v155, v49 quad_perm:[1,0,3,2] row_mask:0xf bank_mask:0xf
    v_fmac_f32 v187, v48, v155
    v_mul_f32 v156, v156, v44
    v_fmac_f32_dpp v186, v185, v240 quad_perm:[1,0,3,2] row_mask:0xf bank_mask:0xf
    v_fmac_f32 v186, v224, v185
    v_mfma_f32_32x32x16_bf16 v[56:71], a[240:243], a[160:163], v[56:71]
    ds_read_b128 a[236:239], v11 offset:4096
    s_waitcnt lgkmcnt(2)
    v_mul_f32_dpp v188, v156, v49 quad_perm:[1,0,3,2] row_mask:0xf bank_mask:0xf
    v_fmac_f32 v188, v48, v156
    v_mul_f32 v157, v157, v45
    v_fmac_f32_dpp v187, v186, v240 quad_perm:[1,0,3,2] row_mask:0xf bank_mask:0xf
    v_fmac_f32 v187, v224, v186
    v_mul_f32_dpp v189, v157, v49 quad_perm:[1,0,3,2] row_mask:0xf bank_mask:0xf
    v_fmac_f32 v189, v48, v157
    v_mul_f32 v158, v158, v46
    v_mfma_f32_32x32x16_bf16 v[56:71], a[244:247], a[164:167], v[56:71]
    ds_read_b128 a[240:243], v8 offset:5120
    buffer_store_dwordx4 a[0:3], v2, s[40:43], s57 offen offset:0 sc1
    v_fmac_f32_dpp v188, v187, v240 quad_perm:[1,0,3,2] row_mask:0xf bank_mask:0xf
    v_fmac_f32 v188, v224, v187
    v_mul_f32_dpp v190, v158, v49 quad_perm:[1,0,3,2] row_mask:0xf bank_mask:0xf
    v_fmac_f32 v190, v48, v158
    v_mfma_f32_32x32x16_bf16 v[56:71], a[248:251], a[168:171], v[56:71]
    ds_read_b128 a[244:247], v9 offset:5120
    buffer_store_dwordx4 a[4:7], v2, s[40:43], s57 offen offset:1024 sc1
    v_mul_f32 v159, v159, v47
    v_fmac_f32_dpp v189, v188, v240 quad_perm:[1,0,3,2] row_mask:0xf bank_mask:0xf
    v_fmac_f32 v189, v224, v188
    v_mul_f32_dpp v191, v159, v49 quad_perm:[1,0,3,2] row_mask:0xf bank_mask:0xf
    v_mfma_f32_32x32x16_bf16 v[56:71], a[252:255], a[172:175], v[56:71]
L_chain1:
L_hk4397:
    s_cbranch_execz L_hk8304
    ds_read_b128 a[248:251], v10 offset:5120
    s_bitcmp1_b32 s15, 0
    s_cselect_b32 s57, 2146435072, s57
    v_fmac_f32 v191, v48, v159
    v_fmac_f32_dpp v190, v189, v240 quad_perm:[1,0,3,2] row_mask:0xf bank_mask:0xf
    v_fmac_f32 v190, v224, v189
    s_nop 1
    v_fmac_f32_dpp v191, v190, v240 quad_perm:[1,0,3,2] row_mask:0xf bank_mask:0xf
    v_fmac_f32 v191, v224, v190
    v_mov_b32 v51, v191
    v_mov_b32 v54, v191
    v_mfma_f32_32x32x16_bf16 v[56:71], a[224:227], a[176:179], v[56:71]
    s_waitcnt lgkmcnt(3)
    ds_read_b128 a[252:255], v11 offset:5120
    buffer_store_dwordx4 a[8:11], v2, s[40:43], s57 offen offset:2048 sc1
    v_permlane32_swap_b32 v51, v54
    v_cndmask_b32 v166, 0, v51, s[82:83]
    v_fmac_f32 v54, v239, v51
    v_mul_f32_dpp v52, v51, v255 quad_perm:[1,0,3,2] row_mask:0xf bank_mask:0xf
    v_add_f32 v54, v54, v52
    v_mfma_f32_32x32x16_bf16 v[56:71], a[228:231], a[180:183], v[56:71]
    ds_read_b128 a[224:227], v8 offset:6144
    buffer_store_dwordx2 v[54:55], v169, s[44:47], s72 offen sc1
    buffer_store_dwordx4 a[12:15], v2, s[40:43], s58 offen sc1
    s_add_u32 s58, s58, 5120
    v_mfma_f32_32x32x16_bf16 v[56:71], a[232:235], a[184:187], v[56:71]
    s_add_u32 s72, s72, 2048
    ds_read_b128 a[228:231], v9 offset:6144
    buffer_store_dwordx4 a[16:19], v2, s[40:43], s58 offen sc1
    v_add_f32 v88, 0x43200000, v94
    v_mfma_f32_32x32x16_bf16 v[56:71], a[236:239], a[188:191], v[56:71]
    s_waitcnt lgkmcnt(3)
    ds_read_b128 a[232:235], v10 offset:6144
    v_mul_f32 v90, v88, v174
    v_mul_f32 v91, v88, v175
    v_exp_f32 v90, v90
    v_fract_f32 v91, v91
    v_cos_f32 v74, v91
    v_mfma_f32_32x32x16_bf16 v[56:71], a[240:243], a[192:195], v[56:71]
    ds_read_b128 a[236:239], v11 offset:6144
    buffer_load_dwordx4 v24, s[20:23], s53 offen offset:0 lds
    v_sin_f32 v78, v91
    v_mul_f32 v74, v90, v74
    v_mul_f32 v78, v90, v78
    v_mfma_f32_32x32x16_bf16 v[56:71], a[244:247], a[196:199], v[56:71]
    ds_read_b128 a[240:243], v8 offset:7168
    buffer_load_dwordx4 v25, s[20:23], s53 offen offset:1024 lds
    v_add_f32 v88, 0xc2c00000, v94
    v_add_f32 v88, v88, v93
    v_mul_f32 v90, v88, v174
    v_mul_f32 v91, v88, v175
    v_mfma_f32_32x32x16_bf16 v[56:71], a[248:251], a[200:203], v[56:71]
    s_waitcnt lgkmcnt(3)
    ds_read_b128 a[244:247], v9 offset:7168
    buffer_load_dwordx4 v26, s[20:23], s53 offen offset:2048 lds
    v_exp_f32 v90, v90
    v_fract_f32 v91, v91
    v_cos_f32 v82, v91
    v_mfma_f32_32x32x16_bf16 v[56:71], a[252:255], a[204:207], v[56:71]
    ds_read_b128 a[248:251], v10 offset:7168
    v_sin_f32 v86, v91
    v_cmp_le_f32 vcc, 0, v88
    s_nop 1
    v_cndmask_b32 v90, 0, v90, vcc
    v_mul_f32 v82, v90, v82
    v_mfma_f32_32x32x16_bf16 v[56:71], a[224:227], a[208:211], v[56:71]
    ds_read_b128 a[252:255], v11 offset:7168
    buffer_load_dwordx4 v12, s[20:23], s53 offen offset:3072 lds
    v_mul_f32 v86, v90, v86
    v_add_f32 v88, 0x43000000, v94
    v_mul_f32 v90, v88, v174
    v_mul_f32 v91, v88, v175
    v_mfma_f32_32x32x16_bf16 v[56:71], a[228:231], a[212:215], v[56:71]
    s_waitcnt lgkmcnt(3)
    s_add_u32 m0, s56, 86016
    ds_read_b128 a[224:227], v8 offset:8192
    v_exp_f32 v90, v90
    v_fract_f32 v91, v91
    v_cos_f32 v75, v91
    v_mfma_f32_32x32x16_bf16 v[56:71], a[232:235], a[216:219], v[56:71]
    s_add_u32 s53, s53, 512
    ds_read_b128 a[228:231], v9 offset:8192
    v_sin_f32 v79, v91
    v_mul_f32 v75, v90, v75
    v_mul_f32 v79, v90, v79
    v_add_f32 v88, 0xc3000000, v94
    v_add_f32 v88, v88, v93
    v_mfma_f32_32x32x16_bf16 v[56:71], a[236:239], a[220:223], v[56:71]
    ds_read_b128 a[232:235], v10 offset:8192
    buffer_load_dwordx4 v24, s[20:23], s53 offen offset:0 lds
    v_mul_f32 v90, v88, v174
    v_mul_f32 v91, v88, v175
    v_exp_f32 v90, v90
    v_mfma_f32_32x32x16_bf16 v[56:71], a[240:243], v[96:99], v[56:71]
    s_waitcnt lgkmcnt(3)
    ds_read_b128 a[236:239], v11 offset:8192
    buffer_load_dwordx4 v25, s[20:23], s53 offen offset:1024 lds
    v_fract_f32 v91, v91
    v_cos_f32 v83, v91
    v_mfma_f32_32x32x16_bf16 v[56:71], a[244:247], v[100:103], v[56:71]
    ds_read_b128 a[240:243], v8 offset:9216
    v_sin_f32 v87, v91
    v_cmp_le_f32 vcc, 0, v88
    s_nop 1
    v_cndmask_b32 v90, 0, v90, vcc
    v_mfma_f32_32x32x16_bf16 v[56:71], a[248:251], v[104:107], v[56:71]
    ds_read_b128 a[244:247], v9 offset:9216
    buffer_load_dwordx4 v26, s[20:23], s53 offen offset:2048 lds
    v_mul_f32 v83, v90, v83
    v_mul_f32 v87, v90, v87
    v_mov_b32 v88, v93
    v_mfma_f32_32x32x16_bf16 v[56:71], a[252:255], v[108:111], v[56:71]
    s_waitcnt lgkmcnt(3)
    ds_read_b128 a[248:251], v10 offset:9216
    buffer_load_dwordx4 v12, s[20:23], s53 offen offset:3072 lds
    v_mul_f32 v90, v88, v174
    v_mul_f32 v91, v88, v175
    v_exp_f32 v90, v90
    v_mfma_f32_32x32x16_bf16 v[56:71], a[224:227], v[112:115], v[56:71]
    s_add_u32 m0, s56, 90112
    ds_read_b128 a[252:255], v11 offset:9216
    v_fract_f32 v91, v91
    v_cos_f32 v160, v91
    v_sin_f32 v161, v91
    v_mul_f32 v160, v90, v160
    v_mfma_f32_32x32x16_bf16 v[56:71], a[228:231], v[116:119], v[56:71]
    s_add_u32 s53, s53, 512
    v_add_u32 v8, 0xffff6000, v8
    v_add_u32 v9, 0xffff6000, v9
    v_mul_f32 v161, v90, v161
    v_mov_b32 v88, 0x43800000
    v_mul_f32 v90, v88, v174
    v_mul_f32 v91, v88, v175
    v_mfma_f32_32x32x16_bf16 v[56:71], a[232:235], v[120:123], v[56:71]
    s_waitcnt lgkmcnt(2)
    buffer_load_dwordx4 v24, s[20:23], s53 offen offset:0 lds
    v_add_u32 v10, 0xffff6000, v10
    v_add_u32 v11, 0xffff6000, v11
    v_exp_f32 v90, v90
    v_fract_f32 v91, v91
    v_mfma_f32_32x32x16_bf16 v[56:71], a[236:239], v[124:127], v[56:71]
    s_waitcnt vmcnt(15) lgkmcnt(0)
    s_barrier
    ds_read_b32 v16, v27 offset:128
    ds_read_b128 a[224:227], v8 offset:0
    ds_read_b128 a[228:231], v9 offset:0
    ds_read_b128 a[232:235], v10 offset:0
    v_cos_f32 v162, v91
    v_mfma_f32_32x32x16_bf16 v[56:71], a[240:243], v[128:131], v[56:71]
    ds_read_b128 v[32:35], v0 offset:128
    ds_read_b128 a[236:239], v11 offset:0
    buffer_load_dwordx4 v25, s[20:23], s53 offen offset:1024 lds
    v_sin_f32 v163, v91
    v_mul_f32 v162, v90, v162
    v_mfma_f32_32x32x16_bf16 v[56:71], a[244:247], v[132:135], v[56:71]
    s_add_u32 m0, s56, 40960
    ds_read_b128 v[36:39], v0 offset:144
    ds_read_b128 a[240:243], v8 offset:1024
    v_mul_f32 v163, v90, v163
    v_mul_f32 v88, 0x41800000, v92
    v_mul_f32 v90, v88, v174
    v_mul_f32 v91, v88, v175
    v_mfma_f32_32x32x16_bf16 v[56:71], a[248:251], v[136:139], v[56:71]
    s_add_u32 s53, s53, 326656
    ds_read_b128 v[40:43], v0 offset:160
    ds_read_b128 a[244:247], v9 offset:1024
    v_exp_f32 v90, v90
    v_fract_f32 v91, v91
    v_cos_f32 v164, v91
    v_mfma_f32_32x32x16_bf16 v[56:71], a[252:255], v[140:143], v[56:71]
    ds_read_b128 v[44:47], v0 offset:176
    ds_read_b128 a[248:251], v10 offset:1024
    s_waitcnt lgkmcnt(9)
    v_sin_f32 v165, v91
    v_mul_f32 v164, v90, v164
    v_mul_f32 v165, v90, v165
    v_mfma_f32_32x32x16_bf16 v[56:71], v[16:19], v[20:23], v[56:71]
    v_mfma_f32_32x32x16_bf16 v[144:159], a[224:227], a[112:115], 0
    ds_read_b128 a[252:255], v11 offset:1024
    buffer_load_dwordx4 v24, s[20:23], s53 offen offset:0 lds
    v_mfma_f32_32x32x16_bf16 v[144:159], a[228:231], a[116:119], v[144:159]
    s_waitcnt lgkmcnt(5)
    ds_read_b128 a[224:227], v8 offset:2048
    s_waitcnt vmcnt(11)
    buffer_store_dword v13, v3, s[28:31], s51 offen sc1
    v_mfma_f32_32x32x16_bf16 v[144:159], a[232:235], a[120:123], v[144:159]
    ds_read_b128 a[228:231], v9 offset:2048
    v_mfma_f32_32x32x16_bf16 v[144:159], a[236:239], a[124:127], v[144:159]
    s_waitcnt lgkmcnt(4)
    ds_read_b128 a[232:235], v10 offset:2048
    buffer_load_dwordx4 v25, s[20:23], s53 offen offset:1024 lds
    v_mul_f32 v56, v56, v32
    v_mul_f32 v57, v57, v33
    v_mfma_f32_32x32x16_bf16 v[144:159], a[240:243], a[128:131], v[144:159]
    s_waitcnt lgkmcnt(3)
    ds_read_b128 a[236:239], v11 offset:2048
    v_mul_f32 v58, v58, v34
    v_mul_f32_dpp v192, v56, v49 quad_perm:[1,0,3,2] row_mask:0xf bank_mask:0xf
    v_fmac_f32 v192, v48, v56
    v_mul_f32 v59, v59, v35
    v_mfma_f32_32x32x16_bf16 v[144:159], a[244:247], a[132:135], v[144:159]
    ds_read_b128 a[240:243], v8 offset:3072
    v_mul_f32_dpp v193, v57, v49 quad_perm:[1,0,3,2] row_mask:0xf bank_mask:0xf
    v_fmac_f32 v193, v48, v57
    v_mul_f32_dpp v194, v58, v49 quad_perm:[1,0,3,2] row_mask:0xf bank_mask:0xf
    v_fmac_f32 v194, v48, v58
    v_mfma_f32_32x32x16_bf16 v[144:159], a[248:251], a[136:139], v[144:159]
    ds_read_b128 a[244:247], v9 offset:3072
    buffer_load_dwordx4 v26, s[20:23], s53 offen offset:2048 lds
    v_fmac_f32_dpp v193, v192, v240 quad_perm:[1,0,3,2] row_mask:0xf bank_mask:0xf
    v_fmac_f32 v193, v224, v192
    v_mfma_f32_32x32x16_bf16 v[144:159], a[252:255], a[140:143], v[144:159]
    s_waitcnt lgkmcnt(3)
    ds_read_b128 a[248:251], v10 offset:3072
    v_mul_f32_dpp v195, v59, v49 quad_perm:[1,0,3,2] row_mask:0xf bank_mask:0xf
    v_fmac_f32 v195, v48, v59
    v_mul_f32 v60, v60, v36
    v_fmac_f32_dpp v194, v193, v240 quad_perm:[1,0,3,2] row_mask:0xf bank_mask:0xf
    v_mfma_f32_32x32x16_bf16 v[144:159], a[224:227], a[144:147], v[144:159]
    ds_read_b128 a[252:255], v11 offset:3072
    buffer_load_dwordx4 v12, s[20:23], s53 offen offset:3072 lds
    v_fmac_f32 v194, v224, v193
    v_mul_f32_dpp v196, v60, v49 quad_perm:[1,0,3,2] row_mask:0xf bank_mask:0xf
    v_mfma_f32_32x32x16_bf16 v[144:159], a[228:231], a[148:151], v[144:159]
    ds_read_b128 a[224:227], v8 offset:4096
    v_fmac_f32 v196, v48, v60
    v_mul_f32 v61, v61, v37
    v_fmac_f32_dpp v195, v194, v240 quad_perm:[1,0,3,2] row_mask:0xf bank_mask:0xf
    v_fmac_f32 v195, v224, v194
    v_mfma_f32_32x32x16_bf16 v[144:159], a[232:235], a[152:155], v[144:159]
    s_waitcnt lgkmcnt(3)
    s_add_u32 m0, s56, 45056
    ds_read_b128 a[228:231], v9 offset:4096
    v_mul_f32_dpp v197, v61, v49 quad_perm:[1,0,3,2] row_mask:0xf bank_mask:0xf
    v_fmac_f32 v197, v48, v61
    v_mul_f32 v62, v62, v38
    v_mfma_f32_32x32x16_bf16 v[144:159], a[236:239], a[156:159], v[144:159]
    ds_read_b128 a[232:235], v10 offset:4096
    v_fmac_f32_dpp v196, v195, v240 quad_perm:[1,0,3,2] row_mask:0xf bank_mask:0xf
    v_fmac_f32 v196, v224, v195
    v_mul_f32_dpp v198, v62, v49 quad_perm:[1,0,3,2] row_mask:0xf bank_mask:0xf
    v_mfma_f32_32x32x16_bf16 v[144:159], a[240:243], a[160:163], v[144:159]
    ds_read_b128 a[236:239], v11 offset:4096
    v_fmac_f32 v198, v48, v62
    v_mul_f32 v63, v63, v39
    v_fmac_f32_dpp v197, v196, v240 quad_perm:[1,0,3,2] row_mask:0xf bank_mask:0xf
    v_fmac_f32 v197, v224, v196
    v_mfma_f32_32x32x16_bf16 v[144:159], a[244:247], a[164:167], v[144:159]
    s_waitcnt lgkmcnt(3)
    s_add_u32 s53, s53, 512
    ds_read_b128 a[240:243], v8 offset:5120
    v_mul_f32_dpp v199, v63, v49 quad_perm:[1,0,3,2] row_mask:0xf bank_mask:0xf
    v_fmac_f32 v199, v48, v63
    v_mul_f32 v64, v64, v40
    v_mfma_f32_32x32x16_bf16 v[144:159], a[248:251], a[168:171], v[144:159]
    ds_read_b128 a[244:247], v9 offset:5120
    v_fmac_f32_dpp v198, v197, v240 quad_perm:[1,0,3,2] row_mask:0xf bank_mask:0xf
    v_fmac_f32 v198, v224, v197
    v_mul_f32_dpp v200, v64, v49 quad_perm:[1,0,3,2] row_mask:0xf bank_mask:0xf
    v_fmac_f32 v200, v48, v64
    v_mfma_f32_32x32x16_bf16 v[144:159], a[252:255], a[172:175], v[144:159]
    ds_read_b128 a[248:251], v10 offset:5120
    buffer_load_dwordx4 v24, s[20:23], s53 offen offset:0 lds
    v_mul_f32 v65, v65, v41
    v_fmac_f32_dpp v199, v198, v240 quad_perm:[1,0,3,2] row_mask:0xf bank_mask:0xf
    v_mfma_f32_32x32x16_bf16 v[144:159], a[224:227], a[176:179], v[144:159]
    s_waitcnt lgkmcnt(3)
    ds_read_b128 a[252:255], v11 offset:5120
    v_fmac_f32 v199, v224, v198
    v_mul_f32_dpp v201, v65, v49 quad_perm:[1,0,3,2] row_mask:0xf bank_mask:0xf
    v_fmac_f32 v201, v48, v65
    v_mul_f32 v66, v66, v42
    v_mfma_f32_32x32x16_bf16 v[144:159], a[228:231], a[180:183], v[144:159]
    ds_read_b128 a[224:227], v8 offset:6144
    v_fmac_f32_dpp v200, v199, v240 quad_perm:[1,0,3,2] row_mask:0xf bank_mask:0xf
    v_fmac_f32 v200, v224, v199
    v_mul_f32_dpp v202, v66, v49 quad_perm:[1,0,3,2] row_mask:0xf bank_mask:0xf
    v_fmac_f32 v202, v48, v66
    v_mfma_f32_32x32x16_bf16 v[144:159], a[232:235], a[184:187], v[144:159]
    ds_read_b128 a[228:231], v9 offset:6144
    buffer_load_dwordx4 v25, s[20:23], s53 offen offset:1024 lds
    v_mul_f32 v67, v67, v43
    v_fmac_f32_dpp v201, v200, v240 quad_perm:[1,0,3,2] row_mask:0xf bank_mask:0xf
    v_mfma_f32_32x32x16_bf16 v[144:159], a[236:239], a[188:191], v[144:159]
    s_waitcnt lgkmcnt(3)
    ds_read_b128 a[232:235], v10 offset:6144
    v_fmac_f32 v201, v224, v200
    v_mul_f32_dpp v203, v67, v49 quad_perm:[1,0,3,2] row_mask:0xf bank_mask:0xf
    v_fmac_f32 v203, v48, v67
    v_mul_f32 v68, v68, v44
    v_mfma_f32_32x32x16_bf16 v[144:159], a[240:243], a[192:195], v[144:159]
    ds_read_b128 a[236:239], v11 offset:6144
    buffer_load_dwordx4 v26, s[20:23], s53 offen offset:2048 lds
    v_fmac_f32_dpp v202, v201, v240 quad_perm:[1,0,3,2] row_mask:0xf bank_mask:0xf
    v_fmac_f32 v202, v224, v201
    v_mfma_f32_32x32x16_bf16 v[144:159], a[244:247], a[196:199], v[144:159]
    ds_read_b128 a[240:243], v8 offset:7168
    v_mul_f32_dpp v204, v68, v49 quad_perm:[1,0,3,2] row_mask:0xf bank_mask:0xf
    v_fmac_f32 v204, v48, v68
    v_mul_f32 v69, v69, v45
    v_fmac_f32_dpp v203, v202, v240 quad_perm:[1,0,3,2] row_mask:0xf bank_mask:0xf
    v_mfma_f32_32x32x16_bf16 v[144:159], a[248:251], a[200:203], v[144:159]
    s_waitcnt lgkmcnt(3)
    ds_read_b128 a[244:247], v9 offset:7168
    v_fmac_f32 v203, v224, v202
    v_mul_f32_dpp v205, v69, v49 quad_perm:[1,0,3,2] row_mask:0xf bank_mask:0xf
    v_fmac_f32 v205, v48, v69
    v_mul_f32 v70, v70, v46
    v_mfma_f32_32x32x16_bf16 v[144:159], a[252:255], a[204:207], v[144:159]
    ds_read_b128 a[248:251], v10 offset:7168
    buffer_load_dwordx4 v12, s[20:23], s53 offen offset:3072 lds
    v_fmac_f32_dpp v204, v203, v240 quad_perm:[1,0,3,2] row_mask:0xf bank_mask:0xf
    v_fmac_f32 v204, v224, v203
    v_mfma_f32_32x32x16_bf16 v[144:159], a[224:227], a[208:211], v[144:159]
    ds_read_b128 a[252:255], v11 offset:7168
    v_mul_f32_dpp v206, v70, v49 quad_perm:[1,0,3,2] row_mask:0xf bank_mask:0xf
    v_fmac_f32 v206, v48, v70
    v_mul_f32 v71, v71, v47
    v_fmac_f32_dpp v205, v204, v240 quad_perm:[1,0,3,2] row_mask:0xf bank_mask:0xf
    v_mfma_f32_32x32x16_bf16 v[144:159], a[228:231], a[212:215], v[144:159]
    s_waitcnt lgkmcnt(3)
    s_add_u32 m0, s56, 49152
    ds_read_b128 a[224:227], v8 offset:8192
    v_fmac_f32 v205, v224, v204
    v_mul_f32_dpp v207, v71, v49 quad_perm:[1,0,3,2] row_mask:0xf bank_mask:0xf
    v_fmac_f32 v207, v48, v71
    v_mfma_f32_32x32x16_bf16 v[144:159], a[232:235], a[216:219], v[144:159]
    ds_read_b128 a[228:231], v9 offset:8192
    v_fmac_f32_dpp v206, v205, v240 quad_perm:[1,0,3,2] row_mask:0xf bank_mask:0xf
    v_fmac_f32 v206, v224, v205
    s_nop 1
    v_fmac_f32_dpp v207, v206, v240 quad_perm:[1,0,3,2] row_mask:0xf bank_mask:0xf
    v_fmac_f32 v207, v224, v206
    v_mfma_f32_32x32x16_bf16 v[144:159], a[236:239], a[220:223], v[144:159]
    ds_read_b128 a[232:235], v10 offset:8192
    v_mov_b32 v51, v207
    v_mov_b32 v54, v207
    s_nop 1
    v_permlane32_swap_b32 v51, v54
    v_cndmask_b32 v167, 0, v51, s[82:83]
    v_mfma_f32_32x32x16_bf16 v[144:159], a[240:243], v[96:99], v[144:159]
    s_waitcnt lgkmcnt(3)
    s_add_u32 s53, s53, 512
    ds_read_b128 a[236:239], v11 offset:8192
    v_fmac_f32 v54, v239, v51
    v_mul_f32_dpp v52, v51, v255 quad_perm:[1,0,3,2] row_mask:0xf bank_mask:0xf
    v_add_f32 v54, v54, v52
    v_mfma_f32_32x32x16_bf16 v[144:159], a[244:247], v[100:103], v[144:159]
    ds_read_b128 a[240:243], v8 offset:9216
    buffer_store_dwordx2 v[54:55], v169, s[44:47], s72 offen sc1
    v_mfma_f32_32x32x16_bf16 v[144:159], a[248:251], v[104:107], v[144:159]
    s_add_u32 s72, s72, 2048
    ds_read_b128 a[244:247], v9 offset:9216
    buffer_load_dwordx4 v24, s[20:23], s53 offen offset:0 lds
    v_mfma_f32_32x32x16_bf16 v[144:159], a[252:255], v[108:111], v[144:159]
    s_waitcnt lgkmcnt(3)
    ds_read_b128 a[248:251], v10 offset:9216
    buffer_load_dwordx2 v[88:89], v170, s[44:47], s73 offen offset:0 sc1
    v_mfma_f32_32x32x16_bf16 v[144:159], a[224:227], v[112:115], v[144:159]
    ds_read_b128 a[252:255], v11 offset:9216
    buffer_load_dwordx4 v25, s[20:23], s53 offen offset:1024 lds
    v_mfma_f32_32x32x16_bf16 v[144:159], a[228:231], v[116:119], v[144:159]
    buffer_load_dwordx2 v[90:91], v170, s[44:47], s73 offen offset:256 sc1
    v_add_u32 v8, 0x14000, v8
    v_add_u32 v9, 0x14000, v9
    v_mfma_f32_32x32x16_bf16 v[144:159], a[232:235], v[120:123], v[144:159]
    s_waitcnt lgkmcnt(2)
    buffer_load_dwordx2 v[92:93], v170, s[44:47], s73 offen offset:512 sc1
    v_add_u32 v10, 0x14000, v10
    v_add_u32 v11, 0x14000, v11
    v_mfma_f32_32x32x16_bf16 v[144:159], a[236:239], v[124:127], v[144:159]
    s_waitcnt vmcnt(15) lgkmcnt(0)
    s_barrier
    s_add_u32 m0, s56, 0
    ds_read_b32 v16, v27 offset:256
    ds_read_b128 a[224:227], v8 offset:0
    ds_read_b128 a[228:231], v9 offset:0
    ds_read_b128 a[232:235], v10 offset:0
    v_mfma_f32_32x32x16_bf16 v[144:159], a[240:243], v[128:131], v[144:159]
    ds_read_b128 v[32:35], v0 offset:256
    ds_read_b128 a[236:239], v11 offset:0
    v_mfma_f32_32x32x16_bf16 v[144:159], a[244:247], v[132:135], v[144:159]
    s_add_u32 s53, s53, 326656
    ds_read_b128 v[36:39], v0 offset:272
    ds_read_b128 a[240:243], v8 offset:1024
    v_mfma_f32_32x32x16_bf16 v[144:159], a[248:251], v[136:139], v[144:159]
    ds_read_b128 v[40:43], v0 offset:288
    ds_read_b128 a[244:247], v9 offset:1024
    buffer_load_dwordx2 v[94:95], v170, s[44:47], s73 offen offset:768 sc1
    v_mfma_f32_32x32x16_bf16 v[144:159], a[252:255], v[140:143], v[144:159]
    ds_read_b128 v[44:47], v0 offset:304
    ds_read_b128 a[248:251], v10 offset:1024
    s_waitcnt lgkmcnt(9)
    v_mfma_f32_32x32x16_bf16 v[144:159], v[16:19], v[20:23], v[144:159]
    v_mfma_f32_32x32x16_bf16 v[56:71], a[224:227], a[112:115], 0
    ds_read_b128 a[252:255], v11 offset:1024
    v_mfma_f32_32x32x16_bf16 v[56:71], a[228:231], a[116:119], v[56:71]
    s_waitcnt lgkmcnt(5)
    ds_read_b128 a[224:227], v8 offset:2048
    buffer_load_dwordx4 v24, s[20:23], s53 offen offset:0 lds
    v_mfma_f32_32x32x16_bf16 v[56:71], a[232:235], a[120:123], v[56:71]
    ds_read_b128 a[228:231], v9 offset:2048
    v_mfma_f32_32x32x16_bf16 v[56:71], a[236:239], a[124:127], v[56:71]
    s_waitcnt lgkmcnt(4)
    ds_read_b128 a[232:235], v10 offset:2048
    buffer_load_dwordx4 v25, s[20:23], s53 offen offset:1024 lds
    v_mul_f32 v144, v144, v32
    v_mul_f32 v145, v145, v33
    v_mul_f32 v146, v146, v34
    v_mul_f32_dpp v208, v144, v49 quad_perm:[1,0,3,2] row_mask:0xf bank_mask:0xf
    v_mfma_f32_32x32x16_bf16 v[56:71], a[240:243], a[128:131], v[56:71]
    s_waitcnt lgkmcnt(3)
    ds_read_b128 a[236:239], v11 offset:2048
    v_fmac_f32 v208, v48, v144
    v_mul_f32 v147, v147, v35
    v_mul_f32_dpp v209, v145, v49 quad_perm:[1,0,3,2] row_mask:0xf bank_mask:0xf
    v_fmac_f32 v209, v48, v145
    v_mul_f32_dpp v210, v146, v49 quad_perm:[1,0,3,2] row_mask:0xf bank_mask:0xf
    v_mfma_f32_32x32x16_bf16 v[56:71], a[244:247], a[132:135], v[56:71]
    ds_read_b128 a[240:243], v8 offset:3072
    v_fmac_f32 v210, v48, v146
    v_fmac_f32_dpp v209, v208, v240 quad_perm:[1,0,3,2] row_mask:0xf bank_mask:0xf
    v_fmac_f32 v209, v224, v208
    v_mul_f32_dpp v211, v147, v49 quad_perm:[1,0,3,2] row_mask:0xf bank_mask:0xf
    v_fmac_f32 v211, v48, v147
    v_mfma_f32_32x32x16_bf16 v[56:71], a[248:251], a[136:139], v[56:71]
    ds_read_b128 a[244:247], v9 offset:3072
    buffer_load_dwordx4 v26, s[20:23], s53 offen offset:2048 lds
    v_mul_f32 v148, v148, v36
    v_fmac_f32_dpp v210, v209, v240 quad_perm:[1,0,3,2] row_mask:0xf bank_mask:0xf
    v_fmac_f32 v210, v224, v209
    v_mfma_f32_32x32x16_bf16 v[56:71], a[252:255], a[140:143], v[56:71]
    s_waitcnt lgkmcnt(3)
    ds_read_b128 a[248:251], v10 offset:3072
    v_mul_f32_dpp v212, v148, v49 quad_perm:[1,0,3,2] row_mask:0xf bank_mask:0xf
    v_fmac_f32 v212, v48, v148
    v_mul_f32 v149, v149, v37
    v_fmac_f32_dpp v211, v210, v240 quad_perm:[1,0,3,2] row_mask:0xf bank_mask:0xf
    v_fmac_f32 v211, v224, v210
    v_mfma_f32_32x32x16_bf16 v[56:71], a[224:227], a[144:147], v[56:71]
    ds_read_b128 a[252:255], v11 offset:3072
    buffer_load_dwordx4 v12, s[20:23], s53 offen offset:3072 lds
    v_mul_f32_dpp v213, v149, v49 quad_perm:[1,0,3,2] row_mask:0xf bank_mask:0xf
    v_fmac_f32 v213, v48, v149
    v_mul_f32 v150, v150, v38
    v_mfma_f32_32x32x16_bf16 v[56:71], a[228:231], a[148:151], v[56:71]
    ds_read_b128 a[224:227], v8 offset:4096
    v_fmac_f32_dpp v212, v211, v240 quad_perm:[1,0,3,2] row_mask:0xf bank_mask:0xf
    v_fmac_f32 v212, v224, v211
    v_mul_f32_dpp v214, v150, v49 quad_perm:[1,0,3,2] row_mask:0xf bank_mask:0xf
    v_fmac_f32 v214, v48, v150
    v_mul_f32 v151, v151, v39
    v_mfma_f32_32x32x16_bf16 v[56:71], a[232:235], a[152:155], v[56:71]
    s_waitcnt lgkmcnt(3)
    s_add_u32 m0, s56, 4096
    ds_read_b128 a[228:231], v9 offset:4096
    v_fmac_f32_dpp v213, v212, v240 quad_perm:[1,0,3,2] row_mask:0xf bank_mask:0xf
    v_fmac_f32 v213, v224, v212
    v_mul_f32_dpp v215, v151, v49 quad_perm:[1,0,3,2] row_mask:0xf bank_mask:0xf
    v_fmac_f32 v215, v48, v151
    v_mfma_f32_32x32x16_bf16 v[56:71], a[236:239], a[156:159], v[56:71]
    ds_read_b128 a[232:235], v10 offset:4096
    v_mul_f32 v152, v152, v40
    v_fmac_f32_dpp v214, v213, v240 quad_perm:[1,0,3,2] row_mask:0xf bank_mask:0xf
    v_fmac_f32 v214, v224, v213
    v_mul_f32_dpp v216, v152, v49 quad_perm:[1,0,3,2] row_mask:0xf bank_mask:0xf
    v_fmac_f32 v216, v48, v152
    v_mfma_f32_32x32x16_bf16 v[56:71], a[240:243], a[160:163], v[56:71]
    ds_read_b128 a[236:239], v11 offset:4096
    v_mul_f32 v153, v153, v41
    v_fmac_f32_dpp v215, v214, v240 quad_perm:[1,0,3,2] row_mask:0xf bank_mask:0xf
    v_fmac_f32 v215, v224, v214
    v_mul_f32_dpp v217, v153, v49 quad_perm:[1,0,3,2] row_mask:0xf bank_mask:0xf
    v_fmac_f32 v217, v48, v153
    v_mfma_f32_32x32x16_bf16 v[56:71], a[244:247], a[164:167], v[56:71]
    s_waitcnt lgkmcnt(3)
    s_add_u32 s53, s53, 512
    ds_read_b128 a[240:243], v8 offset:5120
    v_mul_f32 v154, v154, v42
    v_fmac_f32_dpp v216, v215, v240 quad_perm:[1,0,3,2] row_mask:0xf bank_mask:0xf
    v_fmac_f32 v216, v224, v215
    v_mul_f32_dpp v218, v154, v49 quad_perm:[1,0,3,2] row_mask:0xf bank_mask:0xf
    v_mfma_f32_32x32x16_bf16 v[56:71], a[248:251], a[168:171], v[56:71]
    ds_read_b128 a[244:247], v9 offset:5120
    v_fmac_f32 v218, v48, v154
    v_mul_f32 v155, v155, v43
    v_fmac_f32_dpp v217, v216, v240 quad_perm:[1,0,3,2] row_mask:0xf bank_mask:0xf
    v_fmac_f32 v217, v224, v216
    v_mul_f32_dpp v219, v155, v49 quad_perm:[1,0,3,2] row_mask:0xf bank_mask:0xf
    v_mfma_f32_32x32x16_bf16 v[56:71], a[252:255], a[172:175], v[56:71]
    ds_read_b128 a[248:251], v10 offset:5120
    buffer_load_dwordx4 v24, s[20:23], s53 offen offset:0 lds
    v_fmac_f32 v219, v48, v155
    v_mul_f32 v156, v156, v44
    v_fmac_f32_dpp v218, v217, v240 quad_perm:[1,0,3,2] row_mask:0xf bank_mask:0xf
    v_fmac_f32 v218, v224, v217
    v_mfma_f32_32x32x16_bf16 v[56:71], a[224:227], a[176:179], v[56:71]
    s_waitcnt lgkmcnt(3)
    ds_read_b128 a[252:255], v11 offset:5120
    v_mul_f32_dpp v220, v156, v49 quad_perm:[1,0,3,2] row_mask:0xf bank_mask:0xf
    v_fmac_f32 v220, v48, v156
    v_mul_f32 v157, v157, v45
    v_fmac_f32_dpp v219, v218, v240 quad_perm:[1,0,3,2] row_mask:0xf bank_mask:0xf
    v_fmac_f32 v219, v224, v218
    v_mfma_f32_32x32x16_bf16 v[56:71], a[228:231], a[180:183], v[56:71]
    ds_read_b128 a[224:227], v8 offset:6144
    v_mul_f32_dpp v221, v157, v49 quad_perm:[1,0,3,2] row_mask:0xf bank_mask:0xf
    v_fmac_f32 v221, v48, v157
    v_mul_f32 v158, v158, v46
    v_fmac_f32_dpp v220, v219, v240 quad_perm:[1,0,3,2] row_mask:0xf bank_mask:0xf
    v_fmac_f32 v220, v224, v219
    v_mfma_f32_32x32x16_bf16 v[56:71], a[232:235], a[184:187], v[56:71]
    ds_read_b128 a[228:231], v9 offset:6144
    buffer_load_dwordx4 v25, s[20:23], s53 offen offset:1024 lds
    v_mul_f32_dpp v222, v158, v49 quad_perm:[1,0,3,2] row_mask:0xf bank_mask:0xf
    v_fmac_f32 v222, v48, v158
    v_mul_f32 v159, v159, v47
    v_fmac_f32_dpp v221, v220, v240 quad_perm:[1,0,3,2] row_mask:0xf bank_mask:0xf
    v_mfma_f32_32x32x16_bf16 v[56:71], a[236:239], a[188:191], v[56:71]
    s_waitcnt lgkmcnt(3)
    ds_read_b128 a[232:235], v10 offset:6144
    v_fmac_f32 v221, v224, v220
    v_mul_f32_dpp v223, v159, v49 quad_perm:[1,0,3,2] row_mask:0xf bank_mask:0xf
    v_fmac_f32 v223, v48, v159
    v_fmac_f32_dpp v222, v221, v240 quad_perm:[1,0,3,2] row_mask:0xf bank_mask:0xf
    v_fmac_f32 v222, v224, v221
    v_mfma_f32_32x32x16_bf16 v[56:71], a[240:243], a[192:195], v[56:71]
    ds_read_b128 a[236:239], v11 offset:6144
    buffer_load_dwordx4 v26, s[20:23], s53 offen offset:2048 lds
    v_fmac_f32_dpp v223, v222, v240 quad_perm:[1,0,3,2] row_mask:0xf bank_mask:0xf
    v_fmac_f32 v223, v224, v222
    v_mov_b32 v51, v223
    v_mov_b32 v54, v223
    v_mfma_f32_32x32x16_bf16 v[56:71], a[244:247], a[196:199], v[56:71]
    ds_read_b128 a[240:243], v8 offset:7168
    v_permlane32_swap_b32 v51, v54
    v_cndmask_b32 v168, 0, v51, s[82:83]
    v_fmac_f32 v54, v239, v51
    v_mul_f32_dpp v52, v51, v255 quad_perm:[1,0,3,2] row_mask:0xf bank_mask:0xf
    v_add_f32 v54, v54, v52
    v_mfma_f32_32x32x16_bf16 v[56:71], a[248:251], a[200:203], v[56:71]
    s_waitcnt lgkmcnt(3)
    ds_read_b128 a[244:247], v9 offset:7168
    buffer_store_dwordx2 v[54:55], v169, s[44:47], s72 offen sc1
    s_add_u32 s72, s72, 2048
    s_waitcnt vmcnt(8)
    v_xor_b32 v89, v89, v13
    v_xor_b32 v91, v91, v13
    v_xor_b32 v93, v93, v13
    v_xor_b32 v95, v95, v13
    v_or3_b32 v89, v89, v91, v93
    v_or_b32 v89, v89, v95
    v_cmp_ne_u32 vcc, 0, v89
    s_cbranch_vccnz Laggs_12
Laggb_13:
    v_mfma_f32_32x32x16_bf16 v[56:71], a[252:255], a[204:207], v[56:71]
    s_add_u32 s73, s73, 0
    ds_read_b128 a[248:251], v10 offset:7168
    buffer_load_dwordx4 v12, s[20:23], s53 offen offset:3072 lds
    v_mul_f32_dpp v89, v88, v76 quad_perm:[1,0,3,2] row_mask:0xf bank_mask:0xf
    v_mul_f32_dpp v93, v88, v84 quad_perm:[1,0,3,2] row_mask:0xf bank_mask:0xf
    v_mul_f32 v91, v72, v88
    v_mfma_f32_32x32x16_bf16 v[56:71], a[224:227], a[208:211], v[56:71]
    ds_read_b128 a[252:255], v11 offset:7168
    v_mul_f32 v95, v80, v88
    v_fmac_f32_dpp v89, v90, v77 quad_perm:[1,0,3,2] row_mask:0xf bank_mask:0xf
    v_fmac_f32_dpp v93, v90, v85 quad_perm:[1,0,3,2] row_mask:0xf bank_mask:0xf
    v_fmac_f32 v91, v73, v90
    v_fmac_f32 v95, v81, v90
    v_mfma_f32_32x32x16_bf16 v[56:71], a[228:231], a[212:215], v[56:71]
    s_waitcnt lgkmcnt(3)
    s_add_u32 m0, s56, 8192
    ds_read_b128 a[224:227], v8 offset:8192
    v_fmac_f32_dpp v89, v92, v78 quad_perm:[1,0,3,2] row_mask:0xf bank_mask:0xf
    v_fmac_f32_dpp v93, v92, v86 quad_perm:[1,0,3,2] row_mask:0xf bank_mask:0xf
    v_fmac_f32 v91, v74, v92
    v_fmac_f32 v95, v82, v92
    v_mfma_f32_32x32x16_bf16 v[56:71], a[232:235], a[216:219], v[56:71]
    ds_read_b128 a[228:231], v9 offset:8192
    v_fmac_f32_dpp v89, v94, v79 quad_perm:[1,0,3,2] row_mask:0xf bank_mask:0xf
    v_fmac_f32_dpp v93, v94, v87 quad_perm:[1,0,3,2] row_mask:0xf bank_mask:0xf
    v_fmac_f32 v91, v75, v94
    v_fmac_f32 v95, v83, v94
    v_add_f32 v89, v89, v91
    v_mfma_f32_32x32x16_bf16 v[56:71], a[236:239], a[220:223], v[56:71]
    ds_read_b128 a[232:235], v10 offset:8192
    v_add_f32 v93, v93, v95
    v_mov_b32 v91, v89
    v_mov_b32 v95, v93
    v_mul_f32_dpp v51, v53, v161 quad_perm:[1,0,3,2] row_mask:0xf bank_mask:0xf
    v_mul_f32_dpp v52, v53, v163 quad_perm:[1,0,3,2] row_mask:0xf bank_mask:0xf
    v_mfma_f32_32x32x16_bf16 v[56:71], a[240:243], v[96:99], v[56:71]
    s_waitcnt lgkmcnt(3)
    s_add_u32 s53, s53, 512
    ds_read_b128 a[236:239], v11 offset:8192
    v_permlane32_swap_b32 v89, v91
    v_permlane32_swap_b32 v93, v95
    v_fmac_f32 v51, v160, v53
    v_fmac_f32 v52, v162, v53
    v_add_f32 v93, v93, v95
    v_mfma_f32_32x32x16_bf16 v[56:71], a[244:247], v[100:103], v[56:71]
    ds_read_b128 a[240:243], v8 offset:9216
    v_add_f32 v89, v89, v91
    v_add_f32 v51, v51, v93
    v_add_f32 v53, v52, v89
    v_fma_f32 v174, v164, v51, v166
    v_mul_f32_dpp v52, v51, v165 quad_perm:[1,0,3,2] row_mask:0xf bank_mask:0xf
    v_add_f32 v174, v174, v52
    v_mfma_f32_32x32x16_bf16 v[56:71], a[248:251], v[104:107], v[56:71]
    ds_read_b128 a[244:247], v9 offset:9216
    buffer_load_dwordx4 v24, s[20:23], s53 offen offset:0 lds
    v_fmac_f32 v176, v224, v174
    v_fmac_f32 v177, v225, v174
    v_mov_b32_dpp v175, v174 quad_perm:[1,0,3,2] row_mask:0xf bank_mask:0xf
    v_fmac_f32 v178, v226, v174
    v_mfma_f32_32x32x16_bf16 v[56:71], a[252:255], v[108:111], v[56:71]
    s_waitcnt lgkmcnt(3)
    ds_read_b128 a[248:251], v10 offset:9216
    buffer_load_dwordx2 v[88:89], v170, s[44:47], s73 offen offset:2048 sc1
    v_fmac_f32 v179, v227, v174
    v_fmac_f32 v180, v228, v174
    v_fmac_f32 v181, v229, v174
    v_fmac_f32 v182, v230, v174
    v_mfma_f32_32x32x16_bf16 v[56:71], a[224:227], v[112:115], v[56:71]
    ds_read_b128 a[252:255], v11 offset:9216
    buffer_load_dwordx4 v25, s[20:23], s53 offen offset:1024 lds
    buffer_load_dwordx2 v[90:91], v170, s[44:47], s73 offen offset:2304 sc1
    v_fmac_f32 v183, v231, v174
    v_fmac_f32 v184, v232, v174
    v_fmac_f32 v185, v233, v174
    v_fmac_f32 v186, v234, v174
    v_mfma_f32_32x32x16_bf16 v[56:71], a[228:231], v[116:119], v[56:71]
    buffer_load_dwordx2 v[92:93], v170, s[44:47], s73 offen offset:2560 sc1
    v_add_u32 v8, 0xffff6000, v8
    v_add_u32 v9, 0xffff6000, v9
    v_fmac_f32 v187, v235, v174
    v_fmac_f32 v188, v236, v174
    v_fmac_f32 v189, v237, v174
    v_fmac_f32 v190, v238, v174
    v_mfma_f32_32x32x16_bf16 v[56:71], a[232:235], v[120:123], v[56:71]
    s_waitcnt lgkmcnt(2)
    buffer_load_dwordx2 v[94:95], v170, s[44:47], s73 offen offset:2816 sc1
    v_add_u32 v10, 0xffff6000, v10
    v_add_u32 v11, 0xffff6000, v11
    v_fmac_f32 v191, v239, v174
    v_fmac_f32 v176, v240, v175
    v_mfma_f32_32x32x16_bf16 v[56:71], a[236:239], v[124:127], v[56:71]
L_chain2:
L_hk5045:
    s_cbranch_execz L_hk7667
    s_waitcnt lgkmcnt(0)
    s_barrier
    s_add_u32 m0, s56, 81920
    ds_read_b32 v16, v27 offset:384
    ds_read_b128 a[224:227], v8 offset:0
    ds_read_b128 a[228:231], v9 offset:0
    ds_read_b128 a[232:235], v10 offset:0
    v_mfma_f32_32x32x16_bf16 v[56:71], a[240:243], v[128:131], v[56:71]
    ds_read_b128 v[32:35], v0 offset:384
    ds_read_b128 a[236:239], v11 offset:0
    buffer_load_dword v6, v7, s[28:31], s51 offen sc1
    v_fmac_f32 v177, v241, v175
    v_fmac_f32 v178, v242, v175
    v_mfma_f32_32x32x16_bf16 v[56:71], a[244:247], v[132:135], v[56:71]
    s_add_u32 s53, s53, 326656
    ds_read_b128 v[36:39], v0 offset:400
    ds_read_b128 a[240:243], v8 offset:1024
    v_fmac_f32 v179, v243, v175
    v_fmac_f32 v180, v244, v175
    v_fmac_f32 v181, v245, v175
    v_fmac_f32 v182, v246, v175
    v_mfma_f32_32x32x16_bf16 v[56:71], a[248:251], v[136:139], v[56:71]
    ds_read_b128 v[40:43], v0 offset:416
    ds_read_b128 a[244:247], v9 offset:1024
    v_fmac_f32 v183, v247, v175
    v_fmac_f32 v184, v248, v175
    v_fmac_f32 v185, v249, v175
    v_fmac_f32 v186, v250, v175
    v_mfma_f32_32x32x16_bf16 v[56:71], a[252:255], v[140:143], v[56:71]
    ds_read_b128 v[44:47], v0 offset:432
    ds_read_b128 a[248:251], v10 offset:1024
    s_waitcnt lgkmcnt(9)
    v_fmac_f32 v187, v251, v175
    v_fmac_f32 v188, v252, v175
    v_fmac_f32 v189, v253, v175
    v_mfma_f32_32x32x16_bf16 v[56:71], v[16:19], v[20:23], v[56:71]
    v_mfma_f32_32x32x16_bf16 v[144:159], a[224:227], a[112:115], 0
    ds_read_b128 a[252:255], v11 offset:1024
    v_fmac_f32 v190, v254, v175
    v_fmac_f32 v191, v255, v175
    v_cvt_pk_bf16_f32 v176, v176, v177
    v_cvt_pk_bf16_f32 v177, v178, v179
    v_cvt_pk_bf16_f32 v178, v180, v181
    v_cvt_pk_bf16_f32 v179, v182, v183
    v_mfma_f32_32x32x16_bf16 v[144:159], a[228:231], a[116:119], v[144:159]
    s_waitcnt lgkmcnt(5)
    ds_read_b128 a[224:227], v8 offset:2048
    buffer_load_dwordx4 v24, s[20:23], s53 offen offset:0 lds
    ds_write_b128 v171, v[176:179] offset:0
    v_cvt_pk_bf16_f32 v180, v184, v185
    v_cvt_pk_bf16_f32 v181, v186, v187
    v_cvt_pk_bf16_f32 v182, v188, v189
    v_cvt_pk_bf16_f32 v183, v190, v191
    v_mfma_f32_32x32x16_bf16 v[144:159], a[232:235], a[120:123], v[144:159]
    ds_read_b128 a[228:231], v9 offset:2048
    ds_write_b128 v171, v[180:183] offset:16
    v_mfma_f32_32x32x16_bf16 v[144:159], a[236:239], a[124:127], v[144:159]
    s_waitcnt lgkmcnt(6)
    ds_read_b128 a[232:235], v10 offset:2048
    buffer_load_dwordx4 v25, s[20:23], s53 offen offset:1024 lds
    v_mul_f32 v56, v56, v32
    v_mul_f32 v57, v57, v33
    v_mul_f32 v58, v58, v34
    v_mul_f32_dpp v176, v56, v49 quad_perm:[1,0,3,2] row_mask:0xf bank_mask:0xf
    v_fmac_f32 v176, v48, v56
    v_mul_f32 v59, v59, v35
    v_mul_f32_dpp v177, v57, v49 quad_perm:[1,0,3,2] row_mask:0xf bank_mask:0xf
    v_mfma_f32_32x32x16_bf16 v[144:159], a[240:243], a[128:131], v[144:159]
    s_waitcnt lgkmcnt(5)
    ds_read_b128 a[236:239], v11 offset:2048
    ds_read_b64_tr_b16 v[184:185], v172 offset:0
    ds_read_b64_tr_b16 v[186:187], v172 offset:640
    v_fmac_f32 v177, v48, v57
    v_mul_f32_dpp v178, v58, v49 quad_perm:[1,0,3,2] row_mask:0xf bank_mask:0xf
    v_fmac_f32 v178, v48, v58
    v_fmac_f32_dpp v177, v176, v240 quad_perm:[1,0,3,2] row_mask:0xf bank_mask:0xf
    v_fmac_f32 v177, v224, v176
    v_mfma_f32_32x32x16_bf16 v[144:159], a[244:247], a[132:135], v[144:159]
    ds_read_b128 a[240:243], v8 offset:3072
    ds_read_b64_tr_b16 v[188:189], v172 offset:16
    ds_read_b64_tr_b16 v[190:191], v172 offset:656
    v_mul_f32_dpp v179, v59, v49 quad_perm:[1,0,3,2] row_mask:0xf bank_mask:0xf
    v_fmac_f32 v179, v48, v59
    v_mul_f32 v60, v60, v36
    v_fmac_f32_dpp v178, v177, v240 quad_perm:[1,0,3,2] row_mask:0xf bank_mask:0xf
    v_mfma_f32_32x32x16_bf16 v[144:159], a[248:251], a[136:139], v[144:159]
    ds_read_b128 a[244:247], v9 offset:3072
    buffer_load_dwordx4 v26, s[20:23], s53 offen offset:2048 lds
    v_fmac_f32 v178, v224, v177
    v_mul_f32_dpp v180, v60, v49 quad_perm:[1,0,3,2] row_mask:0xf bank_mask:0xf
    v_fmac_f32 v180, v48, v60
    v_mul_f32 v61, v61, v37
    v_fmac_f32_dpp v179, v178, v240 quad_perm:[1,0,3,2] row_mask:0xf bank_mask:0xf
    v_mfma_f32_32x32x16_bf16 v[144:159], a[252:255], a[140:143], v[144:159]
    s_waitcnt lgkmcnt(7)
    s_waitcnt lgkmcnt(1)
    ds_read_b128 a[248:251], v10 offset:3072
    buffer_store_dwordx4 v[184:187], v173, s[24:27], s54 offen sc1
    v_mfma_f32_32x32x16_bf16 v[144:159], a[224:227], a[144:147], v[144:159]
    s_add_u32 s54, s54, 96256
    ds_read_b128 a[252:255], v11 offset:3072
    buffer_load_dwordx4 v12, s[20:23], s53 offen offset:3072 lds
    v_fmac_f32 v179, v224, v178
    v_mul_f32_dpp v181, v61, v49 quad_perm:[1,0,3,2] row_mask:0xf bank_mask:0xf
    v_fmac_f32 v181, v48, v61
    v_mul_f32 v62, v62, v38
    v_mfma_f32_32x32x16_bf16 v[144:159], a[228:231], a[148:151], v[144:159]
    ds_read_b128 a[224:227], v8 offset:4096
    v_fmac_f32_dpp v180, v179, v240 quad_perm:[1,0,3,2] row_mask:0xf bank_mask:0xf
    v_fmac_f32 v180, v224, v179
    v_mul_f32_dpp v182, v62, v49 quad_perm:[1,0,3,2] row_mask:0xf bank_mask:0xf
    v_fmac_f32 v182, v48, v62
    v_mul_f32 v63, v63, v39
    v_fmac_f32_dpp v181, v180, v240 quad_perm:[1,0,3,2] row_mask:0xf bank_mask:0xf
    v_mfma_f32_32x32x16_bf16 v[144:159], a[232:235], a[152:155], v[144:159]
    s_waitcnt lgkmcnt(3)
    s_add_u32 m0, s56, 86016
    ds_read_b128 a[228:231], v9 offset:4096
    buffer_store_dwordx4 v[188:191], v173, s[24:27], s54 offen sc1
    v_mfma_f32_32x32x16_bf16 v[144:159], a[236:239], a[156:159], v[144:159]
    s_add_u32 s54, s54, 1443840
    ds_read_b128 a[232:235], v10 offset:4096
    v_fmac_f32 v181, v224, v180
    v_mul_f32_dpp v183, v63, v49 quad_perm:[1,0,3,2] row_mask:0xf bank_mask:0xf
    v_fmac_f32 v183, v48, v63
    v_mul_f32 v64, v64, v40
    v_fmac_f32_dpp v182, v181, v240 quad_perm:[1,0,3,2] row_mask:0xf bank_mask:0xf
    v_fmac_f32 v182, v224, v181
    v_mfma_f32_32x32x16_bf16 v[144:159], a[240:243], a[160:163], v[144:159]
    ds_read_b128 a[236:239], v11 offset:4096
    s_waitcnt vmcnt(6)
    v_cmp_ne_u32 vcc, v6, v13
    s_cbranch_vccnz Lf6ss_14
Lf6sb_15:
    v_mul_f32_dpp v184, v64, v49 quad_perm:[1,0,3,2] row_mask:0xf bank_mask:0xf
    v_fmac_f32 v184, v48, v64
    v_mul_f32 v65, v65, v41
    v_mfma_f32_32x32x16_bf16 v[144:159], a[244:247], a[164:167], v[144:159]
    s_waitcnt lgkmcnt(3)
    s_add_u32 s53, s53, 512
    ds_read_b128 a[240:243], v8 offset:5120
    v_fmac_f32_dpp v183, v182, v240 quad_perm:[1,0,3,2] row_mask:0xf bank_mask:0xf
    v_fmac_f32 v183, v224, v182
    v_mul_f32_dpp v185, v65, v49 quad_perm:[1,0,3,2] row_mask:0xf bank_mask:0xf
    v_fmac_f32 v185, v48, v65
    v_mul_f32 v66, v66, v42
    v_mfma_f32_32x32x16_bf16 v[144:159], a[248:251], a[168:171], v[144:159]
    ds_read_b128 a[244:247], v9 offset:5120
    s_add_u32 s50, s48, 0
    buffer_load_dwordx4 a[0:3], v2, s[40:43], s50 offen offset:0
    v_fmac_f32_dpp v184, v183, v240 quad_perm:[1,0,3,2] row_mask:0xf bank_mask:0xf
    v_fmac_f32 v184, v224, v183
    v_mfma_f32_32x32x16_bf16 v[144:159], a[252:255], a[172:175], v[144:159]
    ds_read_b128 a[248:251], v10 offset:5120
    buffer_load_dwordx4 v24, s[20:23], s53 offen offset:0 lds
    v_mul_f32_dpp v186, v66, v49 quad_perm:[1,0,3,2] row_mask:0xf bank_mask:0xf
    v_fmac_f32 v186, v48, v66
    v_mul_f32 v67, v67, v43
    v_fmac_f32_dpp v185, v184, v240 quad_perm:[1,0,3,2] row_mask:0xf bank_mask:0xf
    v_mfma_f32_32x32x16_bf16 v[144:159], a[224:227], a[176:179], v[144:159]
    s_waitcnt lgkmcnt(3)
    ds_read_b128 a[252:255], v11 offset:5120
    v_fmac_f32 v185, v224, v184
    v_mul_f32_dpp v187, v67, v49 quad_perm:[1,0,3,2] row_mask:0xf bank_mask:0xf
    v_fmac_f32 v187, v48, v67
    v_mul_f32 v68, v68, v44
    v_fmac_f32_dpp v186, v185, v240 quad_perm:[1,0,3,2] row_mask:0xf bank_mask:0xf
    v_fmac_f32 v186, v224, v185
    v_mfma_f32_32x32x16_bf16 v[144:159], a[228:231], a[180:183], v[144:159]
    ds_read_b128 a[224:227], v8 offset:6144
    buffer_load_dwordx4 a[4:7], v2, s[40:43], s50 offen offset:1024
    v_mul_f32_dpp v188, v68, v49 quad_perm:[1,0,3,2] row_mask:0xf bank_mask:0xf
    v_fmac_f32 v188, v48, v68
    v_mul_f32 v69, v69, v45
    v_fmac_f32_dpp v187, v186, v240 quad_perm:[1,0,3,2] row_mask:0xf bank_mask:0xf
    v_mfma_f32_32x32x16_bf16 v[144:159], a[232:235], a[184:187], v[144:159]
    ds_read_b128 a[228:231], v9 offset:6144
    buffer_load_dwordx4 v25, s[20:23], s53 offen offset:1024 lds
    v_fmac_f32 v187, v224, v186
    v_mul_f32_dpp v189, v69, v49 quad_perm:[1,0,3,2] row_mask:0xf bank_mask:0xf
    v_fmac_f32 v189, v48, v69
    v_mul_f32 v70, v70, v46
    v_mfma_f32_32x32x16_bf16 v[144:159], a[236:239], a[188:191], v[144:159]
    s_waitcnt lgkmcnt(3)
    ds_read_b128 a[232:235], v10 offset:6144
    v_fmac_f32_dpp v188, v187, v240 quad_perm:[1,0,3,2] row_mask:0xf bank_mask:0xf
    v_fmac_f32 v188, v224, v187
    v_mul_f32_dpp v190, v70, v49 quad_perm:[1,0,3,2] row_mask:0xf bank_mask:0xf
    v_fmac_f32 v190, v48, v70
    v_mul_f32 v71, v71, v47
    v_fmac_f32_dpp v189, v188, v240 quad_perm:[1,0,3,2] row_mask:0xf bank_mask:0xf
    v_mfma_f32_32x32x16_bf16 v[144:159], a[240:243], a[192:195], v[144:159]
    ds_read_b128 a[236:239], v11 offset:6144
    buffer_load_dwordx4 a[8:11], v2, s[40:43], s50 offen offset:2048
    buffer_load_dwordx4 v26, s[20:23], s53 offen offset:2048 lds
    v_fmac_f32 v189, v224, v188
    v_mul_f32_dpp v191, v71, v49 quad_perm:[1,0,3,2] row_mask:0xf bank_mask:0xf
    v_mfma_f32_32x32x16_bf16 v[144:159], a[244:247], a[196:199], v[144:159]
    ds_read_b128 a[240:243], v8 offset:7168
    v_fmac_f32 v191, v48, v71
    v_fmac_f32_dpp v190, v189, v240 quad_perm:[1,0,3,2] row_mask:0xf bank_mask:0xf
    v_fmac_f32 v190, v224, v189
    s_nop 1
    v_fmac_f32_dpp v191, v190, v240 quad_perm:[1,0,3,2] row_mask:0xf bank_mask:0xf
    v_fmac_f32 v191, v224, v190
    v_mov_b32 v51, v191
    v_mfma_f32_32x32x16_bf16 v[144:159], a[248:251], a[200:203], v[144:159]
    s_waitcnt lgkmcnt(3)
    ds_read_b128 a[244:247], v9 offset:7168
    v_mov_b32 v54, v191
    s_nop 1
    v_permlane32_swap_b32 v51, v54
    v_cndmask_b32 v166, 0, v51, s[82:83]
    v_fmac_f32 v54, v239, v51
    v_mul_f32_dpp v52, v51, v255 quad_perm:[1,0,3,2] row_mask:0xf bank_mask:0xf
    v_add_f32 v54, v54, v52
    v_mfma_f32_32x32x16_bf16 v[144:159], a[252:255], a[204:207], v[144:159]
    ds_read_b128 a[248:251], v10 offset:7168
    buffer_load_dwordx4 v12, s[20:23], s53 offen offset:3072 lds
    buffer_store_dwordx2 v[54:55], v169, s[44:47], s72 offen sc1
    buffer_load_dwordx4 a[12:15], v2, s[40:43], s50 offen offset:3072
    s_add_u32 s50, s48, 4096
    v_mfma_f32_32x32x16_bf16 v[144:159], a[224:227], a[208:211], v[144:159]
    s_add_u32 s72, s72, 2048
    ds_read_b128 a[252:255], v11 offset:7168
    v_xor_b32 v89, v89, v13
    v_xor_b32 v91, v91, v13
    v_xor_b32 v93, v93, v13
    v_xor_b32 v95, v95, v13
    v_or3_b32 v89, v89, v91, v93
    v_or_b32 v89, v89, v95
    v_cmp_ne_u32 vcc, 0, v89
    s_cbranch_vccnz Laggs_16
Laggb_17:
    v_mfma_f32_32x32x16_bf16 v[144:159], a[228:231], a[212:215], v[144:159]
    s_waitcnt lgkmcnt(3)
    s_add_u32 m0, s56, 90112
    s_add_u32 s73, s73, 4096
    ds_read_b128 a[224:227], v8 offset:8192
    v_mul_f32_dpp v89, v88, v76 quad_perm:[1,0,3,2] row_mask:0xf bank_mask:0xf
    v_mul_f32_dpp v93, v88, v84 quad_perm:[1,0,3,2] row_mask:0xf bank_mask:0xf
    v_mul_f32 v91, v72, v88
    v_mul_f32 v95, v80, v88
    v_mfma_f32_32x32x16_bf16 v[144:159], a[232:235], a[216:219], v[144:159]
    ds_read_b128 a[228:231], v9 offset:8192
    buffer_load_dwordx4 a[16:19], v2, s[40:43], s50 offen offset:0
    v_fmac_f32_dpp v89, v90, v77 quad_perm:[1,0,3,2] row_mask:0xf bank_mask:0xf
    v_fmac_f32_dpp v93, v90, v85 quad_perm:[1,0,3,2] row_mask:0xf bank_mask:0xf
    v_fmac_f32 v91, v73, v90
    v_fmac_f32 v95, v81, v90
    v_mfma_f32_32x32x16_bf16 v[144:159], a[236:239], a[220:223], v[144:159]
    ds_read_b128 a[232:235], v10 offset:8192
    v_fmac_f32_dpp v89, v92, v78 quad_perm:[1,0,3,2] row_mask:0xf bank_mask:0xf
    v_fmac_f32_dpp v93, v92, v86 quad_perm:[1,0,3,2] row_mask:0xf bank_mask:0xf
    v_fmac_f32 v91, v74, v92
    v_fmac_f32 v95, v82, v92
    v_fmac_f32_dpp v89, v94, v79 quad_perm:[1,0,3,2] row_mask:0xf bank_mask:0xf
    v_fmac_f32_dpp v93, v94, v87 quad_perm:[1,0,3,2] row_mask:0xf bank_mask:0xf
    v_mfma_f32_32x32x16_bf16 v[144:159], a[240:243], v[96:99], v[144:159]
    s_waitcnt lgkmcnt(3)
    s_add_u32 s53, s53, 512
    ds_read_b128 a[236:239], v11 offset:8192
    v_fmac_f32 v91, v75, v94
    v_fmac_f32 v95, v83, v94
    v_add_f32 v89, v89, v91
    v_add_f32 v93, v93, v95
    v_mov_b32 v91, v89
    v_mov_b32 v95, v93
    v_mfma_f32_32x32x16_bf16 v[144:159], a[244:247], v[100:103], v[144:159]
    ds_read_b128 a[240:243], v8 offset:9216
    buffer_load_dwordx4 a[20:23], v2, s[40:43], s50 offen offset:1024
    v_mul_f32_dpp v51, v53, v161 quad_perm:[1,0,3,2] row_mask:0xf bank_mask:0xf
    v_mul_f32_dpp v52, v53, v163 quad_perm:[1,0,3,2] row_mask:0xf bank_mask:0xf
    v_permlane32_swap_b32 v89, v91
    v_permlane32_swap_b32 v93, v95
    v_mfma_f32_32x32x16_bf16 v[144:159], a[248:251], v[104:107], v[144:159]
    ds_read_b128 a[244:247], v9 offset:9216
    buffer_load_dwordx4 v24, s[20:23], s53 offen offset:0 lds
    v_fmac_f32 v51, v160, v53
    v_fmac_f32 v52, v162, v53
    v_add_f32 v93, v93, v95
    v_add_f32 v89, v89, v91
    v_add_f32 v51, v51, v93
    v_mfma_f32_32x32x16_bf16 v[144:159], a[252:255], v[108:111], v[144:159]
    s_waitcnt lgkmcnt(3)
    ds_read_b128 a[248:251], v10 offset:9216
    v_add_f32 v53, v52, v89
    v_fma_f32 v174, v164, v51, v167
    v_mul_f32_dpp v52, v51, v165 quad_perm:[1,0,3,2] row_mask:0xf bank_mask:0xf
    v_add_f32 v174, v174, v52
    v_fmac_f32 v192, v224, v174
    v_fmac_f32 v193, v225, v174
    v_mfma_f32_32x32x16_bf16 v[144:159], a[224:227], v[112:115], v[144:159]
    ds_read_b128 a[252:255], v11 offset:9216
    buffer_load_dwordx4 a[24:27], v2, s[40:43], s50 offen offset:2048
    buffer_load_dwordx4 v25, s[20:23], s53 offen offset:1024 lds
    v_mov_b32_dpp v175, v174 quad_perm:[1,0,3,2] row_mask:0xf bank_mask:0xf
    v_fmac_f32 v194, v226, v174
    v_mfma_f32_32x32x16_bf16 v[144:159], a[228:231], v[116:119], v[144:159]
    buffer_load_dwordx2 v[88:89], v170, s[44:47], s73 offen offset:0 sc1
    v_add_u32 v8, 0xffff6000, v8
    v_add_u32 v9, 0xffff6000, v9
    v_fmac_f32 v195, v227, v174
    v_fmac_f32 v196, v228, v174
    v_fmac_f32 v197, v229, v174
    v_fmac_f32 v198, v230, v174
    v_mfma_f32_32x32x16_bf16 v[144:159], a[232:235], v[120:123], v[144:159]
    s_waitcnt lgkmcnt(2)
    s_add_u32 m0, s56, 40960
    buffer_load_dwordx2 v[90:91], v170, s[44:47], s73 offen offset:256 sc1
    v_add_u32 v10, 0xffff6000, v10
    v_add_u32 v11, 0xffff6000, v11
    v_fmac_f32 v199, v231, v174
    v_fmac_f32 v200, v232, v174
    v_fmac_f32 v201, v233, v174
    v_fmac_f32 v202, v234, v174
    v_mfma_f32_32x32x16_bf16 v[144:159], a[236:239], v[124:127], v[144:159]
    s_waitcnt vmcnt(16) lgkmcnt(0)
    s_barrier
    ds_read_b32 v16, v27 offset:512
    ds_read_b128 a[224:227], v8 offset:0
    ds_read_b128 a[228:231], v9 offset:0
    ds_read_b128 a[232:235], v10 offset:0
    buffer_load_dwordx2 v[92:93], v170, s[44:47], s73 offen offset:512 sc1
    buffer_load_dwordx4 a[28:31], v2, s[40:43], s50 offen offset:3072
    s_add_u32 s50, s48, 8192
    v_mfma_f32_32x32x16_bf16 v[144:159], a[240:243], v[128:131], v[144:159]
    ds_read_b128 v[32:35], v0 offset:512
    ds_read_b128 a[236:239], v11 offset:0
    buffer_store_dword v13, v14, s[28:31], s55 offen sc1
    s_add_u32 s55, s55, 65536
    v_fmac_f32 v203, v235, v174
    v_fmac_f32 v204, v236, v174
    v_fmac_f32 v205, v237, v174
    v_fmac_f32 v206, v238, v174
    v_mfma_f32_32x32x16_bf16 v[144:159], a[244:247], v[132:135], v[144:159]
    s_add_u32 s53, s53, 326656
    ds_read_b128 v[36:39], v0 offset:528
    ds_read_b128 a[240:243], v8 offset:1024
    buffer_load_dwordx2 v[94:95], v170, s[44:47], s73 offen offset:768 sc1
    v_fmac_f32 v207, v239, v174
    v_fmac_f32 v192, v240, v175
    v_fmac_f32 v193, v241, v175
    v_fmac_f32 v194, v242, v175
    v_mfma_f32_32x32x16_bf16 v[144:159], a[248:251], v[136:139], v[144:159]
    ds_read_b128 v[40:43], v0 offset:544
    ds_read_b128 a[244:247], v9 offset:1024
    v_fmac_f32 v195, v243, v175
    v_fmac_f32 v196, v244, v175
    v_fmac_f32 v197, v245, v175
    v_fmac_f32 v198, v246, v175
    v_fmac_f32 v199, v247, v175
    v_fmac_f32 v200, v248, v175
    v_mfma_f32_32x32x16_bf16 v[144:159], a[252:255], v[140:143], v[144:159]
    ds_read_b128 v[44:47], v0 offset:560
    ds_read_b128 a[248:251], v10 offset:1024
    s_waitcnt lgkmcnt(9)
    v_fmac_f32 v201, v249, v175
    v_fmac_f32 v202, v250, v175
    v_fmac_f32 v203, v251, v175
    v_fmac_f32 v204, v252, v175
    v_fmac_f32 v205, v253, v175
    v_mfma_f32_32x32x16_bf16 v[144:159], v[16:19], v[20:23], v[144:159]
    v_mfma_f32_32x32x16_bf16 v[56:71], a[224:227], a[112:115], 0
    ds_read_b128 a[252:255], v11 offset:1024
    buffer_load_dwordx4 v24, s[20:23], s53 offen offset:0 lds
    v_fmac_f32 v206, v254, v175
    v_fmac_f32 v207, v255, v175
    v_cvt_pk_bf16_f32 v192, v192, v193
    v_cvt_pk_bf16_f32 v193, v194, v195
    v_cvt_pk_bf16_f32 v194, v196, v197
    v_cvt_pk_bf16_f32 v195, v198, v199
    v_mfma_f32_32x32x16_bf16 v[56:71], a[228:231], a[116:119], v[56:71]
    s_waitcnt lgkmcnt(5)
    ds_read_b128 a[224:227], v8 offset:2048
    ds_write_b128 v171, v[192:195] offset:2560
    v_cvt_pk_bf16_f32 v196, v200, v201
    v_cvt_pk_bf16_f32 v197, v202, v203
    v_cvt_pk_bf16_f32 v198, v204, v205
    v_cvt_pk_bf16_f32 v199, v206, v207
    v_mfma_f32_32x32x16_bf16 v[56:71], a[232:235], a[120:123], v[56:71]
    ds_read_b128 a[228:231], v9 offset:2048
    buffer_load_dwordx4 v25, s[20:23], s53 offen offset:1024 lds
    ds_write_b128 v171, v[196:199] offset:2576
    v_mfma_f32_32x32x16_bf16 v[56:71], a[236:239], a[124:127], v[56:71]
    s_waitcnt lgkmcnt(6)
    ds_read_b128 a[232:235], v10 offset:2048
    buffer_load_dwordx4 a[32:35], v2, s[40:43], s50 offen offset:0
    v_mul_f32 v144, v144, v32
    v_mul_f32 v145, v145, v33
    v_mul_f32 v146, v146, v34
    v_mul_f32_dpp v192, v144, v49 quad_perm:[1,0,3,2] row_mask:0xf bank_mask:0xf
    v_fmac_f32 v192, v48, v144
    v_mul_f32 v147, v147, v35
    v_mul_f32_dpp v193, v145, v49 quad_perm:[1,0,3,2] row_mask:0xf bank_mask:0xf
    v_mfma_f32_32x32x16_bf16 v[56:71], a[240:243], a[128:131], v[56:71]
    s_waitcnt lgkmcnt(5)
    ds_read_b128 a[236:239], v11 offset:2048
    ds_read_b64_tr_b16 v[200:201], v172 offset:2560
    ds_read_b64_tr_b16 v[202:203], v172 offset:3200
    v_fmac_f32 v193, v48, v145
    v_mul_f32_dpp v194, v146, v49 quad_perm:[1,0,3,2] row_mask:0xf bank_mask:0xf
    v_fmac_f32 v194, v48, v146
    v_fmac_f32_dpp v193, v192, v240 quad_perm:[1,0,3,2] row_mask:0xf bank_mask:0xf
    v_fmac_f32 v193, v224, v192
    v_mfma_f32_32x32x16_bf16 v[56:71], a[244:247], a[132:135], v[56:71]
    ds_read_b128 a[240:243], v8 offset:3072
    buffer_load_dwordx4 v26, s[20:23], s53 offen offset:2048 lds
    ds_read_b64_tr_b16 v[204:205], v172 offset:2576
    ds_read_b64_tr_b16 v[206:207], v172 offset:3216
    v_mul_f32_dpp v195, v147, v49 quad_perm:[1,0,3,2] row_mask:0xf bank_mask:0xf
    v_mfma_f32_32x32x16_bf16 v[56:71], a[248:251], a[136:139], v[56:71]
    ds_read_b128 a[244:247], v9 offset:3072
    buffer_load_dwordx4 a[36:39], v2, s[40:43], s50 offen offset:1024
    v_fmac_f32 v195, v48, v147
    v_mul_f32 v148, v148, v36
    v_fmac_f32_dpp v194, v193, v240 quad_perm:[1,0,3,2] row_mask:0xf bank_mask:0xf
    v_mfma_f32_32x32x16_bf16 v[56:71], a[252:255], a[140:143], v[56:71]
    s_waitcnt lgkmcnt(7)
    ds_read_b128 a[248:251], v10 offset:3072
    v_fmac_f32 v194, v224, v193
    v_mul_f32_dpp v196, v148, v49 quad_perm:[1,0,3,2] row_mask:0xf bank_mask:0xf
    v_fmac_f32 v196, v48, v148
    v_mul_f32 v149, v149, v37
    v_fmac_f32_dpp v195, v194, v240 quad_perm:[1,0,3,2] row_mask:0xf bank_mask:0xf
    v_mfma_f32_32x32x16_bf16 v[56:71], a[224:227], a[144:147], v[56:71]
    s_waitcnt lgkmcnt(2)
    ds_read_b128 a[252:255], v11 offset:3072
    buffer_load_dwordx4 v12, s[20:23], s53 offen offset:3072 lds
    buffer_store_dwordx4 v[200:203], v173, s[24:27], s54 offen sc1
    v_mfma_f32_32x32x16_bf16 v[56:71], a[228:231], a[148:151], v[56:71]
    s_add_u32 m0, s56, 45056
    s_add_u32 s54, s54, 96256
    ds_read_b128 a[224:227], v8 offset:4096
    v_fmac_f32 v195, v224, v194
    v_mul_f32_dpp v197, v149, v49 quad_perm:[1,0,3,2] row_mask:0xf bank_mask:0xf
    v_fmac_f32 v197, v48, v149
    v_mul_f32 v150, v150, v38
    v_fmac_f32_dpp v196, v195, v240 quad_perm:[1,0,3,2] row_mask:0xf bank_mask:0xf
    v_mfma_f32_32x32x16_bf16 v[56:71], a[232:235], a[152:155], v[56:71]
    s_waitcnt lgkmcnt(3)
    ds_read_b128 a[228:231], v9 offset:4096
    v_fmac_f32 v196, v224, v195
    v_mul_f32_dpp v198, v150, v49 quad_perm:[1,0,3,2] row_mask:0xf bank_mask:0xf
    v_fmac_f32 v198, v48, v150
    v_mul_f32 v151, v151, v39
    v_fmac_f32_dpp v197, v196, v240 quad_perm:[1,0,3,2] row_mask:0xf bank_mask:0xf
    v_mfma_f32_32x32x16_bf16 v[56:71], a[236:239], a[156:159], v[56:71]
    s_add_u32 s53, s53, 512
    ds_read_b128 a[232:235], v10 offset:4096
    buffer_store_dwordx4 v[204:207], v173, s[24:27], s54 offen sc1
    v_mfma_f32_32x32x16_bf16 v[56:71], a[240:243], a[160:163], v[56:71]
    s_add_u32 s54, s54, 1443840
    ds_read_b128 a[236:239], v11 offset:4096
    buffer_load_dwordx4 a[40:43], v2, s[40:43], s50 offen offset:2048
    v_fmac_f32 v197, v224, v196
    v_mul_f32_dpp v199, v151, v49 quad_perm:[1,0,3,2] row_mask:0xf bank_mask:0xf
    v_fmac_f32 v199, v48, v151
    v_mul_f32 v152, v152, v40
    v_fmac_f32_dpp v198, v197, v240 quad_perm:[1,0,3,2] row_mask:0xf bank_mask:0xf
    v_mfma_f32_32x32x16_bf16 v[56:71], a[244:247], a[164:167], v[56:71]
    s_waitcnt lgkmcnt(3)
    ds_read_b128 a[240:243], v8 offset:5120
    v_fmac_f32 v198, v224, v197
    v_mul_f32_dpp v200, v152, v49 quad_perm:[1,0,3,2] row_mask:0xf bank_mask:0xf
    v_fmac_f32 v200, v48, v152
    v_mul_f32 v153, v153, v41
    v_fmac_f32_dpp v199, v198, v240 quad_perm:[1,0,3,2] row_mask:0xf bank_mask:0xf
    v_fmac_f32 v199, v224, v198
    v_mul_f32_dpp v201, v153, v49 quad_perm:[1,0,3,2] row_mask:0xf bank_mask:0xf
    v_mfma_f32_32x32x16_bf16 v[56:71], a[248:251], a[168:171], v[56:71]
    ds_read_b128 a[244:247], v9 offset:5120
    buffer_load_dwordx4 v24, s[20:23], s53 offen offset:0 lds
    v_fmac_f32 v201, v48, v153
    v_mul_f32 v154, v154, v42
    v_fmac_f32_dpp v200, v199, v240 quad_perm:[1,0,3,2] row_mask:0xf bank_mask:0xf
    v_fmac_f32 v200, v224, v199
    v_mul_f32_dpp v202, v154, v49 quad_perm:[1,0,3,2] row_mask:0xf bank_mask:0xf
    v_mfma_f32_32x32x16_bf16 v[56:71], a[252:255], a[172:175], v[56:71]
    ds_read_b128 a[248:251], v10 offset:5120
    buffer_load_dwordx4 a[44:47], v2, s[40:43], s50 offen offset:3072
    v_fmac_f32 v202, v48, v154
    v_mul_f32 v155, v155, v43
    v_fmac_f32_dpp v201, v200, v240 quad_perm:[1,0,3,2] row_mask:0xf bank_mask:0xf
    v_fmac_f32 v201, v224, v200
    v_mul_f32_dpp v203, v155, v49 quad_perm:[1,0,3,2] row_mask:0xf bank_mask:0xf
    v_mfma_f32_32x32x16_bf16 v[56:71], a[224:227], a[176:179], v[56:71]
    s_waitcnt lgkmcnt(3)
    ds_read_b128 a[252:255], v11 offset:5120
    v_fmac_f32 v203, v48, v155
    v_mul_f32 v156, v156, v44
    v_fmac_f32_dpp v202, v201, v240 quad_perm:[1,0,3,2] row_mask:0xf bank_mask:0xf
    v_fmac_f32 v202, v224, v201
    v_mul_f32_dpp v204, v156, v49 quad_perm:[1,0,3,2] row_mask:0xf bank_mask:0xf
    v_fmac_f32 v204, v48, v156
    v_mul_f32 v157, v157, v45
    v_mfma_f32_32x32x16_bf16 v[56:71], a[228:231], a[180:183], v[56:71]
    s_add_u32 s50, s48, 12288
    ds_read_b128 a[224:227], v8 offset:6144
    v_fmac_f32_dpp v203, v202, v240 quad_perm:[1,0,3,2] row_mask:0xf bank_mask:0xf
    v_fmac_f32 v203, v224, v202
    v_mul_f32_dpp v205, v157, v49 quad_perm:[1,0,3,2] row_mask:0xf bank_mask:0xf
    v_fmac_f32 v205, v48, v157
    v_mul_f32 v158, v158, v46
    v_fmac_f32_dpp v204, v203, v240 quad_perm:[1,0,3,2] row_mask:0xf bank_mask:0xf
    v_fmac_f32 v204, v224, v203
    v_mfma_f32_32x32x16_bf16 v[56:71], a[232:235], a[184:187], v[56:71]
    ds_read_b128 a[228:231], v9 offset:6144
    buffer_load_dwordx4 v25, s[20:23], s53 offen offset:1024 lds
    v_mul_f32_dpp v206, v158, v49 quad_perm:[1,0,3,2] row_mask:0xf bank_mask:0xf
    v_fmac_f32 v206, v48, v158
    v_mul_f32 v159, v159, v47
    v_fmac_f32_dpp v205, v204, v240 quad_perm:[1,0,3,2] row_mask:0xf bank_mask:0xf
    v_fmac_f32 v205, v224, v204
    v_mfma_f32_32x32x16_bf16 v[56:71], a[236:239], a[188:191], v[56:71]
    s_waitcnt lgkmcnt(3)
    ds_read_b128 a[232:235], v10 offset:6144
    v_mul_f32_dpp v207, v159, v49 quad_perm:[1,0,3,2] row_mask:0xf bank_mask:0xf
    v_fmac_f32 v207, v48, v159
    v_fmac_f32_dpp v206, v205, v240 quad_perm:[1,0,3,2] row_mask:0xf bank_mask:0xf
    v_fmac_f32 v206, v224, v205
    s_nop 1
    v_fmac_f32_dpp v207, v206, v240 quad_perm:[1,0,3,2] row_mask:0xf bank_mask:0xf
    v_fmac_f32 v207, v224, v206
    v_mov_b32 v51, v207
    v_mfma_f32_32x32x16_bf16 v[56:71], a[240:243], a[192:195], v[56:71]
    ds_read_b128 a[236:239], v11 offset:6144
    buffer_load_dwordx4 v26, s[20:23], s53 offen offset:2048 lds
    v_mov_b32 v54, v207
    s_nop 1
    v_permlane32_swap_b32 v51, v54
    v_cndmask_b32 v167, 0, v51, s[82:83]
    v_fmac_f32 v54, v239, v51
    v_mul_f32_dpp v52, v51, v255 quad_perm:[1,0,3,2] row_mask:0xf bank_mask:0xf
    v_add_f32 v54, v54, v52
    v_mfma_f32_32x32x16_bf16 v[56:71], a[244:247], a[196:199], v[56:71]
    ds_read_b128 a[240:243], v8 offset:7168
    buffer_load_dwordx4 a[48:51], v2, s[40:43], s50 offen offset:0
    buffer_store_dwordx2 v[54:55], v169, s[44:47], s72 offen sc1
    s_add_u32 s72, s72, 2048
    v_mfma_f32_32x32x16_bf16 v[56:71], a[248:251], a[200:203], v[56:71]
    s_waitcnt lgkmcnt(3)
    ds_read_b128 a[244:247], v9 offset:7168
    s_waitcnt vmcnt(15)
    v_xor_b32 v89, v89, v13
    v_xor_b32 v91, v91, v13
    v_xor_b32 v93, v93, v13
    v_xor_b32 v95, v95, v13
    v_or3_b32 v89, v89, v91, v93
    v_or_b32 v89, v89, v95
    v_cmp_ne_u32 vcc, 0, v89
    s_cbranch_vccnz Laggs_18
Laggb_19:
    v_mfma_f32_32x32x16_bf16 v[56:71], a[252:255], a[204:207], v[56:71]
    s_add_u32 s73, s73, 0
    ds_read_b128 a[248:251], v10 offset:7168
    buffer_load_dwordx4 v12, s[20:23], s53 offen offset:3072 lds
    v_mul_f32_dpp v89, v88, v76 quad_perm:[1,0,3,2] row_mask:0xf bank_mask:0xf
    v_mul_f32_dpp v93, v88, v84 quad_perm:[1,0,3,2] row_mask:0xf bank_mask:0xf
    v_mul_f32 v91, v72, v88
    v_mul_f32 v95, v80, v88
    v_mfma_f32_32x32x16_bf16 v[56:71], a[224:227], a[208:211], v[56:71]
    s_add_u32 m0, s56, 49152
    ds_read_b128 a[252:255], v11 offset:7168
    v_fmac_f32_dpp v89, v90, v77 quad_perm:[1,0,3,2] row_mask:0xf bank_mask:0xf
    v_fmac_f32_dpp v93, v90, v85 quad_perm:[1,0,3,2] row_mask:0xf bank_mask:0xf
    v_fmac_f32 v91, v73, v90
    v_fmac_f32 v95, v81, v90
    v_fmac_f32_dpp v89, v92, v78 quad_perm:[1,0,3,2] row_mask:0xf bank_mask:0xf
    v_mfma_f32_32x32x16_bf16 v[56:71], a[228:231], a[212:215], v[56:71]
    s_waitcnt lgkmcnt(3)
    ds_read_b128 a[224:227], v8 offset:8192
    v_fmac_f32_dpp v93, v92, v86 quad_perm:[1,0,3,2] row_mask:0xf bank_mask:0xf
    v_fmac_f32 v91, v74, v92
    v_fmac_f32 v95, v82, v92
    v_fmac_f32_dpp v89, v94, v79 quad_perm:[1,0,3,2] row_mask:0xf bank_mask:0xf
    v_fmac_f32_dpp v93, v94, v87 quad_perm:[1,0,3,2] row_mask:0xf bank_mask:0xf
    v_mfma_f32_32x32x16_bf16 v[56:71], a[232:235], a[216:219], v[56:71]
    s_add_u32 s53, s53, 512
    ds_read_b128 a[228:231], v9 offset:8192
    v_fmac_f32 v91, v75, v94
    v_fmac_f32 v95, v83, v94
    v_add_f32 v89, v89, v91
    v_add_f32 v93, v93, v95
    v_mov_b32 v91, v89
    v_mov_b32 v95, v93
    v_mfma_f32_32x32x16_bf16 v[56:71], a[236:239], a[220:223], v[56:71]
    ds_read_b128 a[232:235], v10 offset:8192
    buffer_load_dwordx4 a[52:55], v2, s[40:43], s50 offen offset:1024
    v_mul_f32_dpp v51, v53, v161 quad_perm:[1,0,3,2] row_mask:0xf bank_mask:0xf
    v_mul_f32_dpp v52, v53, v163 quad_perm:[1,0,3,2] row_mask:0xf bank_mask:0xf
    v_permlane32_swap_b32 v89, v91
    v_mfma_f32_32x32x16_bf16 v[56:71], a[240:243], v[96:99], v[56:71]
    s_waitcnt lgkmcnt(3)
    ds_read_b128 a[236:239], v11 offset:8192
    v_permlane32_swap_b32 v93, v95
    v_fmac_f32 v51, v160, v53
    v_fmac_f32 v52, v162, v53
    v_add_f32 v93, v93, v95
    v_add_f32 v89, v89, v91
    v_add_f32 v51, v51, v93
    v_mfma_f32_32x32x16_bf16 v[56:71], a[244:247], v[100:103], v[56:71]
    ds_read_b128 a[240:243], v8 offset:9216
    buffer_load_dwordx4 v24, s[20:23], s53 offen offset:0 lds
    v_add_f32 v53, v52, v89
    v_fma_f32 v174, v164, v51, v168
    v_mul_f32_dpp v52, v51, v165 quad_perm:[1,0,3,2] row_mask:0xf bank_mask:0xf
    v_add_f32 v174, v174, v52
    v_mfma_f32_32x32x16_bf16 v[56:71], a[248:251], v[104:107], v[56:71]
    ds_read_b128 a[244:247], v9 offset:9216
    buffer_load_dwordx4 a[56:59], v2, s[40:43], s50 offen offset:2048
    v_fmac_f32 v208, v224, v174
    v_fmac_f32 v209, v225, v174
    v_mov_b32_dpp v175, v174 quad_perm:[1,0,3,2] row_mask:0xf bank_mask:0xf
    v_fmac_f32 v210, v226, v174
    v_mfma_f32_32x32x16_bf16 v[56:71], a[252:255], v[108:111], v[56:71]
    s_waitcnt lgkmcnt(3)
    ds_read_b128 a[248:251], v10 offset:9216
    buffer_load_dwordx2 v[88:89], v170, s[44:47], s73 offen offset:2048 sc1
    v_fmac_f32 v211, v227, v174
    v_fmac_f32 v212, v228, v174
    v_fmac_f32 v213, v229, v174
    v_fmac_f32 v214, v230, v174
    v_mfma_f32_32x32x16_bf16 v[56:71], a[224:227], v[112:115], v[56:71]
    ds_read_b128 a[252:255], v11 offset:9216
    buffer_load_dwordx4 v25, s[20:23], s53 offen offset:1024 lds
    buffer_load_dwordx2 v[90:91], v170, s[44:47], s73 offen offset:2304 sc1
    v_fmac_f32 v215, v231, v174
    v_fmac_f32 v216, v232, v174
    v_fmac_f32 v217, v233, v174
    v_fmac_f32 v218, v234, v174
    v_mfma_f32_32x32x16_bf16 v[56:71], a[228:231], v[116:119], v[56:71]
    s_add_u32 m0, s56, 0
    buffer_load_dwordx2 v[92:93], v170, s[44:47], s73 offen offset:2560 sc1
    v_add_u32 v8, 0x14000, v8
    v_add_u32 v9, 0x14000, v9
    v_fmac_f32 v219, v235, v174
    v_fmac_f32 v220, v236, v174
    v_fmac_f32 v221, v237, v174
    v_fmac_f32 v222, v238, v174
    v_mfma_f32_32x32x16_bf16 v[56:71], a[232:235], v[120:123], v[56:71]
    s_waitcnt lgkmcnt(2)
    buffer_load_dwordx2 v[94:95], v170, s[44:47], s73 offen offset:2816 sc1
    v_add_u32 v10, 0x14000, v10
    v_add_u32 v11, 0x14000, v11
    v_fmac_f32 v223, v239, v174
    v_fmac_f32 v208, v240, v175
    v_fmac_f32 v209, v241, v175
    v_mfma_f32_32x32x16_bf16 v[56:71], a[236:239], v[124:127], v[56:71]
L_chain3:
L_hk5695:
    s_cbranch_execz L_hk7079
    s_waitcnt vmcnt(16) lgkmcnt(0)
    s_barrier
    s_add_u32 s53, s53, 326656
    ds_read_b32 v16, v27 offset:640
    ds_read_b128 a[224:227], v8 offset:0
    ds_read_b128 a[228:231], v9 offset:0
    ds_read_b128 a[232:235], v10 offset:0
    v_mfma_f32_32x32x16_bf16 v[56:71], a[240:243], v[128:131], v[56:71]
    ds_read_b128 v[32:35], v0 offset:640
    ds_read_b128 a[236:239], v11 offset:0
    buffer_store_dword v13, v14, s[28:31], s55 offen sc1
    s_add_u32 s55, s55, 65536
    v_fmac_f32 v210, v242, v175
    v_mfma_f32_32x32x16_bf16 v[56:71], a[244:247], v[132:135], v[56:71]
    ds_read_b128 v[36:39], v0 offset:656
    ds_read_b128 a[240:243], v8 offset:1024
    buffer_load_dwordx4 a[60:63], v2, s[40:43], s50 offen offset:3072
    v_fmac_f32 v211, v243, v175
    v_fmac_f32 v212, v244, v175
    v_mfma_f32_32x32x16_bf16 v[56:71], a[248:251], v[136:139], v[56:71]
    s_add_u32 s50, s48, 16384
    ds_read_b128 v[40:43], v0 offset:672
    ds_read_b128 a[244:247], v9 offset:1024
    v_fmac_f32 v213, v245, v175
    v_fmac_f32 v214, v246, v175
    v_fmac_f32 v215, v247, v175
    v_fmac_f32 v216, v248, v175
    v_fmac_f32 v217, v249, v175
    v_mfma_f32_32x32x16_bf16 v[56:71], a[252:255], v[140:143], v[56:71]
    ds_read_b128 v[44:47], v0 offset:688
    ds_read_b128 a[248:251], v10 offset:1024
    s_waitcnt lgkmcnt(9)
    v_fmac_f32 v218, v250, v175
    v_fmac_f32 v219, v251, v175
    v_fmac_f32 v220, v252, v175
    v_fmac_f32 v221, v253, v175
    v_mfma_f32_32x32x16_bf16 v[56:71], v[16:19], v[20:23], v[56:71]
    v_mfma_f32_32x32x16_bf16 v[144:159], a[224:227], a[112:115], 0
    ds_read_b128 a[252:255], v11 offset:1024
    v_fmac_f32 v222, v254, v175
    v_fmac_f32 v223, v255, v175
    v_cvt_pk_bf16_f32 v208, v208, v209
    v_cvt_pk_bf16_f32 v209, v210, v211
    v_cvt_pk_bf16_f32 v210, v212, v213
    v_cvt_pk_bf16_f32 v211, v214, v215
    v_mfma_f32_32x32x16_bf16 v[144:159], a[228:231], a[116:119], v[144:159]
    s_waitcnt lgkmcnt(5)
    ds_read_b128 a[224:227], v8 offset:2048
    buffer_load_dwordx4 a[64:67], v2, s[40:43], s50 offen offset:0
    ds_write_b128 v171, v[208:211] offset:0
    v_cvt_pk_bf16_f32 v212, v216, v217
    v_cvt_pk_bf16_f32 v213, v218, v219
    v_cvt_pk_bf16_f32 v214, v220, v221
    v_cvt_pk_bf16_f32 v215, v222, v223
    v_mfma_f32_32x32x16_bf16 v[144:159], a[232:235], a[120:123], v[144:159]
    ds_read_b128 a[228:231], v9 offset:2048
    ds_write_b128 v171, v[212:215] offset:16
    v_mfma_f32_32x32x16_bf16 v[144:159], a[236:239], a[124:127], v[144:159]
    s_waitcnt lgkmcnt(6)
    ds_read_b128 a[232:235], v10 offset:2048
    buffer_load_dwordx4 a[68:71], v2, s[40:43], s50 offen offset:1024
    v_mul_f32 v56, v56, v32
    v_mul_f32 v57, v57, v33
    v_mul_f32 v58, v58, v34
    v_mfma_f32_32x32x16_bf16 v[144:159], a[240:243], a[128:131], v[144:159]
    s_waitcnt lgkmcnt(5)
    ds_read_b128 a[236:239], v11 offset:2048
    v_mul_f32_dpp v208, v56, v49 quad_perm:[1,0,3,2] row_mask:0xf bank_mask:0xf
    v_fmac_f32 v208, v48, v56
    v_mul_f32 v59, v59, v35
    v_mul_f32_dpp v209, v57, v49 quad_perm:[1,0,3,2] row_mask:0xf bank_mask:0xf
    v_mfma_f32_32x32x16_bf16 v[144:159], a[244:247], a[132:135], v[144:159]
    ds_read_b128 a[240:243], v8 offset:3072
    ds_read_b64_tr_b16 v[216:217], v172 offset:0
    ds_read_b64_tr_b16 v[218:219], v172 offset:640
    v_fmac_f32 v209, v48, v57
    v_mul_f32_dpp v210, v58, v49 quad_perm:[1,0,3,2] row_mask:0xf bank_mask:0xf
    v_fmac_f32 v210, v48, v58
    v_fmac_f32_dpp v209, v208, v240 quad_perm:[1,0,3,2] row_mask:0xf bank_mask:0xf
    v_fmac_f32 v209, v224, v208
    v_mfma_f32_32x32x16_bf16 v[144:159], a[248:251], a[136:139], v[144:159]
    ds_read_b128 a[244:247], v9 offset:3072
    buffer_load_dwordx4 a[72:75], v2, s[40:43], s50 offen offset:2048
    ds_read_b64_tr_b16 v[220:221], v172 offset:16
    ds_read_b64_tr_b16 v[222:223], v172 offset:656
    v_mul_f32_dpp v211, v59, v49 quad_perm:[1,0,3,2] row_mask:0xf bank_mask:0xf
    v_fmac_f32 v211, v48, v59
    v_mfma_f32_32x32x16_bf16 v[144:159], a[252:255], a[140:143], v[144:159]
    s_waitcnt lgkmcnt(7)
    ds_read_b128 a[248:251], v10 offset:3072
    v_mul_f32 v60, v60, v36
    v_fmac_f32_dpp v210, v209, v240 quad_perm:[1,0,3,2] row_mask:0xf bank_mask:0xf
    v_fmac_f32 v210, v224, v209
    v_mul_f32_dpp v212, v60, v49 quad_perm:[1,0,3,2] row_mask:0xf bank_mask:0xf
    v_fmac_f32 v212, v48, v60
    v_mul_f32 v61, v61, v37
    v_fmac_f32_dpp v211, v210, v240 quad_perm:[1,0,3,2] row_mask:0xf bank_mask:0xf
    v_mfma_f32_32x32x16_bf16 v[144:159], a[224:227], a[144:147], v[144:159]
    s_waitcnt lgkmcnt(1)
    ds_read_b128 a[252:255], v11 offset:3072
    buffer_store_dwordx4 v[216:219], v173, s[24:27], s54 offen sc1
    v_mfma_f32_32x32x16_bf16 v[144:159], a[228:231], a[148:151], v[144:159]
    s_add_u32 s54, s54, 96256
    ds_read_b128 a[224:227], v8 offset:4096
    buffer_load_dwordx4 a[76:79], v2, s[40:43], s50 offen offset:3072
    v_fmac_f32 v211, v224, v210
    v_mul_f32_dpp v213, v61, v49 quad_perm:[1,0,3,2] row_mask:0xf bank_mask:0xf
    v_fmac_f32 v213, v48, v61
    v_mul_f32 v62, v62, v38
    v_mfma_f32_32x32x16_bf16 v[144:159], a[232:235], a[152:155], v[144:159]
    ds_read_b128 a[228:231], v9 offset:4096
    v_fmac_f32_dpp v212, v211, v240 quad_perm:[1,0,3,2] row_mask:0xf bank_mask:0xf
    v_fmac_f32 v212, v224, v211
    v_mul_f32_dpp v214, v62, v49 quad_perm:[1,0,3,2] row_mask:0xf bank_mask:0xf
    v_fmac_f32 v214, v48, v62
    v_mul_f32 v63, v63, v39
    v_fmac_f32_dpp v213, v212, v240 quad_perm:[1,0,3,2] row_mask:0xf bank_mask:0xf
    v_mfma_f32_32x32x16_bf16 v[144:159], a[236:239], a[156:159], v[144:159]
    s_add_u32 s50, s48, 20480
    ds_read_b128 a[232:235], v10 offset:4096
    buffer_store_dwordx4 v[220:223], v173, s[24:27], s54 offen sc1
    v_mfma_f32_32x32x16_bf16 v[144:159], a[240:243], a[160:163], v[144:159]
    s_add_u32 s54, s54, 1443840
    ds_read_b128 a[236:239], v11 offset:4096
    v_fmac_f32 v213, v224, v212
    v_mul_f32_dpp v215, v63, v49 quad_perm:[1,0,3,2] row_mask:0xf bank_mask:0xf
    v_fmac_f32 v215, v48, v63
    v_mul_f32 v64, v64, v40
    v_fmac_f32_dpp v214, v213, v240 quad_perm:[1,0,3,2] row_mask:0xf bank_mask:0xf
    v_fmac_f32 v214, v224, v213
    v_mfma_f32_32x32x16_bf16 v[144:159], a[244:247], a[164:167], v[144:159]
    s_waitcnt lgkmcnt(3)
    ds_read_b128 a[240:243], v8 offset:5120
    v_mul_f32_dpp v216, v64, v49 quad_perm:[1,0,3,2] row_mask:0xf bank_mask:0xf
    v_fmac_f32 v216, v48, v64
    v_mul_f32 v65, v65, v41
    v_fmac_f32_dpp v215, v214, v240 quad_perm:[1,0,3,2] row_mask:0xf bank_mask:0xf
    v_fmac_f32 v215, v224, v214
    v_mul_f32_dpp v217, v65, v49 quad_perm:[1,0,3,2] row_mask:0xf bank_mask:0xf
    v_mfma_f32_32x32x16_bf16 v[144:159], a[248:251], a[168:171], v[144:159]
    ds_read_b128 a[244:247], v9 offset:5120
    buffer_load_dwordx4 a[80:83], v2, s[40:43], s50 offen offset:0
    v_fmac_f32 v217, v48, v65
    v_mul_f32 v66, v66, v42
    v_fmac_f32_dpp v216, v215, v240 quad_perm:[1,0,3,2] row_mask:0xf bank_mask:0xf
    v_fmac_f32 v216, v224, v215
    v_mfma_f32_32x32x16_bf16 v[144:159], a[252:255], a[172:175], v[144:159]
    ds_read_b128 a[248:251], v10 offset:5120
    v_mul_f32_dpp v218, v66, v49 quad_perm:[1,0,3,2] row_mask:0xf bank_mask:0xf
    v_fmac_f32 v218, v48, v66
    v_mul_f32 v67, v67, v43
    v_fmac_f32_dpp v217, v216, v240 quad_perm:[1,0,3,2] row_mask:0xf bank_mask:0xf
    v_fmac_f32 v217, v224, v216
    v_mul_f32_dpp v219, v67, v49 quad_perm:[1,0,3,2] row_mask:0xf bank_mask:0xf
    v_mfma_f32_32x32x16_bf16 v[144:159], a[224:227], a[176:179], v[144:159]
    s_waitcnt lgkmcnt(3)
    ds_read_b128 a[252:255], v11 offset:5120
    buffer_load_dwordx4 a[84:87], v2, s[40:43], s50 offen offset:1024
    v_fmac_f32 v219, v48, v67
    v_mul_f32 v68, v68, v44
    v_fmac_f32_dpp v218, v217, v240 quad_perm:[1,0,3,2] row_mask:0xf bank_mask:0xf
    v_fmac_f32 v218, v224, v217
    v_mfma_f32_32x32x16_bf16 v[144:159], a[228:231], a[180:183], v[144:159]
    ds_read_b128 a[224:227], v8 offset:6144
    v_mul_f32_dpp v220, v68, v49 quad_perm:[1,0,3,2] row_mask:0xf bank_mask:0xf
    v_fmac_f32 v220, v48, v68
    v_mul_f32 v69, v69, v45
    v_fmac_f32_dpp v219, v218, v240 quad_perm:[1,0,3,2] row_mask:0xf bank_mask:0xf
    v_fmac_f32 v219, v224, v218
    v_mul_f32_dpp v221, v69, v49 quad_perm:[1,0,3,2] row_mask:0xf bank_mask:0xf
    v_mfma_f32_32x32x16_bf16 v[144:159], a[232:235], a[184:187], v[144:159]
    ds_read_b128 a[228:231], v9 offset:6144
    v_fmac_f32 v221, v48, v69
    v_mul_f32 v70, v70, v46
    v_fmac_f32_dpp v220, v219, v240 quad_perm:[1,0,3,2] row_mask:0xf bank_mask:0xf
    v_fmac_f32 v220, v224, v219
    v_mul_f32_dpp v222, v70, v49 quad_perm:[1,0,3,2] row_mask:0xf bank_mask:0xf
    v_fmac_f32 v222, v48, v70
    v_mfma_f32_32x32x16_bf16 v[144:159], a[236:239], a[188:191], v[144:159]
    s_waitcnt lgkmcnt(3)
    ds_read_b128 a[232:235], v10 offset:6144
    buffer_load_dwordx4 a[88:91], v2, s[40:43], s50 offen offset:2048
    v_mul_f32 v71, v71, v47
    v_fmac_f32_dpp v221, v220, v240 quad_perm:[1,0,3,2] row_mask:0xf bank_mask:0xf
    v_fmac_f32 v221, v224, v220
    v_mul_f32_dpp v223, v71, v49 quad_perm:[1,0,3,2] row_mask:0xf bank_mask:0xf
    v_mfma_f32_32x32x16_bf16 v[144:159], a[240:243], a[192:195], v[144:159]
    ds_read_b128 a[236:239], v11 offset:6144
    v_fmac_f32 v223, v48, v71
    v_fmac_f32_dpp v222, v221, v240 quad_perm:[1,0,3,2] row_mask:0xf bank_mask:0xf
    v_fmac_f32 v222, v224, v221
    s_nop 1
    v_fmac_f32_dpp v223, v222, v240 quad_perm:[1,0,3,2] row_mask:0xf bank_mask:0xf
    v_fmac_f32 v223, v224, v222
    v_mov_b32 v51, v223
    v_mfma_f32_32x32x16_bf16 v[144:159], a[244:247], a[196:199], v[144:159]
    ds_read_b128 a[240:243], v8 offset:7168
    v_mov_b32 v54, v223
    s_nop 1
    v_permlane32_swap_b32 v51, v54
    v_cndmask_b32 v168, 0, v51, s[82:83]
    v_fmac_f32 v54, v239, v51
    v_mul_f32_dpp v52, v51, v255 quad_perm:[1,0,3,2] row_mask:0xf bank_mask:0xf
    v_add_f32 v54, v54, v52
    v_mfma_f32_32x32x16_bf16 v[144:159], a[248:251], a[200:203], v[144:159]
    s_waitcnt lgkmcnt(3)
    ds_read_b128 a[244:247], v9 offset:7168
    buffer_load_dwordx4 a[92:95], v2, s[40:43], s50 offen offset:3072
    buffer_store_dwordx2 v[54:55], v169, s[44:47], s72 offen sc1
    s_add_u32 s72, s72, 2048
    s_waitcnt vmcnt(13)
    v_xor_b32 v89, v89, v13
    v_xor_b32 v91, v91, v13
    v_xor_b32 v93, v93, v13
    v_xor_b32 v95, v95, v13
    v_or3_b32 v89, v89, v91, v93
    v_or_b32 v89, v89, v95
    v_cmp_ne_u32 vcc, 0, v89
    s_cbranch_vccnz Laggs_20
Laggb_21:
    v_mfma_f32_32x32x16_bf16 v[144:159], a[252:255], a[204:207], v[144:159]
    s_add_u32 s73, s73, 4096
    ds_read_b128 a[248:251], v10 offset:7168
    v_mul_f32_dpp v89, v88, v76 quad_perm:[1,0,3,2] row_mask:0xf bank_mask:0xf
    v_mul_f32_dpp v93, v88, v84 quad_perm:[1,0,3,2] row_mask:0xf bank_mask:0xf
    v_mul_f32 v91, v72, v88
    v_mul_f32 v95, v80, v88
    v_fmac_f32_dpp v89, v90, v77 quad_perm:[1,0,3,2] row_mask:0xf bank_mask:0xf
    v_mfma_f32_32x32x16_bf16 v[144:159], a[224:227], a[208:211], v[144:159]
    s_add_u32 s50, s48, 24576
    ds_read_b128 a[252:255], v11 offset:7168
    v_fmac_f32_dpp v93, v90, v85 quad_perm:[1,0,3,2] row_mask:0xf bank_mask:0xf
    v_fmac_f32 v91, v73, v90
    v_fmac_f32 v95, v81, v90
    v_fmac_f32_dpp v89, v92, v78 quad_perm:[1,0,3,2] row_mask:0xf bank_mask:0xf
    v_fmac_f32_dpp v93, v92, v86 quad_perm:[1,0,3,2] row_mask:0xf bank_mask:0xf
    v_mfma_f32_32x32x16_bf16 v[144:159], a[228:231], a[212:215], v[144:159]
    s_waitcnt lgkmcnt(3)
    ds_read_b128 a[224:227], v8 offset:8192
    v_fmac_f32 v91, v74, v92
    v_fmac_f32 v95, v82, v92
    v_fmac_f32_dpp v89, v94, v79 quad_perm:[1,0,3,2] row_mask:0xf bank_mask:0xf
    v_fmac_f32_dpp v93, v94, v87 quad_perm:[1,0,3,2] row_mask:0xf bank_mask:0xf
    v_fmac_f32 v91, v75, v94
    v_mfma_f32_32x32x16_bf16 v[144:159], a[232:235], a[216:219], v[144:159]
    ds_read_b128 a[228:231], v9 offset:8192
    v_fmac_f32 v95, v83, v94
    v_add_f32 v89, v89, v91
    v_add_f32 v93, v93, v95
    v_mov_b32 v91, v89
    v_mov_b32 v95, v93
    v_mfma_f32_32x32x16_bf16 v[144:159], a[236:239], a[220:223], v[144:159]
    ds_read_b128 a[232:235], v10 offset:8192
    buffer_load_dwordx4 a[96:99], v2, s[40:43], s50 offen offset:0
    v_mul_f32_dpp v51, v53, v161 quad_perm:[1,0,3,2] row_mask:0xf bank_mask:0xf
    v_mul_f32_dpp v52, v53, v163 quad_perm:[1,0,3,2] row_mask:0xf bank_mask:0xf
    v_permlane32_swap_b32 v89, v91
    v_mfma_f32_32x32x16_bf16 v[144:159], a[240:243], v[96:99], v[144:159]
    s_waitcnt lgkmcnt(3)
    ds_read_b128 a[236:239], v11 offset:8192
    v_permlane32_swap_b32 v93, v95
    v_fmac_f32 v51, v160, v53
    v_fmac_f32 v52, v162, v53
    v_add_f32 v93, v93, v95
    v_add_f32 v89, v89, v91
    v_add_f32 v51, v51, v93
    v_mfma_f32_32x32x16_bf16 v[144:159], a[244:247], v[100:103], v[144:159]
    ds_read_b128 a[240:243], v8 offset:9216
    buffer_load_dwordx4 a[100:103], v2, s[40:43], s50 offen offset:1024
    v_add_f32 v53, v52, v89
    v_fma_f32 v174, v164, v51, v166
    v_mul_f32_dpp v52, v51, v165 quad_perm:[1,0,3,2] row_mask:0xf bank_mask:0xf
    v_mfma_f32_32x32x16_bf16 v[144:159], a[248:251], v[104:107], v[144:159]
    ds_read_b128 a[244:247], v9 offset:9216
    v_add_f32 v174, v174, v52
    v_fmac_f32 v176, v224, v174
    v_fmac_f32 v177, v225, v174
    v_mov_b32_dpp v175, v174 quad_perm:[1,0,3,2] row_mask:0xf bank_mask:0xf
    v_fmac_f32 v178, v226, v174
    v_mfma_f32_32x32x16_bf16 v[144:159], a[252:255], v[108:111], v[144:159]
    s_waitcnt lgkmcnt(3)
    ds_read_b128 a[248:251], v10 offset:9216
    buffer_load_dwordx2 v[88:89], v170, s[44:47], s73 offen offset:0 sc1
    v_fmac_f32 v179, v227, v174
    v_fmac_f32 v180, v228, v174
    v_fmac_f32 v181, v229, v174
    v_fmac_f32 v182, v230, v174
    v_mfma_f32_32x32x16_bf16 v[144:159], a[224:227], v[112:115], v[144:159]
    ds_read_b128 a[252:255], v11 offset:9216
    buffer_load_dwordx4 a[104:107], v2, s[40:43], s50 offen offset:2048
    buffer_load_dwordx2 v[90:91], v170, s[44:47], s73 offen offset:256 sc1
    v_fmac_f32 v183, v231, v174
    v_fmac_f32 v184, v232, v174
    v_fmac_f32 v185, v233, v174
    v_fmac_f32 v186, v234, v174
    v_mfma_f32_32x32x16_bf16 v[144:159], a[228:231], v[116:119], v[144:159]
    buffer_load_dwordx2 v[92:93], v170, s[44:47], s73 offen offset:512 sc1
    v_add_u32 v8, 0xffff6000, v8
    v_add_u32 v9, 0xffff6000, v9
    v_fmac_f32 v187, v235, v174
    v_fmac_f32 v188, v236, v174
    v_fmac_f32 v189, v237, v174
    v_fmac_f32 v190, v238, v174
    v_mfma_f32_32x32x16_bf16 v[144:159], a[232:235], v[120:123], v[144:159]
    s_waitcnt lgkmcnt(2)
    buffer_load_dwordx4 a[108:111], v2, s[40:43], s50 offen offset:3072
    buffer_load_dwordx2 v[94:95], v170, s[44:47], s73 offen offset:768 sc1
    v_add_u32 v10, 0xffff6000, v10
    v_add_u32 v11, 0xffff6000, v11
    v_fmac_f32 v191, v239, v174
    v_mfma_f32_32x32x16_bf16 v[144:159], a[236:239], v[124:127], v[144:159]
    s_waitcnt vmcnt(13) lgkmcnt(0)
    s_barrier
    ds_read_b32 v16, v27 offset:768
    ds_read_b128 a[224:227], v8 offset:0
    ds_read_b128 a[228:231], v9 offset:0
    ds_read_b128 a[232:235], v10 offset:0
    v_fmac_f32 v176, v240, v175
    v_mfma_f32_32x32x16_bf16 v[144:159], a[240:243], v[128:131], v[144:159]
    ds_read_b128 v[32:35], v0 offset:768
    ds_read_b128 a[236:239], v11 offset:0
    buffer_store_dword v13, v14, s[28:31], s55 offen sc1
    s_add_u32 s55, s55, 65536
    v_fmac_f32 v177, v241, v175
    v_mfma_f32_32x32x16_bf16 v[144:159], a[244:247], v[132:135], v[144:159]
    s_add_u32 s50, s48, 28672
    ds_read_b128 v[36:39], v0 offset:784
    ds_read_b128 a[240:243], v8 offset:1024
    v_fmac_f32 v178, v242, v175
    v_fmac_f32 v179, v243, v175
    v_fmac_f32 v180, v244, v175
    v_fmac_f32 v181, v245, v175
    v_mfma_f32_32x32x16_bf16 v[144:159], a[248:251], v[136:139], v[144:159]
    ds_read_b128 v[40:43], v0 offset:800
    ds_read_b128 a[244:247], v9 offset:1024
    v_fmac_f32 v182, v246, v175
    v_fmac_f32 v183, v247, v175
    v_fmac_f32 v184, v248, v175
    v_fmac_f32 v185, v249, v175
    v_mfma_f32_32x32x16_bf16 v[144:159], a[252:255], v[140:143], v[144:159]
    ds_read_b128 v[44:47], v0 offset:816
    ds_read_b128 a[248:251], v10 offset:1024
    s_waitcnt lgkmcnt(9)
    v_fmac_f32 v186, v250, v175
    v_fmac_f32 v187, v251, v175
    v_fmac_f32 v188, v252, v175
    v_fmac_f32 v189, v253, v175
    v_mfma_f32_32x32x16_bf16 v[144:159], v[16:19], v[20:23], v[144:159]
    v_mfma_f32_32x32x16_bf16 v[56:71], a[224:227], a[112:115], 0
    ds_read_b128 a[252:255], v11 offset:1024
    v_fmac_f32 v190, v254, v175
    v_fmac_f32 v191, v255, v175
    v_cvt_pk_bf16_f32 v176, v176, v177
    v_cvt_pk_bf16_f32 v177, v178, v179
    v_cvt_pk_bf16_f32 v178, v180, v181
    v_cvt_pk_bf16_f32 v179, v182, v183
    v_mfma_f32_32x32x16_bf16 v[56:71], a[228:231], a[116:119], v[56:71]
    s_waitcnt lgkmcnt(5)
    ds_read_b128 a[224:227], v8 offset:2048
    buffer_load_dwordx4 a[112:115], v2, s[40:43], s50 offen offset:0
    ds_write_b128 v171, v[176:179] offset:2560
    v_mfma_f32_32x32x16_bf16 v[56:71], a[232:235], a[120:123], v[56:71]
    ds_read_b128 a[228:231], v9 offset:2048
    buffer_load_dwordx4 a[116:119], v2, s[40:43], s50 offen offset:1024
    v_cvt_pk_bf16_f32 v180, v184, v185
    v_cvt_pk_bf16_f32 v181, v186, v187
    v_cvt_pk_bf16_f32 v182, v188, v189
    v_cvt_pk_bf16_f32 v183, v190, v191
    v_mfma_f32_32x32x16_bf16 v[56:71], a[236:239], a[124:127], v[56:71]
    ds_read_b128 a[232:235], v10 offset:2048
    ds_write_b128 v171, v[180:183] offset:2576
    s_waitcnt lgkmcnt(7)
    v_mul_f32 v144, v144, v32
    v_mul_f32 v145, v145, v33
    v_mfma_f32_32x32x16_bf16 v[56:71], a[240:243], a[128:131], v[56:71]
    s_waitcnt lgkmcnt(5)
    ds_read_b128 a[236:239], v11 offset:2048
    buffer_load_dwordx4 a[120:123], v2, s[40:43], s50 offen offset:2048
    v_mul_f32 v146, v146, v34
    v_mul_f32_dpp v176, v144, v49 quad_perm:[1,0,3,2] row_mask:0xf bank_mask:0xf
    v_fmac_f32 v176, v48, v144
    v_mul_f32 v147, v147, v35
    v_mul_f32_dpp v177, v145, v49 quad_perm:[1,0,3,2] row_mask:0xf bank_mask:0xf
    v_mfma_f32_32x32x16_bf16 v[56:71], a[244:247], a[132:135], v[56:71]
    ds_read_b128 a[240:243], v8 offset:3072
    ds_read_b64_tr_b16 v[184:185], v172 offset:2560
    ds_read_b64_tr_b16 v[186:187], v172 offset:3200
    v_fmac_f32 v177, v48, v145
    v_mul_f32_dpp v178, v146, v49 quad_perm:[1,0,3,2] row_mask:0xf bank_mask:0xf
    v_fmac_f32 v178, v48, v146
    v_fmac_f32_dpp v177, v176, v240 quad_perm:[1,0,3,2] row_mask:0xf bank_mask:0xf
    v_fmac_f32 v177, v224, v176
    v_mfma_f32_32x32x16_bf16 v[56:71], a[248:251], a[136:139], v[56:71]
    ds_read_b128 a[244:247], v9 offset:3072
    ds_read_b64_tr_b16 v[188:189], v172 offset:2576
    ds_read_b64_tr_b16 v[190:191], v172 offset:3216
    buffer_load_dwordx4 a[124:127], v2, s[40:43], s50 offen offset:3072
    s_add_u32 s50, s48, 32768
    v_mul_f32_dpp v179, v147, v49 quad_perm:[1,0,3,2] row_mask:0xf bank_mask:0xf
    v_fmac_f32 v179, v48, v147
    v_mfma_f32_32x32x16_bf16 v[56:71], a[252:255], a[140:143], v[56:71]
    s_waitcnt lgkmcnt(8)
    ds_read_b128 a[248:251], v10 offset:3072
    v_mul_f32 v148, v148, v36
    v_fmac_f32_dpp v178, v177, v240 quad_perm:[1,0,3,2] row_mask:0xf bank_mask:0xf
    v_fmac_f32 v178, v224, v177
    v_mul_f32_dpp v180, v148, v49 quad_perm:[1,0,3,2] row_mask:0xf bank_mask:0xf
    v_fmac_f32 v180, v48, v148
    v_mul_f32 v149, v149, v37
    v_fmac_f32_dpp v179, v178, v240 quad_perm:[1,0,3,2] row_mask:0xf bank_mask:0xf
    v_mfma_f32_32x32x16_bf16 v[56:71], a[224:227], a[144:147], v[56:71]
    s_waitcnt lgkmcnt(1)
    ds_read_b128 a[252:255], v11 offset:3072
    buffer_load_dwordx4 a[128:131], v2, s[40:43], s50 offen offset:0
    buffer_store_dwordx4 v[184:187], v173, s[24:27], s54 offen sc1
    v_mfma_f32_32x32x16_bf16 v[56:71], a[228:231], a[148:151], v[56:71]
    s_add_u32 s54, s54, 96256
    ds_read_b128 a[224:227], v8 offset:4096
    v_fmac_f32 v179, v224, v178
    v_mul_f32_dpp v181, v149, v49 quad_perm:[1,0,3,2] row_mask:0xf bank_mask:0xf
    v_fmac_f32 v181, v48, v149
    v_mul_f32 v150, v150, v38
    v_fmac_f32_dpp v180, v179, v240 quad_perm:[1,0,3,2] row_mask:0xf bank_mask:0xf
    v_fmac_f32 v180, v224, v179
    v_mfma_f32_32x32x16_bf16 v[56:71], a[232:235], a[152:155], v[56:71]
    ds_read_b128 a[228:231], v9 offset:4096
    buffer_load_dwordx4 a[132:135], v2, s[40:43], s50 offen offset:1024
    v_mul_f32_dpp v182, v150, v49 quad_perm:[1,0,3,2] row_mask:0xf bank_mask:0xf
    v_fmac_f32 v182, v48, v150
    v_mul_f32 v151, v151, v39
    v_fmac_f32_dpp v181, v180, v240 quad_perm:[1,0,3,2] row_mask:0xf bank_mask:0xf
    v_mfma_f32_32x32x16_bf16 v[56:71], a[236:239], a[156:159], v[56:71]
    ds_read_b128 a[232:235], v10 offset:4096
    buffer_store_dwordx4 v[188:191], v173, s[24:27], s54 offen sc1
    v_mfma_f32_32x32x16_bf16 v[56:71], a[240:243], a[160:163], v[56:71]
    s_add_u32 s54, s54, 1443840
    ds_read_b128 a[236:239], v11 offset:4096
    buffer_load_dwordx4 a[136:139], v2, s[40:43], s50 offen offset:2048
    v_fmac_f32 v181, v224, v180
    v_mul_f32_dpp v183, v151, v49 quad_perm:[1,0,3,2] row_mask:0xf bank_mask:0xf
    v_fmac_f32 v183, v48, v151
    v_mul_f32 v152, v152, v40
    v_mfma_f32_32x32x16_bf16 v[56:71], a[244:247], a[164:167], v[56:71]
    s_waitcnt lgkmcnt(3)
    ds_read_b128 a[240:243], v8 offset:5120
    v_fmac_f32_dpp v182, v181, v240 quad_perm:[1,0,3,2] row_mask:0xf bank_mask:0xf
    v_fmac_f32 v182, v224, v181
    v_mul_f32_dpp v184, v152, v49 quad_perm:[1,0,3,2] row_mask:0xf bank_mask:0xf
    v_fmac_f32 v184, v48, v152
    v_mul_f32 v153, v153, v41
    v_mfma_f32_32x32x16_bf16 v[56:71], a[248:251], a[168:171], v[56:71]
    ds_read_b128 a[244:247], v9 offset:5120
    buffer_load_dwordx4 a[140:143], v2, s[40:43], s50 offen offset:3072
    s_add_u32 s50, s48, 36864
    v_fmac_f32_dpp v183, v182, v240 quad_perm:[1,0,3,2] row_mask:0xf bank_mask:0xf
    v_fmac_f32 v183, v224, v182
    v_mul_f32_dpp v185, v153, v49 quad_perm:[1,0,3,2] row_mask:0xf bank_mask:0xf
    v_mfma_f32_32x32x16_bf16 v[56:71], a[252:255], a[172:175], v[56:71]
    ds_read_b128 a[248:251], v10 offset:5120
    v_fmac_f32 v185, v48, v153
    v_mul_f32 v154, v154, v42
    v_fmac_f32_dpp v184, v183, v240 quad_perm:[1,0,3,2] row_mask:0xf bank_mask:0xf
    v_fmac_f32 v184, v224, v183
    v_mul_f32_dpp v186, v154, v49 quad_perm:[1,0,3,2] row_mask:0xf bank_mask:0xf
    v_mfma_f32_32x32x16_bf16 v[56:71], a[224:227], a[176:179], v[56:71]
    s_waitcnt lgkmcnt(3)
    ds_read_b128 a[252:255], v11 offset:5120
    buffer_load_dwordx4 a[144:147], v2, s[40:43], s50 offen offset:0
    v_fmac_f32 v186, v48, v154
    v_mul_f32 v155, v155, v43
    v_fmac_f32_dpp v185, v184, v240 quad_perm:[1,0,3,2] row_mask:0xf bank_mask:0xf
    v_fmac_f32 v185, v224, v184
    v_mfma_f32_32x32x16_bf16 v[56:71], a[228:231], a[180:183], v[56:71]
    ds_read_b128 a[224:227], v8 offset:6144
    v_mul_f32_dpp v187, v155, v49 quad_perm:[1,0,3,2] row_mask:0xf bank_mask:0xf
    v_fmac_f32 v187, v48, v155
    v_mul_f32 v156, v156, v44
    v_fmac_f32_dpp v186, v185, v240 quad_perm:[1,0,3,2] row_mask:0xf bank_mask:0xf
    v_fmac_f32 v186, v224, v185
    v_mfma_f32_32x32x16_bf16 v[56:71], a[232:235], a[184:187], v[56:71]
    ds_read_b128 a[228:231], v9 offset:6144
    buffer_load_dwordx4 a[148:151], v2, s[40:43], s50 offen offset:1024
    v_mul_f32_dpp v188, v156, v49 quad_perm:[1,0,3,2] row_mask:0xf bank_mask:0xf
    v_fmac_f32 v188, v48, v156
    v_mul_f32 v157, v157, v45
    v_fmac_f32_dpp v187, v186, v240 quad_perm:[1,0,3,2] row_mask:0xf bank_mask:0xf
    v_mfma_f32_32x32x16_bf16 v[56:71], a[236:239], a[188:191], v[56:71]
    s_waitcnt lgkmcnt(3)
    ds_read_b128 a[232:235], v10 offset:6144
    v_fmac_f32 v187, v224, v186
    v_mul_f32_dpp v189, v157, v49 quad_perm:[1,0,3,2] row_mask:0xf bank_mask:0xf
    v_fmac_f32 v189, v48, v157
    v_mul_f32 v158, v158, v46
    v_fmac_f32_dpp v188, v187, v240 quad_perm:[1,0,3,2] row_mask:0xf bank_mask:0xf
    v_fmac_f32 v188, v224, v187
    v_mfma_f32_32x32x16_bf16 v[56:71], a[240:243], a[192:195], v[56:71]
    ds_read_b128 a[236:239], v11 offset:6144
    s_mul_i32 s16, s15, 6
    s_add_u32 s17, s15, 23
    s_cmp_eq_u32 s8, 0
    s_cselect_b32 s16, s16, s17
    s_cselect_b32 s17, 5, 1
    s_cselect_b32 s18, 64, 2
    v_and_b32 v6, 7, v1
    v_min_u32 v7, s17, v6
    v_add_u32 v7, s16, v7
    v_min_u32 v7, 26, v7
    s_and_b32 s16, s15, 1
    s_mul_i32 s16, s16, 5
    s_add_u32 s16, s16, 25
    v_cmp_gt_u32 vcc, s18, v6
    v_min_u32 v6, 6, v6
    v_add_u32 v6, s16, v6
    v_cndmask_b32 v7, v6, v7, vcc
    v_and_b32 v6, 8, v1
    v_lshl_add_u32 v7, v6, 3, v7
    v_lshlrev_b32 v7, 7, v7
    buffer_load_dwordx4 a[152:155], v2, s[40:43], s50 offen offset:2048
    v_mfma_f32_32x32x16_bf16 v[56:71], a[244:247], a[196:199], v[56:71]
    ds_read_b128 a[240:243], v8 offset:7168
    buffer_load_dwordx4 a[156:159], v2, s[40:43], s50 offen offset:3072
    s_add_u32 s50, s48, 40960
    v_mul_f32_dpp v190, v158, v49 quad_perm:[1,0,3,2] row_mask:0xf bank_mask:0xf
    v_fmac_f32 v190, v48, v158
    v_mul_f32 v159, v159, v47
    v_mfma_f32_32x32x16_bf16 v[56:71], a[248:251], a[200:203], v[56:71]
    s_waitcnt lgkmcnt(3)
    ds_read_b128 a[244:247], v9 offset:7168
    v_fmac_f32_dpp v189, v188, v240 quad_perm:[1,0,3,2] row_mask:0xf bank_mask:0xf
    v_fmac_f32 v189, v224, v188
    v_mul_f32_dpp v191, v159, v49 quad_perm:[1,0,3,2] row_mask:0xf bank_mask:0xf
    v_fmac_f32 v191, v48, v159
    v_fmac_f32_dpp v190, v189, v240 quad_perm:[1,0,3,2] row_mask:0xf bank_mask:0xf
    v_mfma_f32_32x32x16_bf16 v[56:71], a[252:255], a[204:207], v[56:71]
    ds_read_b128 a[248:251], v10 offset:7168
    buffer_load_dwordx4 a[160:163], v2, s[40:43], s50 offen offset:0
    v_fmac_f32 v190, v224, v189
    s_nop 1
    v_fmac_f32_dpp v191, v190, v240 quad_perm:[1,0,3,2] row_mask:0xf bank_mask:0xf
    v_fmac_f32 v191, v224, v190
    v_mov_b32 v51, v191
    v_mfma_f32_32x32x16_bf16 v[56:71], a[224:227], a[208:211], v[56:71]
    ds_read_b128 a[252:255], v11 offset:7168
    v_mov_b32 v54, v191
    s_nop 1
    v_permlane32_swap_b32 v51, v54
    v_cndmask_b32 v166, 0, v51, s[82:83]
    v_fmac_f32 v54, v239, v51
    v_mul_f32_dpp v52, v51, v255 quad_perm:[1,0,3,2] row_mask:0xf bank_mask:0xf
    v_add_f32 v54, v54, v52
    v_mfma_f32_32x32x16_bf16 v[56:71], a[228:231], a[212:215], v[56:71]
    s_waitcnt lgkmcnt(3)
    ds_read_b128 a[224:227], v8 offset:8192
    buffer_load_dwordx4 a[164:167], v2, s[40:43], s50 offen offset:1024
    buffer_store_dwordx2 v[54:55], v169, s[44:47], s72 offen sc1
    v_mfma_f32_32x32x16_bf16 v[56:71], a[232:235], a[216:219], v[56:71]
    s_add_u32 s72, s72, 2048
    ds_read_b128 a[228:231], v9 offset:8192
    s_waitcnt vmcnt(9)
    s_barrier
    v_xor_b32 v89, v89, v13
    v_xor_b32 v91, v91, v13
    v_xor_b32 v93, v93, v13
    v_xor_b32 v95, v95, v13
    v_or3_b32 v89, v89, v91, v93
    v_or_b32 v89, v89, v95
    v_cmp_ne_u32 vcc, 0, v89
    s_cbranch_vccnz Laggs_22
Laggb_23:
    v_mfma_f32_32x32x16_bf16 v[56:71], a[236:239], a[220:223], v[56:71]
    s_add_u32 s73, s73, 0
    ds_read_b128 a[232:235], v10 offset:8192
    buffer_store_dword v13, v14, s[28:31], s55 offen sc1
    s_add_u32 s55, s55, 65536
    buffer_load_dwordx4 a[168:171], v2, s[40:43], s50 offen offset:2048
    v_mfma_f32_32x32x16_bf16 v[56:71], a[240:243], v[96:99], v[56:71]
    s_waitcnt lgkmcnt(3)
    ds_read_b128 a[236:239], v11 offset:8192
    v_mul_f32_dpp v89, v88, v76 quad_perm:[1,0,3,2] row_mask:0xf bank_mask:0xf
    v_mul_f32_dpp v93, v88, v84 quad_perm:[1,0,3,2] row_mask:0xf bank_mask:0xf
    v_mul_f32 v91, v72, v88
    v_mul_f32 v95, v80, v88
    v_fmac_f32_dpp v89, v90, v77 quad_perm:[1,0,3,2] row_mask:0xf bank_mask:0xf
    v_fmac_f32_dpp v93, v90, v85 quad_perm:[1,0,3,2] row_mask:0xf bank_mask:0xf
    v_fmac_f32 v91, v73, v90
    v_mfma_f32_32x32x16_bf16 v[56:71], a[244:247], v[100:103], v[56:71]
    ds_read_b128 a[240:243], v8 offset:9216
    buffer_load_dwordx4 a[172:175], v2, s[40:43], s50 offen offset:3072
    s_add_u32 s50, s48, 45056
    v_fmac_f32 v95, v81, v90
    v_fmac_f32_dpp v89, v92, v78 quad_perm:[1,0,3,2] row_mask:0xf bank_mask:0xf
    v_fmac_f32_dpp v93, v92, v86 quad_perm:[1,0,3,2] row_mask:0xf bank_mask:0xf
    v_fmac_f32 v91, v74, v92
    v_mfma_f32_32x32x16_bf16 v[56:71], a[248:251], v[104:107], v[56:71]
    ds_read_b128 a[244:247], v9 offset:9216
    v_fmac_f32 v95, v82, v92
    v_fmac_f32_dpp v89, v94, v79 quad_perm:[1,0,3,2] row_mask:0xf bank_mask:0xf
    v_fmac_f32_dpp v93, v94, v87 quad_perm:[1,0,3,2] row_mask:0xf bank_mask:0xf
    v_fmac_f32 v91, v75, v94
    v_fmac_f32 v95, v83, v94
    v_add_f32 v89, v89, v91
    v_add_f32 v93, v93, v95
    v_mfma_f32_32x32x16_bf16 v[56:71], a[252:255], v[108:111], v[56:71]
    s_waitcnt lgkmcnt(3)
    ds_read_b128 a[248:251], v10 offset:9216
    buffer_load_dwordx4 a[176:179], v2, s[40:43], s50 offen offset:0
    v_mov_b32 v91, v89
    v_mov_b32 v95, v93
    v_mul_f32_dpp v51, v53, v161 quad_perm:[1,0,3,2] row_mask:0xf bank_mask:0xf
    v_mul_f32_dpp v52, v53, v163 quad_perm:[1,0,3,2] row_mask:0xf bank_mask:0xf
    v_permlane32_swap_b32 v89, v91
    v_mfma_f32_32x32x16_bf16 v[56:71], a[224:227], v[112:115], v[56:71]
    ds_read_b128 a[252:255], v11 offset:9216
    v_permlane32_swap_b32 v93, v95
    v_fmac_f32 v51, v160, v53
    v_fmac_f32 v52, v162, v53
    v_add_f32 v93, v93, v95
    v_add_f32 v89, v89, v91
    v_add_f32 v51, v51, v93
    v_add_f32 v53, v52, v89
    v_mfma_f32_32x32x16_bf16 v[56:71], a[228:231], v[116:119], v[56:71]
    buffer_load_dwordx4 a[180:183], v2, s[40:43], s50 offen offset:1024
    v_fma_f32 v174, v164, v51, v167
    v_mul_f32_dpp v52, v51, v165 quad_perm:[1,0,3,2] row_mask:0xf bank_mask:0xf
    v_add_f32 v174, v174, v52
    v_fmac_f32 v192, v224, v174
    v_fmac_f32 v193, v225, v174
    v_mov_b32_dpp v175, v174 quad_perm:[1,0,3,2] row_mask:0xf bank_mask:0xf
    v_fmac_f32 v194, v226, v174
    v_mfma_f32_32x32x16_bf16 v[56:71], a[232:235], v[120:123], v[56:71]
    s_waitcnt lgkmcnt(2)
    buffer_load_dwordx2 v[88:89], v170, s[44:47], s73 offen offset:2048 sc1
    v_fmac_f32 v195, v227, v174
    v_fmac_f32 v196, v228, v174
    v_fmac_f32 v197, v229, v174
    v_fmac_f32 v198, v230, v174
    v_mfma_f32_32x32x16_bf16 v[56:71], a[236:239], v[124:127], v[56:71]
    s_waitcnt lgkmcnt(0)
    ds_read_b32 v16, v27 offset:896
    buffer_load_dwordx4 a[184:187], v2, s[40:43], s50 offen offset:2048
    buffer_load_dwordx2 v[90:91], v170, s[44:47], s73 offen offset:2304 sc1
    v_fmac_f32 v199, v231, v174
    v_fmac_f32 v200, v232, v174
    v_fmac_f32 v201, v233, v174
    v_fmac_f32 v202, v234, v174
    v_mfma_f32_32x32x16_bf16 v[56:71], a[240:243], v[128:131], v[56:71]
    ds_read_b128 v[32:35], v0 offset:896
    buffer_load_dwordx2 v[92:93], v170, s[44:47], s73 offen offset:2560 sc1
    v_fmac_f32 v203, v235, v174
    v_fmac_f32 v204, v236, v174
    v_fmac_f32 v205, v237, v174
    v_fmac_f32 v206, v238, v174
    v_mfma_f32_32x32x16_bf16 v[56:71], a[244:247], v[132:135], v[56:71]
    ds_read_b128 v[36:39], v0 offset:912
L_hk6350:
    s_cbranch_execz L_hback
    buffer_load_dwordx2 v[94:95], v170, s[44:47], s73 offen offset:2816 sc1
    buffer_load_dwordx4 a[188:191], v2, s[40:43], s50 offen offset:3072
    s_add_u32 s50, s48, 49152
    v_fmac_f32 v207, v239, v174
    v_fmac_f32 v192, v240, v175
    v_mfma_f32_32x32x16_bf16 v[56:71], a[248:251], v[136:139], v[56:71]
    ds_read_b128 v[40:43], v0 offset:928
    v_fmac_f32 v193, v241, v175
    v_fmac_f32 v194, v242, v175
    v_fmac_f32 v195, v243, v175
    v_fmac_f32 v196, v244, v175
    v_fmac_f32 v197, v245, v175
    v_fmac_f32 v198, v246, v175
    v_fmac_f32 v199, v247, v175
    v_mfma_f32_32x32x16_bf16 v[56:71], a[252:255], v[140:143], v[56:71]
    ds_read_b128 v[44:47], v0 offset:944
    s_waitcnt lgkmcnt(4)
    v_fmac_f32 v200, v248, v175
    v_fmac_f32 v201, v249, v175
    v_fmac_f32 v202, v250, v175
    v_fmac_f32 v203, v251, v175
    v_fmac_f32 v204, v252, v175
    v_fmac_f32 v205, v253, v175
    v_mfma_f32_32x32x16_bf16 v[56:71], v[16:19], v[20:23], v[56:71]
    s_xor_b32 s16, s92, 0
    s_mul_i32 s11, s16, 192512
    s_lshl_b32 s87, s9, 14
    s_add_u32 s87, s87, 8320
    v_add_u32 v4, 96256, v2
    buffer_load_dword v6, v7, s[28:31], s87 offen sc1
    s_mov_b32 s57, 12288
    v_fmac_f32 v206, v254, v175
    v_fmac_f32 v207, v255, v175
    v_cvt_pk_bf16_f32 v192, v192, v193
    v_cvt_pk_bf16_f32 v193, v194, v195
    v_cvt_pk_bf16_f32 v194, v196, v197
    v_cvt_pk_bf16_f32 v195, v198, v199
    ds_write_b128 v171, v[192:195] offset:0
    v_cvt_pk_bf16_f32 v196, v200, v201
    v_cvt_pk_bf16_f32 v197, v202, v203
    v_cvt_pk_bf16_f32 v198, v204, v205
    v_cvt_pk_bf16_f32 v199, v206, v207
    ds_write_b128 v171, v[196:199] offset:16
    s_waitcnt lgkmcnt(2)
    v_mul_f32 v56, v56, v32
    v_mul_f32 v57, v57, v33
    v_mul_f32 v58, v58, v34
    v_mul_f32_dpp v192, v56, v49 quad_perm:[1,0,3,2] row_mask:0xf bank_mask:0xf
    v_fmac_f32 v192, v48, v56
    v_mul_f32 v59, v59, v35
    v_mul_f32_dpp v193, v57, v49 quad_perm:[1,0,3,2] row_mask:0xf bank_mask:0xf
    ds_read_b64_tr_b16 v[200:201], v172 offset:0
    ds_read_b64_tr_b16 v[202:203], v172 offset:640
    ds_read_b64_tr_b16 v[204:205], v172 offset:16
    ds_read_b64_tr_b16 v[206:207], v172 offset:656
    v_fmac_f32 v193, v48, v57
    v_mul_f32_dpp v194, v58, v49 quad_perm:[1,0,3,2] row_mask:0xf bank_mask:0xf
    v_fmac_f32 v194, v48, v58
    v_fmac_f32_dpp v193, v192, v240 quad_perm:[1,0,3,2] row_mask:0xf bank_mask:0xf
    v_fmac_f32 v193, v224, v192
    v_mul_f32_dpp v195, v59, v49 quad_perm:[1,0,3,2] row_mask:0xf bank_mask:0xf
    v_fmac_f32 v195, v48, v59
    v_mul_f32 v60, v60, v36
    v_fmac_f32_dpp v194, v193, v240 quad_perm:[1,0,3,2] row_mask:0xf bank_mask:0xf
    v_fmac_f32 v194, v224, v193
    v_mul_f32_dpp v196, v60, v49 quad_perm:[1,0,3,2] row_mask:0xf bank_mask:0xf
    v_fmac_f32 v196, v48, v60
    s_waitcnt lgkmcnt(0)
    buffer_store_dwordx4 v[200:203], v173, s[24:27], s54 offen sc1
    s_add_u32 s54, s54, 96256
    v_mul_f32 v61, v61, v37
    v_fmac_f32_dpp v195, v194, v240 quad_perm:[1,0,3,2] row_mask:0xf bank_mask:0xf
    v_fmac_f32 v195, v224, v194
    v_mul_f32_dpp v197, v61, v49 quad_perm:[1,0,3,2] row_mask:0xf bank_mask:0xf
    v_fmac_f32 v197, v48, v61
    v_mul_f32 v62, v62, v38
    v_fmac_f32_dpp v196, v195, v240 quad_perm:[1,0,3,2] row_mask:0xf bank_mask:0xf
    v_fmac_f32 v196, v224, v195
    v_mul_f32_dpp v198, v62, v49 quad_perm:[1,0,3,2] row_mask:0xf bank_mask:0xf
    v_fmac_f32 v198, v48, v62
    v_mul_f32 v63, v63, v39
    v_fmac_f32_dpp v197, v196, v240 quad_perm:[1,0,3,2] row_mask:0xf bank_mask:0xf
    buffer_store_dwordx4 v[204:207], v173, s[24:27], s54 offen sc1
    s_add_u32 s54, s54, 1443840
    v_fmac_f32 v197, v224, v196
    v_mul_f32_dpp v199, v63, v49 quad_perm:[1,0,3,2] row_mask:0xf bank_mask:0xf
    v_fmac_f32 v199, v48, v63
    v_mul_f32 v64, v64, v40
    v_fmac_f32_dpp v198, v197, v240 quad_perm:[1,0,3,2] row_mask:0xf bank_mask:0xf
    v_fmac_f32 v198, v224, v197
    v_mul_f32_dpp v200, v64, v49 quad_perm:[1,0,3,2] row_mask:0xf bank_mask:0xf
    v_fmac_f32 v200, v48, v64
    v_mul_f32 v65, v65, v41
    v_fmac_f32_dpp v199, v198, v240 quad_perm:[1,0,3,2] row_mask:0xf bank_mask:0xf
    v_fmac_f32 v199, v224, v198
    v_mul_f32_dpp v201, v65, v49 quad_perm:[1,0,3,2] row_mask:0xf bank_mask:0xf
    v_fmac_f32 v201, v48, v65
    v_mul_f32 v66, v66, v42
    v_fmac_f32_dpp v200, v199, v240 quad_perm:[1,0,3,2] row_mask:0xf bank_mask:0xf
    v_fmac_f32 v200, v224, v199
    v_mul_f32_dpp v202, v66, v49 quad_perm:[1,0,3,2] row_mask:0xf bank_mask:0xf
    v_fmac_f32 v202, v48, v66
    v_mul_f32 v67, v67, v43
    v_fmac_f32_dpp v201, v200, v240 quad_perm:[1,0,3,2] row_mask:0xf bank_mask:0xf
    v_fmac_f32 v201, v224, v200
    v_mul_f32_dpp v203, v67, v49 quad_perm:[1,0,3,2] row_mask:0xf bank_mask:0xf
    v_fmac_f32 v203, v48, v67
    v_mul_f32 v68, v68, v44
    v_fmac_f32_dpp v202, v201, v240 quad_perm:[1,0,3,2] row_mask:0xf bank_mask:0xf
    v_fmac_f32 v202, v224, v201
    v_mul_f32_dpp v204, v68, v49 quad_perm:[1,0,3,2] row_mask:0xf bank_mask:0xf
    v_fmac_f32 v204, v48, v68
    v_mul_f32 v69, v69, v45
    v_fmac_f32_dpp v203, v202, v240 quad_perm:[1,0,3,2] row_mask:0xf bank_mask:0xf
    v_fmac_f32 v203, v224, v202
    v_mul_f32_dpp v205, v69, v49 quad_perm:[1,0,3,2] row_mask:0xf bank_mask:0xf
    v_fmac_f32 v205, v48, v69
    v_mul_f32 v70, v70, v46
    v_fmac_f32_dpp v204, v203, v240 quad_perm:[1,0,3,2] row_mask:0xf bank_mask:0xf
    v_fmac_f32 v204, v224, v203
    v_mul_f32_dpp v206, v70, v49 quad_perm:[1,0,3,2] row_mask:0xf bank_mask:0xf
    v_fmac_f32 v206, v48, v70
    v_mul_f32 v71, v71, v47
    v_fmac_f32_dpp v205, v204, v240 quad_perm:[1,0,3,2] row_mask:0xf bank_mask:0xf
    v_fmac_f32 v205, v224, v204
    v_mul_f32_dpp v207, v71, v49 quad_perm:[1,0,3,2] row_mask:0xf bank_mask:0xf
    v_fmac_f32 v207, v48, v71
    v_fmac_f32_dpp v206, v205, v240 quad_perm:[1,0,3,2] row_mask:0xf bank_mask:0xf
    v_fmac_f32 v206, v224, v205
    s_nop 1
    v_fmac_f32_dpp v207, v206, v240 quad_perm:[1,0,3,2] row_mask:0xf bank_mask:0xf
    v_fmac_f32 v207, v224, v206
    v_mov_b32 v51, v207
    v_mov_b32 v54, v207
    s_nop 1
    v_permlane32_swap_b32 v51, v54
    v_cndmask_b32 v167, 0, v51, s[82:83]
    v_fmac_f32 v54, v239, v51
    v_mul_f32_dpp v52, v51, v255 quad_perm:[1,0,3,2] row_mask:0xf bank_mask:0xf
    v_add_f32 v54, v54, v52
    buffer_load_dwordx2 v[32:33], v170, s[44:47], s57 offen offset:0 sc1
    buffer_load_dwordx2 v[34:35], v170, s[44:47], s57 offen offset:256 sc1
    buffer_load_dwordx2 v[36:37], v170, s[44:47], s57 offen offset:512 sc1
    buffer_load_dwordx2 v[38:39], v170, s[44:47], s57 offen offset:768 sc1
    buffer_store_dwordx2 v[54:55], v169, s[44:47], s72 offen sc1
    s_add_u32 s72, s72, 2048
    s_waitcnt vmcnt(9)
    v_xor_b32 v89, v89, v13
    v_xor_b32 v91, v91, v13
    v_xor_b32 v93, v93, v13
    v_xor_b32 v95, v95, v13
    v_or3_b32 v89, v89, v91, v93
    v_or_b32 v89, v89, v95
    v_cmp_ne_u32 vcc, 0, v89
    s_cbranch_vccnz Laggs_24
Laggb_25:
    s_add_u32 s73, s73, 4096
    v_mul_f32_dpp v89, v88, v76 quad_perm:[1,0,3,2] row_mask:0xf bank_mask:0xf
    v_mul_f32_dpp v93, v88, v84 quad_perm:[1,0,3,2] row_mask:0xf bank_mask:0xf
    v_mul_f32 v91, v72, v88
    v_mul_f32 v95, v80, v88
    buffer_load_dwordx4 a[192:195], v2, s[40:43], s50 offen offset:0
    v_fmac_f32_dpp v89, v90, v77 quad_perm:[1,0,3,2] row_mask:0xf bank_mask:0xf
    v_fmac_f32_dpp v93, v90, v85 quad_perm:[1,0,3,2] row_mask:0xf bank_mask:0xf
    v_fmac_f32 v91, v73, v90
    v_fmac_f32 v95, v81, v90
    v_fmac_f32_dpp v89, v92, v78 quad_perm:[1,0,3,2] row_mask:0xf bank_mask:0xf
    buffer_load_dwordx4 a[196:199], v2, s[40:43], s50 offen offset:1024
    s_add_u32 s50, s49, 0
    v_fmac_f32_dpp v93, v92, v86 quad_perm:[1,0,3,2] row_mask:0xf bank_mask:0xf
    v_fmac_f32 v91, v74, v92
    v_fmac_f32 v95, v82, v92
    v_fmac_f32_dpp v89, v94, v79 quad_perm:[1,0,3,2] row_mask:0xf bank_mask:0xf
    v_fmac_f32_dpp v93, v94, v87 quad_perm:[1,0,3,2] row_mask:0xf bank_mask:0xf
    buffer_load_dwordx4 a[200:203], v2, s[40:43], s50 offen offset:0
    v_fmac_f32 v91, v75, v94
    v_fmac_f32 v95, v83, v94
    v_add_f32 v89, v89, v91
    v_add_f32 v93, v93, v95
    v_mov_b32 v91, v89
    buffer_load_dwordx4 a[204:207], v2, s[40:43], s50 offen offset:1024
    v_mov_b32 v95, v93
    v_mul_f32_dpp v51, v53, v161 quad_perm:[1,0,3,2] row_mask:0xf bank_mask:0xf
    v_mul_f32_dpp v52, v53, v163 quad_perm:[1,0,3,2] row_mask:0xf bank_mask:0xf
    v_permlane32_swap_b32 v89, v91
    buffer_load_dwordx4 a[208:211], v2, s[40:43], s50 offen offset:2048
    v_permlane32_swap_b32 v93, v95
    v_fmac_f32 v51, v160, v53
    v_fmac_f32 v52, v162, v53
    v_add_f32 v93, v93, v95
    v_add_f32 v89, v89, v91
    buffer_load_dwordx4 a[212:215], v2, s[40:43], s50 offen offset:3072
    s_add_u32 s50, s49, 4096
    v_add_f32 v51, v51, v93
    v_add_f32 v53, v52, v89
    v_fma_f32 v174, v164, v51, v168
    v_mul_f32_dpp v52, v51, v165 quad_perm:[1,0,3,2] row_mask:0xf bank_mask:0xf
    v_add_f32 v174, v174, v52
    buffer_load_dwordx4 a[216:219], v2, s[40:43], s50 offen offset:0
    s_add_u32 s50, s84, 0
    v_fmac_f32 v208, v224, v174
    v_fmac_f32 v209, v225, v174
    v_mov_b32_dpp v175, v174 quad_perm:[1,0,3,2] row_mask:0xf bank_mask:0xf
    v_fmac_f32 v210, v226, v174
    v_fmac_f32 v211, v227, v174
    buffer_load_dwordx4 a[220:223], v2, s[40:43], s50 offen offset:0
    v_fmac_f32 v212, v228, v174
    v_fmac_f32 v213, v229, v174
    v_fmac_f32 v214, v230, v174
    v_fmac_f32 v215, v231, v174
    buffer_load_dwordx4 a[224:227], v2, s[40:43], s50 offen offset:1024
    v_fmac_f32 v216, v232, v174
    v_fmac_f32 v217, v233, v174
    v_fmac_f32 v218, v234, v174
    v_fmac_f32 v219, v235, v174
    v_fmac_f32 v220, v236, v174
    buffer_load_dwordx4 a[228:231], v2, s[40:43], s50 offen offset:2048
    v_fmac_f32 v221, v237, v174
    v_fmac_f32 v222, v238, v174
    v_fmac_f32 v223, v239, v174
    v_fmac_f32 v208, v240, v175
    v_fmac_f32 v209, v241, v175
    buffer_load_dwordx4 a[232:235], v2, s[40:43], s50 offen offset:3072
    s_add_u32 s50, s84, 4096
    v_fmac_f32 v210, v242, v175
    v_fmac_f32 v211, v243, v175
    v_fmac_f32 v212, v244, v175
    v_fmac_f32 v213, v245, v175
    v_fmac_f32 v214, v246, v175
    buffer_load_dwordx4 a[236:239], v2, s[40:43], s50 offen offset:0
    v_fmac_f32 v215, v247, v175
    v_fmac_f32 v216, v248, v175
    v_fmac_f32 v217, v249, v175
    v_fmac_f32 v218, v250, v175
    s_waitcnt vmcnt(19)
    v_cmp_ne_u32 vcc, v6, v13
    s_cbranch_vccnz Lq0s_26
Lq0b_27:
    v_fmac_f32 v219, v251, v175
    v_fmac_f32 v220, v252, v175
    v_fmac_f32 v221, v253, v175
    v_fmac_f32 v222, v254, v175
    v_fmac_f32 v223, v255, v175
    s_add_u32 s19, s11, s93
    buffer_load_dwordx4 v[96:99], v2, s[24:27], s19 offen offset:0 sc1
    v_cvt_pk_bf16_f32 v208, v208, v209
    v_cvt_pk_bf16_f32 v209, v210, v211
    v_cvt_pk_bf16_f32 v210, v212, v213
    v_cvt_pk_bf16_f32 v211, v214, v215
    ds_write_b128 v171, v[208:211] offset:2560
    buffer_load_dwordx4 v[100:103], v4, s[24:27], s19 offen offset:0 sc1
    v_cvt_pk_bf16_f32 v212, v216, v217
    v_cvt_pk_bf16_f32 v213, v218, v219
    v_cvt_pk_bf16_f32 v214, v220, v221
    v_cvt_pk_bf16_f32 v215, v222, v223
    ds_write_b128 v171, v[212:215] offset:2576
    buffer_load_dwordx4 v[104:107], v2, s[24:27], s19 offen offset:1024 sc1
    ds_read_b64_tr_b16 v[216:217], v172 offset:2560
    ds_read_b64_tr_b16 v[218:219], v172 offset:3200
    ds_read_b64_tr_b16 v[220:221], v172 offset:2576
    ds_read_b64_tr_b16 v[222:223], v172 offset:3216
    buffer_load_dwordx4 v[108:111], v4, s[24:27], s19 offen offset:1024 sc1
    v_lshrrev_b32 v51, 5, v1
    v_mul_u32_u24 v51, 65408, v51
    v_lshl_add_u32 v14, v1, 2, v51
    v_add_u32 v14, s52, v14
    s_add_u32 s64, s55, 131072
    s_waitcnt vmcnt(17)
    v_xor_b32 v33, v33, v13
    v_xor_b32 v35, v35, v13
    v_xor_b32 v37, v37, v13
    v_xor_b32 v39, v39, v13
    v_or3_b32 v33, v33, v35, v37
    v_or_b32 v33, v33, v39
    v_cmp_ne_u32 vcc, 0, v33
    s_cbranch_vccnz Laggs_28
Laggb_29:
    s_add_u32 s73, s73, 0
    v_mul_f32_dpp v33, v32, v76 quad_perm:[1,0,3,2] row_mask:0xf bank_mask:0xf
    v_mul_f32_dpp v37, v32, v84 quad_perm:[1,0,3,2] row_mask:0xf bank_mask:0xf
    v_mul_f32 v35, v72, v32
    v_mul_f32 v39, v80, v32
    v_fmac_f32_dpp v33, v34, v77 quad_perm:[1,0,3,2] row_mask:0xf bank_mask:0xf
    v_fmac_f32_dpp v37, v34, v85 quad_perm:[1,0,3,2] row_mask:0xf bank_mask:0xf
    v_fmac_f32 v35, v73, v34
    v_fmac_f32 v39, v81, v34
    v_fmac_f32_dpp v33, v36, v78 quad_perm:[1,0,3,2] row_mask:0xf bank_mask:0xf
    buffer_load_dwordx2 v[40:41], v170, s[44:47], s57 offen offset:2048 sc1
    buffer_load_dwordx2 v[42:43], v170, s[44:47], s57 offen offset:2304 sc1
    buffer_load_dwordx2 v[44:45], v170, s[44:47], s57 offen offset:2560 sc1
    buffer_load_dwordx2 v[46:47], v170, s[44:47], s57 offen offset:2816 sc1
    v_fmac_f32_dpp v37, v36, v86 quad_perm:[1,0,3,2] row_mask:0xf bank_mask:0xf
    v_fmac_f32 v35, v74, v36
    v_fmac_f32 v39, v82, v36
    v_fmac_f32_dpp v33, v38, v79 quad_perm:[1,0,3,2] row_mask:0xf bank_mask:0xf
    v_fmac_f32_dpp v37, v38, v87 quad_perm:[1,0,3,2] row_mask:0xf bank_mask:0xf
    buffer_load_dwordx4 v[112:115], v2, s[24:27], s19 offen offset:2048 sc1
    v_fmac_f32 v35, v75, v38
    v_fmac_f32 v39, v83, v38
    v_add_f32 v33, v33, v35
    v_add_f32 v37, v37, v39
    v_mov_b32 v35, v33
    buffer_load_dwordx4 v[116:119], v4, s[24:27], s19 offen offset:2048 sc1
    v_mov_b32 v39, v37
    v_mul_f32_dpp v51, v53, v161 quad_perm:[1,0,3,2] row_mask:0xf bank_mask:0xf
    v_mul_f32_dpp v52, v53, v163 quad_perm:[1,0,3,2] row_mask:0xf bank_mask:0xf
    v_permlane32_swap_b32 v33, v35
    v_permlane32_swap_b32 v37, v39
    buffer_load_dwordx4 v[120:123], v2, s[24:27], s19 offen offset:3072 sc1
    v_fmac_f32 v51, v160, v53
    v_fmac_f32 v52, v162, v53
    v_add_f32 v37, v37, v39
    v_add_f32 v33, v33, v35
    buffer_load_dwordx4 v[124:127], v4, s[24:27], s19 offen offset:3072 sc1
    v_add_f32 v51, v51, v37
    v_add_f32 v53, v52, v33
    v_fma_f32 v174, v164, v51, v166
    v_mul_f32_dpp v52, v51, v165 quad_perm:[1,0,3,2] row_mask:0xf bank_mask:0xf
    v_add_f32 v174, v174, v52
    s_add_u32 s19, s19, 4096
    buffer_load_dwordx4 v[128:131], v2, s[24:27], s19 offen offset:0 sc1
    v_fmac_f32 v176, v224, v174
    v_fmac_f32 v177, v225, v174
    v_mov_b32_dpp v175, v174 quad_perm:[1,0,3,2] row_mask:0xf bank_mask:0xf
    v_fmac_f32 v178, v226, v174
    v_fmac_f32 v179, v227, v174
    buffer_load_dwordx4 v[132:135], v4, s[24:27], s19 offen offset:0 sc1
    v_fmac_f32 v180, v228, v174
    v_fmac_f32 v181, v229, v174
    v_fmac_f32 v182, v230, v174
    v_fmac_f32 v183, v231, v174
    v_fmac_f32 v184, v232, v174
    buffer_load_dwordx4 v[136:139], v2, s[24:27], s19 offen offset:1024 sc1
    v_fmac_f32 v185, v233, v174
    v_fmac_f32 v186, v234, v174
    v_fmac_f32 v187, v235, v174
    v_fmac_f32 v188, v236, v174
    buffer_load_dwordx4 v[140:143], v4, s[24:27], s19 offen offset:1024 sc1
    v_fmac_f32 v189, v237, v174
    v_fmac_f32 v190, v238, v174
    v_fmac_f32 v191, v239, v174
    v_fmac_f32 v176, v240, v175
    v_fmac_f32 v177, v241, v175
    buffer_load_dwordx4 v[144:147], v2, s[24:27], s19 offen offset:2048 sc1
    v_fmac_f32 v178, v242, v175
    v_fmac_f32 v179, v243, v175
    v_fmac_f32 v180, v244, v175
    v_fmac_f32 v181, v245, v175
    v_fmac_f32 v182, v246, v175
    buffer_load_dwordx4 v[148:151], v4, s[24:27], s19 offen offset:2048 sc1
    v_fmac_f32 v183, v247, v175
    v_fmac_f32 v184, v248, v175
    v_fmac_f32 v185, v249, v175
    v_fmac_f32 v186, v250, v175
    v_fmac_f32 v187, v251, v175
    buffer_load_dwordx4 v[152:155], v2, s[24:27], s19 offen offset:3072 sc1
    v_fmac_f32 v188, v252, v175
    v_fmac_f32 v189, v253, v175
    v_fmac_f32 v190, v254, v175
    v_fmac_f32 v191, v255, v175
    buffer_load_dwordx4 v[156:159], v4, s[24:27], s19 offen offset:3072 sc1
    v_cvt_pk_bf16_f32 v176, v176, v177
    v_cvt_pk_bf16_f32 v177, v178, v179
    v_cvt_pk_bf16_f32 v178, v180, v181
    v_cvt_pk_bf16_f32 v179, v182, v183
    ds_write_b128 v171, v[176:179] offset:0
    s_waitcnt lgkmcnt(1)
    v_cvt_pk_bf16_f32 v180, v184, v185
    v_cvt_pk_bf16_f32 v181, v186, v187
    v_cvt_pk_bf16_f32 v182, v188, v189
    v_cvt_pk_bf16_f32 v183, v190, v191
    ds_write_b128 v171, v[180:183] offset:16
    buffer_store_dwordx4 v[216:219], v173, s[24:27], s54 offen sc1
    s_add_u32 s54, s54, 96256
    ds_read_b64_tr_b16 v[184:185], v172 offset:0
    ds_read_b64_tr_b16 v[186:187], v172 offset:640
    ds_read_b64_tr_b16 v[188:189], v172 offset:16
    ds_read_b64_tr_b16 v[190:191], v172 offset:656
    buffer_store_dwordx4 v[220:223], v173, s[24:27], s54 offen sc1
    s_add_u32 s54, s54, 1443840
    s_waitcnt vmcnt(14)
    v_xor_b32 v41, v41, v13
    v_xor_b32 v43, v43, v13
    v_xor_b32 v45, v45, v13
    v_xor_b32 v47, v47, v13
    v_or3_b32 v41, v41, v43, v45
    v_or_b32 v41, v41, v47
    v_cmp_ne_u32 vcc, 0, v41
    s_cbranch_vccnz Laggs_30
Laggb_31:
    s_add_u32 s73, s73, 4096
    v_mul_f32_dpp v41, v40, v76 quad_perm:[1,0,3,2] row_mask:0xf bank_mask:0xf
    v_mul_f32_dpp v45, v40, v84 quad_perm:[1,0,3,2] row_mask:0xf bank_mask:0xf
    v_mul_f32 v43, v72, v40
    v_mul_f32 v47, v80, v40
    v_fmac_f32_dpp v41, v42, v77 quad_perm:[1,0,3,2] row_mask:0xf bank_mask:0xf
    v_fmac_f32_dpp v45, v42, v85 quad_perm:[1,0,3,2] row_mask:0xf bank_mask:0xf
    v_fmac_f32 v43, v73, v42
    v_fmac_f32 v47, v81, v42
    v_fmac_f32_dpp v41, v44, v78 quad_perm:[1,0,3,2] row_mask:0xf bank_mask:0xf
    v_fmac_f32_dpp v45, v44, v86 quad_perm:[1,0,3,2] row_mask:0xf bank_mask:0xf
    v_fmac_f32 v43, v74, v44
    v_fmac_f32 v47, v82, v44
    v_fmac_f32_dpp v41, v46, v79 quad_perm:[1,0,3,2] row_mask:0xf bank_mask:0xf
    v_fmac_f32_dpp v45, v46, v87 quad_perm:[1,0,3,2] row_mask:0xf bank_mask:0xf
    v_fmac_f32 v43, v75, v46
    v_fmac_f32 v47, v83, v46
    v_add_f32 v41, v41, v43
    v_add_f32 v45, v45, v47
    v_mov_b32 v43, v41
    v_mov_b32 v47, v45
    s_waitcnt lgkmcnt(0)
    v_mul_f32_dpp v51, v53, v161 quad_perm:[1,0,3,2] row_mask:0xf bank_mask:0xf
    v_mul_f32_dpp v52, v53, v163 quad_perm:[1,0,3,2] row_mask:0xf bank_mask:0xf
    v_permlane32_swap_b32 v41, v43
    v_permlane32_swap_b32 v45, v47
    v_fmac_f32 v51, v160, v53
    v_fmac_f32 v52, v162, v53
    v_add_f32 v45, v45, v47
    v_add_f32 v41, v41, v43
    v_add_f32 v51, v51, v45
    v_add_f32 v53, v52, v41
    v_fma_f32 v174, v164, v51, v167
    v_mul_f32_dpp v52, v51, v165 quad_perm:[1,0,3,2] row_mask:0xf bank_mask:0xf
    v_add_f32 v174, v174, v52
    v_fmac_f32 v192, v224, v174
    v_fmac_f32 v193, v225, v174
    v_mov_b32_dpp v175, v174 quad_perm:[1,0,3,2] row_mask:0xf bank_mask:0xf
    v_fmac_f32 v194, v226, v174
    v_fmac_f32 v195, v227, v174
    v_fmac_f32 v196, v228, v174
    v_fmac_f32 v197, v229, v174
    buffer_store_dwordx4 v[184:187], v173, s[24:27], s54 offen sc1
    s_add_u32 s54, s54, 96256
    v_fmac_f32 v198, v230, v174
    v_fmac_f32 v199, v231, v174
    v_fmac_f32 v200, v232, v174
    v_fmac_f32 v201, v233, v174
    v_fmac_f32 v202, v234, v174
    v_fmac_f32 v203, v235, v174
    v_fmac_f32 v204, v236, v174
    v_fmac_f32 v205, v237, v174
    v_fmac_f32 v206, v238, v174
    v_fmac_f32 v207, v239, v174
    v_fmac_f32 v192, v240, v175
    v_fmac_f32 v193, v241, v175
    v_fmac_f32 v194, v242, v175
    v_fmac_f32 v195, v243, v175
    v_fmac_f32 v196, v244, v175
    v_fmac_f32 v197, v245, v175
    v_fmac_f32 v198, v246, v175
    v_fmac_f32 v199, v247, v175
    v_fmac_f32 v200, v248, v175
    v_fmac_f32 v201, v249, v175
    buffer_store_dwordx4 v[188:191], v173, s[24:27], s54 offen sc1
    s_add_u32 s54, s54, 1443840
    v_fmac_f32 v202, v250, v175
    v_fmac_f32 v203, v251, v175
    v_fmac_f32 v204, v252, v175
    v_fmac_f32 v205, v253, v175
    v_fmac_f32 v206, v254, v175
    v_fmac_f32 v207, v255, v175
    v_cvt_pk_bf16_f32 v192, v192, v193
    v_cvt_pk_bf16_f32 v193, v194, v195
    v_cvt_pk_bf16_f32 v194, v196, v197
    v_cvt_pk_bf16_f32 v195, v198, v199
    ds_write_b128 v171, v[192:195] offset:2560
    v_cvt_pk_bf16_f32 v196, v200, v201
    v_cvt_pk_bf16_f32 v197, v202, v203
    v_cvt_pk_bf16_f32 v198, v204, v205
    v_cvt_pk_bf16_f32 v199, v206, v207
    ds_write_b128 v171, v[196:199] offset:2576
    ds_read_b64_tr_b16 v[200:201], v172 offset:2560
    ds_read_b64_tr_b16 v[202:203], v172 offset:3200
    ds_read_b64_tr_b16 v[204:205], v172 offset:2576
    ds_read_b64_tr_b16 v[206:207], v172 offset:3216
    s_waitcnt lgkmcnt(0)
    buffer_store_dwordx4 v[200:203], v173, s[24:27], s54 offen sc1
    s_add_u32 s54, s54, 96256
    buffer_store_dwordx4 v[204:207], v173, s[24:27], s54 offen sc1
    s_add_u32 s54, s54, 1443840
    s_branch L_p2
L_spare:
    s_waitcnt lgkmcnt(0)
    s_mov_b64 s[32:33], s[88:89]
    s_mov_b32 s34, 2211840
    s_mov_b32 s35, 0x20000
    s_mov_b64 s[36:37], s[74:75]
    s_mov_b32 s38, 819200
    s_mov_b32 s39, 0x20000
    s_mov_b32 m0, s86
    s_nop 0
    buffer_load_dwordx4 v40, s[32:35], s85 offen lds
    s_add_u32 m0, s86, 1024
    s_nop 0
    buffer_load_dwordx4 v41, s[32:35], s85 offen lds
    s_add_u32 m0, s86, 2048
    s_nop 0
    buffer_load_dwordx4 v42, s[32:35], s85 offen lds
    s_add_u32 m0, s86, 3072
    s_nop 0
    buffer_load_dwordx4 v43, s[36:39], s87 offen lds
    s_add_u32 m0, s86, 4096
    s_add_u32 s87, s87, 10240
    buffer_load_dwordx4 v43, s[36:39], s87 offen lds
    s_nop 0
    s_waitcnt vmcnt(0)
    ds_read_b64_tr_b16 a[200:201], v4 offset:0
    ds_read_b64_tr_b16 a[202:203], v4 offset:384
    ds_read_b64_tr_b16 a[204:205], v4 offset:32
    ds_read_b64_tr_b16 a[206:207], v4 offset:416
    ds_read_b64_tr_b16 a[208:209], v4 offset:64
    ds_read_b64_tr_b16 a[210:211], v4 offset:448
    ds_read_b128 a[212:215], v5 offset:3072
    ds_read_b128 a[216:219], v5 offset:3136
    s_waitcnt lgkmcnt(0)
    buffer_store_dwordx4 a[200:203], v2, s[40:43], s57 offen offset:0 sc1
    buffer_store_dwordx4 a[204:207], v2, s[40:43], s57 offen offset:1024 sc1
    s_bitcmp1_b32 s15, 0
    s_cselect_b32 s57, 2146435072, s57
    buffer_store_dwordx4 a[208:211], v2, s[40:43], s57 offen offset:2048 sc1
    buffer_store_dwordx4 a[212:215], v2, s[40:43], s58 offen sc1
    s_add_u32 s58, s58, 5120
    buffer_store_dwordx4 a[216:219], v2, s[40:43], s58 offen sc1
    s_waitcnt vmcnt(0)
    buffer_store_dword v13, v3, s[28:31], s51 offen sc1
    s_add_u32 s32, s94, 18792448
    s_addc_u32 s33, s95, 0
    s_mov_b32 s34, 655360
    s_mov_b32 s35, 0x20000
    s_lshl_b32 s16, s7, 2
    s_add_u32 s16, s16, s15
    s_mul_i32 s16, s16, 24576
    v_mul_u32_u24 v16, 384, v1
    buffer_load_dword v255, v16, s[32:35], s16 offen offset:0
    buffer_load_dword v255, v16, s[32:35], s16 offen offset:128
    buffer_load_dword v255, v16, s[32:35], s16 offen offset:256
    s_cmp_lg_u32 s7, 13
    s_cbranch_scc1 Lnog_32
    s_lshl_b32 s16, s15, 15
    s_add_u32 s16, s16, 811140
    v_lshl_add_u32 v20, v1, 7, s16
    v_add_u32 v21, 8192, v20
    v_add_u32 v22, 16384, v20
    v_add_u32 v23, 24576, v20
    s_mov_b32 s13, 0
Lgen_34:
    s_sleep 40
    buffer_load_dword v16, v20, s[28:31], 0 offen sc1
    buffer_load_dword v17, v21, s[28:31], 0 offen sc1
    buffer_load_dword v18, v22, s[28:31], 0 offen sc1
    buffer_load_dword v19, v23, s[28:31], 0 offen sc1
    s_add_u32 s13, s13, 1
    s_waitcnt vmcnt(0)
    v_xor_b32 v16, v16, v13
    v_xor_b32 v17, v17, v13
    v_xor_b32 v18, v18, v13
    v_xor_b32 v19, v19, v13
    v_or3_b32 v16, v16, v17, v18
    v_or_b32 v16, v16, v19
    v_cmp_ne_u32 vcc, 0, v16
    s_cmp_ge_u32 s13, 131072
    s_cbranch_scc1 Lgeno_35
    s_cbranch_vccnz Lgen_34
Lgeno_35:
    s_barrier
    s_mov_b32 s16, 0
    s_cmp_eq_u32 s15, 0
    s_cselect_b32 s16, s16, 2146435072
    v_lshlrev_b32 v5, 25, v1
    v_and_b32 v5, 0x40000000, v5
    v_lshl_add_u32 v5, v1, 2, v5
    v_add_u32 v5, s16, v5
    buffer_store_dword v13, v5, s[28:31], 0 offen sc1
    s_branch Lgdone_33
Lnog_32:
Lgdone_33:
    s_mov_b32 s13, 0
Lf6p_36:
    buffer_load_dword v6, v7, s[28:31], s51 offen sc1
    s_add_u32 s13, s13, 1
    s_waitcnt vmcnt(0)
    v_cmp_ne_u32 vcc, v6, v13
    s_sleep 32
    s_cmp_ge_u32 s13, 131072
    s_cbranch_scc1 Lf6po_37
    s_cbranch_vccnz Lf6p_36
Lf6po_37:
    s_add_u32 s50, s48, 0
    buffer_load_dwordx4 a[0:3], v2, s[40:43], s50 offen offset:0
    buffer_load_dwordx4 a[4:7], v2, s[40:43], s50 offen offset:1024
    buffer_load_dwordx4 a[8:11], v2, s[40:43], s50 offen offset:2048
    buffer_load_dwordx4 a[12:15], v2, s[40:43], s50 offen offset:3072
    s_add_u32 s50, s48, 4096
    buffer_load_dwordx4 a[16:19], v2, s[40:43], s50 offen offset:0
    buffer_load_dwordx4 a[20:23], v2, s[40:43], s50 offen offset:1024
    buffer_load_dwordx4 a[24:27], v2, s[40:43], s50 offen offset:2048
    buffer_load_dwordx4 a[28:31], v2, s[40:43], s50 offen offset:3072
    s_add_u32 s50, s48, 8192
    buffer_load_dwordx4 a[32:35], v2, s[40:43], s50 offen offset:0
    buffer_load_dwordx4 a[36:39], v2, s[40:43], s50 offen offset:1024
    buffer_load_dwordx4 a[40:43], v2, s[40:43], s50 offen offset:2048
    buffer_load_dwordx4 a[44:47], v2, s[40:43], s50 offen offset:3072
    s_add_u32 s50, s48, 12288
    buffer_load_dwordx4 a[48:51], v2, s[40:43], s50 offen offset:0
    buffer_load_dwordx4 a[52:55], v2, s[40:43], s50 offen offset:1024
    buffer_load_dwordx4 a[56:59], v2, s[40:43], s50 offen offset:2048
    buffer_load_dwordx4 a[60:63], v2, s[40:43], s50 offen offset:3072
    s_add_u32 s50, s48, 16384
    buffer_load_dwordx4 a[64:67], v2, s[40:43], s50 offen offset:0
    buffer_load_dwordx4 a[68:71], v2, s[40:43], s50 offen offset:1024
    buffer_load_dwordx4 a[72:75], v2, s[40:43], s50 offen offset:2048
    buffer_load_dwordx4 a[76:79], v2, s[40:43], s50 offen offset:3072
    s_add_u32 s50, s48, 20480
    buffer_load_dwordx4 a[80:83], v2, s[40:43], s50 offen offset:0
    buffer_load_dwordx4 a[84:87], v2, s[40:43], s50 offen offset:1024
    buffer_load_dwordx4 a[88:91], v2, s[40:43], s50 offen offset:2048
    buffer_load_dwordx4 a[92:95], v2, s[40:43], s50 offen offset:3072
    s_add_u32 s50, s48, 24576
    buffer_load_dwordx4 a[96:99], v2, s[40:43], s50 offen offset:0
    buffer_load_dwordx4 a[100:103], v2, s[40:43], s50 offen offset:1024
    buffer_load_dwordx4 a[104:107], v2, s[40:43], s50 offen offset:2048
    buffer_load_dwordx4 a[108:111], v2, s[40:43], s50 offen offset:3072
    s_add_u32 s50, s48, 28672
    buffer_load_dwordx4 a[112:115], v2, s[40:43], s50 offen offset:0
    buffer_load_dwordx4 a[116:119], v2, s[40:43], s50 offen offset:1024
    buffer_load_dwordx4 a[120:123], v2, s[40:43], s50 offen offset:2048
    buffer_load_dwordx4 a[124:127], v2, s[40:43], s50 offen offset:3072
    s_add_u32 s50, s48, 32768
    buffer_load_dwordx4 a[128:131], v2, s[40:43], s50 offen offset:0
    buffer_load_dwordx4 a[132:135], v2, s[40:43], s50 offen offset:1024
    buffer_load_dwordx4 a[136:139], v2, s[40:43], s50 offen offset:2048
    buffer_load_dwordx4 a[140:143], v2, s[40:43], s50 offen offset:3072
    s_add_u32 s50, s48, 36864
    buffer_load_dwordx4 a[144:147], v2, s[40:43], s50 offen offset:0
    buffer_load_dwordx4 a[148:151], v2, s[40:43], s50 offen offset:1024
    buffer_load_dwordx4 a[152:155], v2, s[40:43], s50 offen offset:2048
    buffer_load_dwordx4 a[156:159], v2, s[40:43], s50 offen offset:3072
    s_add_u32 s50, s48, 40960
    buffer_load_dwordx4 a[160:163], v2, s[40:43], s50 offen offset:0
    buffer_load_dwordx4 a[164:167], v2, s[40:43], s50 offen offset:1024
    buffer_load_dwordx4 a[168:171], v2, s[40:43], s50 offen offset:2048
    buffer_load_dwordx4 a[172:175], v2, s[40:43], s50 offen offset:3072
    s_add_u32 s50, s48, 45056
    buffer_load_dwordx4 a[176:179], v2, s[40:43], s50 offen offset:0
    buffer_load_dwordx4 a[180:183], v2, s[40:43], s50 offen offset:1024
    buffer_load_dwordx4 a[184:187], v2, s[40:43], s50 offen offset:2048
    buffer_load_dwordx4 a[188:191], v2, s[40:43], s50 offen offset:3072
    s_add_u32 s50, s48, 49152
    buffer_load_dwordx4 a[192:195], v2, s[40:43], s50 offen offset:0
    buffer_load_dwordx4 a[196:199], v2, s[40:43], s50 offen offset:1024
    s_add_u32 s50, s49, 0
    buffer_load_dwordx4 a[200:203], v2, s[40:43], s50 offen offset:0
    buffer_load_dwordx4 a[204:207], v2, s[40:43], s50 offen offset:1024
    buffer_load_dwordx4 a[208:211], v2, s[40:43], s50 offen offset:2048
    buffer_load_dwordx4 a[212:215], v2, s[40:43], s50 offen offset:3072
    s_add_u32 s50, s49, 4096
    buffer_load_dwordx4 a[216:219], v2, s[40:43], s50 offen offset:0
    s_add_u32 s50, s84, 0
    buffer_load_dwordx4 a[220:223], v2, s[40:43], s50 offen offset:0
    buffer_load_dwordx4 a[224:227], v2, s[40:43], s50 offen offset:1024
    buffer_load_dwordx4 a[228:231], v2, s[40:43], s50 offen offset:2048
    buffer_load_dwordx4 a[232:235], v2, s[40:43], s50 offen offset:3072
    s_add_u32 s50, s84, 4096
    buffer_load_dwordx4 a[236:239], v2, s[40:43], s50 offen offset:0
    v_mov_b32 v14, 2146435072
    s_mov_b32 s55, 0
    s_mov_b32 s64, 0
    s_mul_i32 s16, s15, 6
    s_add_u32 s17, s15, 23
    s_cmp_eq_u32 s8, 0
    s_cselect_b32 s16, s16, s17
    s_cselect_b32 s17, 5, 1
    s_cselect_b32 s18, 64, 2
    v_and_b32 v6, 7, v1
    v_min_u32 v7, s17, v6
    v_add_u32 v7, s16, v7
    v_min_u32 v7, 26, v7
    s_and_b32 s16, s15, 1
    s_mul_i32 s16, s16, 5
    s_add_u32 s16, s16, 25
    v_cmp_gt_u32 vcc, s18, v6
    v_min_u32 v6, 6, v6
    v_add_u32 v6, s16, v6
    v_cndmask_b32 v7, v6, v7, vcc
    v_and_b32 v6, 8, v1
    v_lshl_add_u32 v7, v6, 3, v7
    v_lshlrev_b32 v7, 7, v7
    s_xor_b32 s16, s92, 0
    s_mul_i32 s11, s16, 192512
    s_lshl_b32 s87, s9, 14
    s_add_u32 s87, s87, 8320
    v_add_u32 v4, 96256, v2
    buffer_load_dword v6, v7, s[28:31], s87 offen sc1
    s_mov_b32 s13, 0
Lq0s_38:
    buffer_load_dword v6, v7, s[28:31], s87 offen sc1
    s_add_u32 s13, s13, 1
    s_waitcnt vmcnt(0)
    v_cmp_ne_u32 vcc, v6, v13
    s_sleep 16
    s_cmp_ge_u32 s13, 131072
    s_cbranch_scc1 Lq0so_39
    s_cbranch_vccnz Lq0s_38
Lq0so_39:
    s_add_u32 s19, s11, s93
    buffer_load_dwordx4 v[96:99], v2, s[24:27], s19 offen offset:0 sc1
    buffer_load_dwordx4 v[100:103], v4, s[24:27], s19 offen offset:0 sc1
    buffer_load_dwordx4 v[104:107], v2, s[24:27], s19 offen offset:1024 sc1
    buffer_load_dwordx4 v[108:111], v4, s[24:27], s19 offen offset:1024 sc1
    buffer_load_dwordx4 v[112:115], v2, s[24:27], s19 offen offset:2048 sc1
    buffer_load_dwordx4 v[116:119], v4, s[24:27], s19 offen offset:2048 sc1
    buffer_load_dwordx4 v[120:123], v2, s[24:27], s19 offen offset:3072 sc1
    buffer_load_dwordx4 v[124:127], v4, s[24:27], s19 offen offset:3072 sc1
    s_add_u32 s19, s19, 4096
    buffer_load_dwordx4 v[128:131], v2, s[24:27], s19 offen offset:0 sc1
    buffer_load_dwordx4 v[132:135], v4, s[24:27], s19 offen offset:0 sc1
    buffer_load_dwordx4 v[136:139], v2, s[24:27], s19 offen offset:1024 sc1
    buffer_load_dwordx4 v[140:143], v4, s[24:27], s19 offen offset:1024 sc1
    buffer_load_dwordx4 v[144:147], v2, s[24:27], s19 offen offset:2048 sc1
    buffer_load_dwordx4 v[148:151], v4, s[24:27], s19 offen offset:2048 sc1
    buffer_load_dwordx4 v[152:155], v2, s[24:27], s19 offen offset:3072 sc1
    buffer_load_dwordx4 v[156:159], v4, s[24:27], s19 offen offset:3072 sc1
    s_mov_b32 s16, 2146435072
    buffer_store_dword v13, v2, s[28:31], s16 offen
    s_mov_b32 s16, 2146435072
    buffer_store_dword v13, v2, s[28:31], s16 offen
L_p2:
L_hk7079:
    s_cbranch_execz L_hback
    s_waitcnt vmcnt(14)
    v_mfma_f32_16x16x32_bf16 v[176:179], a[0:3], v[96:99], 0
    s_and_b32 s48, s15, 1
    v_mfma_f32_16x16x32_bf16 v[180:183], a[4:7], v[96:99], 0
    s_lshl_b32 s48, s48, 3
    s_lshr_b32 s49, s15, 1
    v_mfma_f32_16x16x32_bf16 v[184:187], a[8:11], v[96:99], 0
    s_mul_i32 s49, s49, 5120
    v_mfma_f32_16x16x32_bf16 v[188:191], a[12:15], v[96:99], 0
    s_lshl_b32 s50, s15, 2
    s_mov_b64 s[32:33], s[80:81]
    v_mfma_f32_16x16x32_bf16 v[192:195], a[16:19], v[96:99], 0
    s_mov_b32 s34, 1280
    v_mfma_f32_16x16x32_bf16 v[196:199], a[0:3], v[100:103], 0
    s_mov_b32 s35, 0x20000
    v_mfma_f32_16x16x32_bf16 v[200:203], a[4:7], v[100:103], 0
    s_mul_i32 s60, s10, 160
    v_add_u32 v92, 0, v1
    v_mfma_f32_16x16x32_bf16 v[204:207], a[8:11], v[100:103], 0
    v_mul_u32_u24 v93, 205, v92
    v_mfma_f32_16x16x32_bf16 v[208:211], a[12:15], v[100:103], 0
    v_lshrrev_b32 v93, 12, v93
    v_mul_u32_u24 v94, 20, v93
    v_mfma_f32_16x16x32_bf16 v[212:215], a[16:19], v[100:103], 0
    v_sub_u32 v92, v92, v94
    v_mfma_f32_16x16x32_bf16 v[176:179], a[20:23], v[104:107], v[176:179]
    v_add3_u32 v94, v92, v93, s48
    v_mfma_f32_16x16x32_bf16 v[180:183], a[24:27], v[104:107], v[180:183]
    v_and_b32 v94, 15, v94
    v_lshlrev_b32 v94, 4, v94
    v_mfma_f32_16x16x32_bf16 v[184:187], a[28:31], v[104:107], v[184:187]
    v_lshl_add_u32 v94, v92, 8, v94
    v_mfma_f32_16x16x32_bf16 v[188:191], a[32:35], v[104:107], v[188:191]
    v_add_u32 v246, s49, v94
    v_and_b32 v94, 4, v93
    v_mfma_f32_16x16x32_bf16 v[192:195], a[36:39], v[104:107], v[192:195]
    v_lshlrev_b32 v94, 2, v94
    v_mfma_f32_16x16x32_bf16 v[196:199], a[20:23], v[108:111], v[196:199]
    v_and_b32 v93, 3, v93
    v_mfma_f32_16x16x32_bf16 v[200:203], a[24:27], v[108:111], v[200:203]
    v_add3_u32 v93, v93, v94, s50
    v_mfma_f32_16x16x32_bf16 v[204:207], a[28:31], v[108:111], v[204:207]
    v_lshlrev_b32 v252, 6, v93
    v_lshlrev_b32 v240, 3, v92
    v_mfma_f32_16x16x32_bf16 v[208:211], a[32:35], v[108:111], v[208:211]
    v_mul_u32_u24 v93, 1280, v93
    v_add_u32 v249, v93, v240
    v_mfma_f32_16x16x32_bf16 v[212:215], a[36:39], v[108:111], v[212:215]
    v_add_u32 v92, 64, v1
    s_waitcnt vmcnt(10)
    v_mfma_f32_16x16x32_bf16 v[176:179], a[40:43], v[112:115], v[176:179]
    v_mul_u32_u24 v93, 205, v92
    v_mfma_f32_16x16x32_bf16 v[180:183], a[44:47], v[112:115], v[180:183]
    v_lshrrev_b32 v93, 12, v93
    v_mul_u32_u24 v94, 20, v93
    v_mfma_f32_16x16x32_bf16 v[184:187], a[48:51], v[112:115], v[184:187]
    s_add_u32 s19, s19, 4096
    buffer_load_dwordx4 v[160:163], v2, s[24:27], s19 offen offset:0 sc1
    v_mfma_f32_16x16x32_bf16 v[188:191], a[52:55], v[112:115], v[188:191]
    v_sub_u32 v92, v92, v94
    v_mfma_f32_16x16x32_bf16 v[192:195], a[56:59], v[112:115], v[192:195]
    v_add3_u32 v94, v92, v93, s48
    v_mfma_f32_16x16x32_bf16 v[196:199], a[40:43], v[116:119], v[196:199]
    v_and_b32 v94, 15, v94
    v_lshlrev_b32 v94, 4, v94
    v_mfma_f32_16x16x32_bf16 v[200:203], a[44:47], v[116:119], v[200:203]
    v_lshl_add_u32 v94, v92, 8, v94
    v_mfma_f32_16x16x32_bf16 v[204:207], a[48:51], v[116:119], v[204:207]
    buffer_load_dwordx4 v[164:167], v4, s[24:27], s19 offen offset:0 sc1
    v_mfma_f32_16x16x32_bf16 v[208:211], a[52:55], v[116:119], v[208:211]
    v_add_u32 v247, s49, v94
    v_and_b32 v94, 4, v93
    v_mfma_f32_16x16x32_bf16 v[212:215], a[56:59], v[116:119], v[212:215]
    v_lshlrev_b32 v94, 2, v94
    v_and_b32 v93, 3, v93
    v_mfma_f32_16x16x32_bf16 v[176:179], a[60:63], v[120:123], v[176:179]
    v_add3_u32 v93, v93, v94, s50
    v_mfma_f32_16x16x32_bf16 v[180:183], a[64:67], v[120:123], v[180:183]
    v_lshlrev_b32 v253, 6, v93
    v_lshlrev_b32 v241, 3, v92
    v_mfma_f32_16x16x32_bf16 v[184:187], a[68:71], v[120:123], v[184:187]
    buffer_load_dwordx4 v[168:171], v2, s[24:27], s19 offen offset:1024 sc1
    v_mfma_f32_16x16x32_bf16 v[188:191], a[72:75], v[120:123], v[188:191]
    v_mul_u32_u24 v93, 1280, v93
    v_add_u32 v250, v93, v241
    v_mfma_f32_16x16x32_bf16 v[192:195], a[76:79], v[120:123], v[192:195]
    v_add_u32 v92, 128, v1
    v_mfma_f32_16x16x32_bf16 v[196:199], a[60:63], v[124:127], v[196:199]
    v_min_u32 v92, 159, v92
    v_mfma_f32_16x16x32_bf16 v[200:203], a[64:67], v[124:127], v[200:203]
    v_mul_u32_u24 v93, 205, v92
    v_lshrrev_b32 v93, 12, v93
    v_mfma_f32_16x16x32_bf16 v[204:207], a[68:71], v[124:127], v[204:207]
    buffer_load_dwordx4 v[172:175], v4, s[24:27], s19 offen offset:1024 sc1
    v_mfma_f32_16x16x32_bf16 v[208:211], a[72:75], v[124:127], v[208:211]
    v_mul_u32_u24 v94, 20, v93
    v_sub_u32 v92, v92, v94
    v_mfma_f32_16x16x32_bf16 v[212:215], a[76:79], v[124:127], v[212:215]
    v_add3_u32 v94, v92, v93, s48
    s_waitcnt vmcnt(10)
    v_mfma_f32_16x16x32_bf16 v[176:179], a[80:83], v[128:131], v[176:179]
    v_and_b32 v94, 15, v94
    v_lshlrev_b32 v94, 4, v94
    v_mfma_f32_16x16x32_bf16 v[180:183], a[84:87], v[128:131], v[180:183]
    v_lshl_add_u32 v94, v92, 8, v94
    v_mfma_f32_16x16x32_bf16 v[184:187], a[88:91], v[128:131], v[184:187]
    s_add_u32 s19, s11, s100
    buffer_load_dwordx4 a[240:243], v2, s[24:27], s19 offen offset:0 sc1
    v_mfma_f32_16x16x32_bf16 v[188:191], a[92:95], v[128:131], v[188:191]
    v_add_u32 v248, s49, v94
    v_and_b32 v94, 4, v93
    v_mfma_f32_16x16x32_bf16 v[192:195], a[96:99], v[128:131], v[192:195]
    v_lshlrev_b32 v94, 2, v94
    v_and_b32 v93, 3, v93
    v_mfma_f32_16x16x32_bf16 v[196:199], a[80:83], v[132:135], v[196:199]
    v_add3_u32 v93, v93, v94, s50
    v_lshlrev_b32 v254, 6, v93
    v_mfma_f32_16x16x32_bf16 v[200:203], a[84:87], v[132:135], v[200:203]
    v_lshlrev_b32 v242, 3, v92
    v_mul_u32_u24 v93, 1280, v93
    v_mfma_f32_16x16x32_bf16 v[204:207], a[88:91], v[132:135], v[204:207]
    buffer_load_dwordx4 a[244:247], v4, s[24:27], s19 offen offset:0 sc1
    v_mfma_f32_16x16x32_bf16 v[208:211], a[92:95], v[132:135], v[208:211]
    v_add_u32 v251, v93, v242
    v_mov_b32 v92, 1073217536
    v_mfma_f32_16x16x32_bf16 v[212:215], a[96:99], v[132:135], v[212:215]
    v_cndmask_b32 v251, v251, v92, s[82:83]
    v_mfma_f32_16x16x32_bf16 v[176:179], a[100:103], v[136:139], v[176:179]
    v_cndmask_b32 v3, v2, v92, s[82:83]
    v_mfma_f32_16x16x32_bf16 v[180:183], a[104:107], v[136:139], v[180:183]
    v_and_b32 v12, 0x1ff, v2
    v_lshrrev_b32 v92, 4, v1
    v_mfma_f32_16x16x32_bf16 v[184:187], a[108:111], v[136:139], v[184:187]
    s_add_u32 s19, s11, s101
    buffer_load_dwordx4 a[248:251], v2, s[24:27], s19 offen offset:0 sc1
    v_mfma_f32_16x16x32_bf16 v[188:191], a[112:115], v[136:139], v[188:191]
    v_add_u32 v93, v92, v1
    v_lshlrev_b32 v92, 8, v92
    v_mfma_f32_16x16x32_bf16 v[192:195], a[116:119], v[136:139], v[192:195]
    v_add_u32 v92, s56, v92
    v_add_u32 v94, 0, v93
    v_mfma_f32_16x16x32_bf16 v[196:199], a[100:103], v[140:143], v[196:199]
    v_and_b32 v94, 15, v94
    v_lshl_add_u32 v8, v94, 4, v92
    v_mfma_f32_16x16x32_bf16 v[200:203], a[104:107], v[140:143], v[200:203]
    v_add_u32 v94, 4, v93
    v_and_b32 v94, 15, v94
    v_mfma_f32_16x16x32_bf16 v[204:207], a[108:111], v[140:143], v[204:207]
    buffer_load_dwordx4 a[252:255], v4, s[24:27], s19 offen offset:0 sc1
    v_mfma_f32_16x16x32_bf16 v[208:211], a[112:115], v[140:143], v[208:211]
    v_lshl_add_u32 v9, v94, 4, v92
    v_add_u32 v94, 8, v93
    v_mfma_f32_16x16x32_bf16 v[212:215], a[116:119], v[140:143], v[212:215]
    s_waitcnt vmcnt(8)
    s_barrier
    buffer_store_dword v13, v14, s[28:31], s55 offen sc1
    buffer_store_dword v13, v14, s[28:31], s64 offen sc1
    v_mfma_f32_16x16x32_bf16 v[176:179], a[120:123], v[144:147], v[176:179]
    v_and_b32 v94, 15, v94
    v_mfma_f32_16x16x32_bf16 v[180:183], a[124:127], v[144:147], v[180:183]
    s_xor_b32 s16, s92, 1
    s_mul_i32 s11, s16, 192512
    s_add_u32 s19, s11, s93
    buffer_load_dwordx4 v[96:99], v2, s[24:27], s19 offen offset:0 sc1
    v_mfma_f32_16x16x32_bf16 v[184:187], a[128:131], v[144:147], v[184:187]
    v_lshl_add_u32 v10, v94, 4, v92
    v_mfma_f32_16x16x32_bf16 v[188:191], a[132:135], v[144:147], v[188:191]
    v_add_u32 v94, 12, v93
    v_and_b32 v94, 15, v94
    v_mfma_f32_16x16x32_bf16 v[192:195], a[136:139], v[144:147], v[192:195]
    buffer_load_dwordx4 v[100:103], v4, s[24:27], s19 offen offset:0 sc1
    v_mfma_f32_16x16x32_bf16 v[196:199], a[120:123], v[148:151], v[196:199]
    v_lshl_add_u32 v11, v94, 4, v92
    v_mfma_f32_16x16x32_bf16 v[200:203], a[124:127], v[148:151], v[200:203]
    v_mov_b32 v5, 0xff
    v_mfma_f32_16x16x32_bf16 v[204:207], a[128:131], v[148:151], v[204:207]
    s_bfe_u32 s66, s14, 0x80000
    buffer_load_dwordx2 v[234:235], v240, s[32:35], s60 offen
    v_mfma_f32_16x16x32_bf16 v[208:211], a[132:135], v[148:151], v[208:211]
    s_bfe_u32 s67, s14, 0x80008
    s_bfe_u32 s68, s14, 0x80010
    s_bfe_u32 s69, s14, 0x80018
    v_mfma_f32_16x16x32_bf16 v[212:215], a[136:139], v[148:151], v[212:215]
    s_add_u32 s44, s94, 19447808
    s_addc_u32 s45, s95, 0
    s_mov_b32 s46, 5242880
    v_mfma_f32_16x16x32_bf16 v[176:179], a[140:143], v[152:155], v[176:179]
    s_mov_b32 s47, 0x20000
    buffer_load_dwordx4 v[104:107], v2, s[24:27], s19 offen offset:1024 sc1
    v_mfma_f32_16x16x32_bf16 v[180:183], a[144:147], v[152:155], v[180:183]
    s_mov_b64 s[36:37], s[90:91]
    s_mov_b32 s38, 5242880
    v_mfma_f32_16x16x32_bf16 v[184:187], a[148:151], v[152:155], v[184:187]
    s_mov_b32 s39, 0x20000
    buffer_load_dwordx2 v[236:237], v241, s[32:35], s60 offen
    v_mfma_f32_16x16x32_bf16 v[188:191], a[152:155], v[152:155], v[188:191]
    s_lshl_b32 s49, s9, 3
    v_mfma_f32_16x16x32_bf16 v[192:195], a[156:159], v[152:155], v[192:195]
    s_add_u32 s49, s49, s10
    s_lshl_b32 s49, s49, 1
    v_mfma_f32_16x16x32_bf16 v[196:199], a[140:143], v[156:159], v[196:199]
    s_add_u32 s49, s49, s8
    buffer_load_dwordx4 v[108:111], v4, s[24:27], s19 offen offset:1024 sc1
    v_mfma_f32_16x16x32_bf16 v[200:203], a[144:147], v[156:159], v[200:203]
    s_xor_b32 s50, s49, 1
    v_mfma_f32_16x16x32_bf16 v[204:207], a[148:151], v[156:159], v[204:207]
    s_mul_i32 s49, s49, 10240
    s_mul_i32 s50, s50, 10240
    v_mfma_f32_16x16x32_bf16 v[208:211], a[152:155], v[156:159], v[208:211]
    s_mul_i32 s48, s15, 2560
    buffer_load_dwordx2 v[238:239], v242, s[32:35], s60 offen
    v_mfma_f32_16x16x32_bf16 v[212:215], a[156:159], v[156:159], v[212:215]
    s_add_u32 s76, s49, s48
    s_waitcnt vmcnt(9)
    v_mfma_f32_16x16x32_bf16 v[176:179], a[160:163], v[160:163], v[176:179]
    v_mfma_f32_16x16x32_bf16 v[180:183], a[164:167], v[160:163], v[180:183]
    v_mfma_f32_16x16x32_bf16 v[184:187], a[168:171], v[160:163], v[184:187]
    s_add_u32 s77, s50, s48
    buffer_load_dwordx4 v[112:115], v2, s[24:27], s19 offen offset:2048 sc1
    v_mfma_f32_16x16x32_bf16 v[188:191], a[172:175], v[160:163], v[188:191]
    v_mfma_f32_16x16x32_bf16 v[192:195], a[176:179], v[160:163], v[192:195]
    v_mfma_f32_16x16x32_bf16 v[176:179], a[180:183], v[168:171], v[176:179]
    v_mfma_f32_16x16x32_bf16 v[180:183], a[184:187], v[168:171], v[180:183]
    v_mfma_f32_16x16x32_bf16 v[184:187], a[188:191], v[168:171], v[184:187]
    s_mov_b32 s12, 0xffff0000
    buffer_load_dwordx4 v[116:119], v4, s[24:27], s19 offen offset:2048 sc1
    v_mfma_f32_16x16x32_bf16 v[188:191], a[192:195], v[168:171], v[188:191]
    v_mfma_f32_16x16x32_bf16 v[192:195], a[196:199], v[168:171], v[192:195]
    v_mfma_f32_16x16x32_bf16 v[176:179], a[200:203], a[240:243], v[176:179]
    s_xor_b32 s16, s92, 1
    s_mul_i32 s78, s16, 40960
    s_add_u32 s78, s78, s60
    s_lshl_b32 s81, s16, 11
    s_add_u32 s81, s81, 811136
    v_mfma_f32_16x16x32_bf16 v[180:183], a[204:207], a[240:243], v[180:183]
    v_mfma_f32_16x16x32_bf16 v[184:187], a[208:211], a[240:243], v[184:187]
    buffer_load_dwordx4 v[120:123], v2, s[24:27], s19 offen offset:3072 sc1
    v_mfma_f32_16x16x32_bf16 v[188:191], a[212:215], a[240:243], v[188:191]
    v_mfma_f32_16x16x32_bf16 v[192:195], a[216:219], a[240:243], v[192:195]
    buffer_load_dwordx2 v[228:229], v249, s[20:23], s78 offen
    v_mfma_f32_16x16x32_bf16 v[176:179], a[220:223], a[248:251], v[176:179]
    v_mfma_f32_16x16x32_bf16 v[180:183], a[224:227], a[248:251], v[180:183]
    v_mfma_f32_16x16x32_bf16 v[184:187], a[228:231], a[248:251], v[184:187]
    buffer_load_dwordx4 v[124:127], v4, s[24:27], s19 offen offset:3072 sc1
    v_mfma_f32_16x16x32_bf16 v[188:191], a[232:235], a[248:251], v[188:191]
    buffer_load_dwordx2 v[240:241], v252, s[28:31], s81 offen sc1
    v_mfma_f32_16x16x32_bf16 v[192:195], a[236:239], a[248:251], v[192:195]
    v_mfma_f32_16x16x32_bf16 v[196:199], a[160:163], v[164:167], v[196:199]
    v_mfma_f32_16x16x32_bf16 v[200:203], a[164:167], v[164:167], v[200:203]
    v_mfma_f32_16x16x32_bf16 v[204:207], a[168:171], v[164:167], v[204:207]
    s_add_u32 s19, s19, 4096
    buffer_load_dwordx4 v[128:131], v2, s[24:27], s19 offen offset:0 sc1
    v_mfma_f32_16x16x32_bf16 v[208:211], a[172:175], v[164:167], v[208:211]
    ds_write_b128 v8, v[176:179] offset:0
    v_mfma_f32_16x16x32_bf16 v[212:215], a[176:179], v[164:167], v[212:215]
    v_mfma_f32_16x16x32_bf16 v[196:199], a[180:183], v[172:175], v[196:199]
    v_mfma_f32_16x16x32_bf16 v[200:203], a[184:187], v[172:175], v[200:203]
    v_mfma_f32_16x16x32_bf16 v[204:207], a[188:191], v[172:175], v[204:207]
    ds_write_b128 v9, v[180:183] offset:1024
    v_mfma_f32_16x16x32_bf16 v[208:211], a[192:195], v[172:175], v[208:211]
    buffer_load_dwordx4 v[132:135], v4, s[24:27], s19 offen offset:0 sc1
    v_mfma_f32_16x16x32_bf16 v[212:215], a[196:199], v[172:175], v[212:215]
    v_mfma_f32_16x16x32_bf16 v[196:199], a[200:203], a[244:247], v[196:199]
    v_mfma_f32_16x16x32_bf16 v[200:203], a[204:207], a[244:247], v[200:203]
    ds_write_b128 v10, v[184:187] offset:2048
    v_mfma_f32_16x16x32_bf16 v[204:207], a[208:211], a[244:247], v[204:207]
    buffer_load_dwordx4 v[136:139], v2, s[24:27], s19 offen offset:1024 sc1
    v_mfma_f32_16x16x32_bf16 v[208:211], a[212:215], a[244:247], v[208:211]
    v_mfma_f32_16x16x32_bf16 v[212:215], a[216:219], a[244:247], v[212:215]
    v_mfma_f32_16x16x32_bf16 v[196:199], a[220:223], a[252:255], v[196:199]
    ds_write_b128 v11, v[188:191] offset:3072
    v_mfma_f32_16x16x32_bf16 v[200:203], a[224:227], a[252:255], v[200:203]
    v_mfma_f32_16x16x32_bf16 v[204:207], a[228:231], a[252:255], v[204:207]
    buffer_load_dwordx4 v[140:143], v4, s[24:27], s19 offen offset:1024 sc1
    v_mfma_f32_16x16x32_bf16 v[208:211], a[232:235], a[252:255], v[208:211]
    v_mfma_f32_16x16x32_bf16 v[212:215], a[236:239], a[252:255], v[212:215]
    ds_write_b128 v8, v[192:195] offset:4096
    s_waitcnt vmcnt(11)
    v_mfma_f32_16x16x32_bf16 v[16:19], a[0:3], v[96:99], 0
    v_mfma_f32_16x16x32_bf16 v[20:23], a[4:7], v[96:99], 0
    buffer_load_dwordx4 v[144:147], v2, s[24:27], s19 offen offset:2048 sc1
    v_mfma_f32_16x16x32_bf16 v[24:27], a[8:11], v[96:99], 0
    v_mfma_f32_16x16x32_bf16 v[28:31], a[12:15], v[96:99], 0
    ds_write_b128 v8, v[196:199] offset:5120
    v_mfma_f32_16x16x32_bf16 v[32:35], a[16:19], v[96:99], 0
    v_mfma_f32_16x16x32_bf16 v[36:39], a[0:3], v[100:103], 0
    buffer_load_dwordx4 v[148:151], v4, s[24:27], s19 offen offset:2048 sc1
    v_mfma_f32_16x16x32_bf16 v[40:43], a[4:7], v[100:103], 0
    ds_write_b128 v9, v[200:203] offset:6144
    v_mfma_f32_16x16x32_bf16 v[44:47], a[8:11], v[100:103], 0
    v_mfma_f32_16x16x32_bf16 v[48:51], a[12:15], v[100:103], 0
    buffer_load_dwordx2 v[230:231], v250, s[20:23], s78 offen
    v_mfma_f32_16x16x32_bf16 v[52:55], a[16:19], v[100:103], 0
    ds_write_b128 v10, v[204:207] offset:7168
    v_mfma_f32_16x16x32_bf16 v[16:19], a[20:23], v[104:107], v[16:19]
    v_mfma_f32_16x16x32_bf16 v[20:23], a[24:27], v[104:107], v[20:23]
    buffer_load_dwordx4 v[152:155], v2, s[24:27], s19 offen offset:3072 sc1
    v_mfma_f32_16x16x32_bf16 v[24:27], a[28:31], v[104:107], v[24:27]
    ds_write_b128 v11, v[208:211] offset:8192
    v_mfma_f32_16x16x32_bf16 v[28:31], a[32:35], v[104:107], v[28:31]
    v_mfma_f32_16x16x32_bf16 v[32:35], a[36:39], v[104:107], v[32:35]
    buffer_load_dwordx4 v[156:159], v4, s[24:27], s19 offen offset:3072 sc1
    v_mfma_f32_16x16x32_bf16 v[36:39], a[20:23], v[108:111], v[36:39]
    ds_write_b128 v8, v[212:215] offset:9216
    v_mfma_f32_16x16x32_bf16 v[40:43], a[24:27], v[108:111], v[40:43]
    v_mfma_f32_16x16x32_bf16 v[44:47], a[28:31], v[108:111], v[44:47]
    v_mfma_f32_16x16x32_bf16 v[48:51], a[32:35], v[108:111], v[48:51]
    buffer_load_dwordx2 v[242:243], v253, s[28:31], s81 offen sc1
    v_mfma_f32_16x16x32_bf16 v[52:55], a[36:39], v[108:111], v[52:55]
    s_waitcnt vmcnt(11)
    v_mfma_f32_16x16x32_bf16 v[16:19], a[40:43], v[112:115], v[16:19]
    s_waitcnt lgkmcnt(0)
    s_barrier
    ds_read_b128 v[80:83], v246 offset:0
    v_mfma_f32_16x16x32_bf16 v[20:23], a[44:47], v[112:115], v[20:23]
    s_add_u32 s19, s19, 4096
    buffer_load_dwordx4 v[160:163], v2, s[24:27], s19 offen offset:0 sc1
    v_mfma_f32_16x16x32_bf16 v[24:27], a[48:51], v[112:115], v[24:27]
    ds_read_b128 v[56:59], v246 offset:10240
    ds_read_b128 v[60:63], v246 offset:20480
    v_mfma_f32_16x16x32_bf16 v[28:31], a[52:55], v[112:115], v[28:31]
    ds_read_b128 v[64:67], v246 offset:30720
    ds_read_b128 v[84:87], v247 offset:0
    v_mfma_f32_16x16x32_bf16 v[32:35], a[56:59], v[112:115], v[32:35]
    buffer_load_dwordx4 v[164:167], v4, s[24:27], s19 offen offset:0 sc1
    v_mfma_f32_16x16x32_bf16 v[36:39], a[40:43], v[116:119], v[36:39]
    ds_read_b128 v[68:71], v247 offset:10240
    ds_read_b128 v[72:75], v247 offset:20480
    v_mfma_f32_16x16x32_bf16 v[40:43], a[44:47], v[116:119], v[40:43]
    ds_read_b128 v[76:79], v247 offset:30720
    v_mfma_f32_16x16x32_bf16 v[44:47], a[48:51], v[116:119], v[44:47]
    s_waitcnt lgkmcnt(4)
    buffer_load_dwordx2 v[232:233], v251, s[20:23], s78 offen
    v_mfma_f32_16x16x32_bf16 v[48:51], a[52:55], v[116:119], v[48:51]
    v_add_f32 v80, v80, v56
    v_add_f32 v60, v60, v64
    v_mfma_f32_16x16x32_bf16 v[52:55], a[56:59], v[116:119], v[52:55]
    v_add_f32 v81, v81, v57
    v_add_f32 v61, v61, v65
    v_mfma_f32_16x16x32_bf16 v[16:19], a[60:63], v[120:123], v[16:19]
    buffer_load_dwordx4 v[168:171], v2, s[24:27], s19 offen offset:1024 sc1
    v_mfma_f32_16x16x32_bf16 v[20:23], a[64:67], v[120:123], v[20:23]
    v_add_f32 v82, v82, v58
    v_add_f32 v62, v62, v66
    v_mfma_f32_16x16x32_bf16 v[24:27], a[68:71], v[120:123], v[24:27]
    buffer_load_dwordx2 v[244:245], v254, s[28:31], s81 offen sc1
    v_mfma_f32_16x16x32_bf16 v[28:31], a[72:75], v[120:123], v[28:31]
    v_add_f32 v83, v83, v59
    v_add_f32 v63, v63, v67
    v_mfma_f32_16x16x32_bf16 v[32:35], a[76:79], v[120:123], v[32:35]
    v_add_f32 v80, v80, v60
    v_add_f32 v81, v81, v61
    v_mfma_f32_16x16x32_bf16 v[36:39], a[60:63], v[124:127], v[36:39]
    buffer_load_dwordx4 v[172:175], v4, s[24:27], s19 offen offset:1024 sc1
    v_mfma_f32_16x16x32_bf16 v[40:43], a[64:67], v[124:127], v[40:43]
    v_add_f32 v82, v82, v62
    v_add_f32 v83, v83, v63
    v_mfma_f32_16x16x32_bf16 v[44:47], a[68:71], v[124:127], v[44:47]
    ds_read_b128 v[88:91], v248 offset:0
    v_mfma_f32_16x16x32_bf16 v[48:51], a[72:75], v[124:127], v[48:51]
    s_lshl_b32 s78, s78, 1
    ds_read_b128 v[56:59], v248 offset:10240
    ds_read_b128 v[60:63], v248 offset:20480
    v_mfma_f32_16x16x32_bf16 v[52:55], a[76:79], v[124:127], v[52:55]
    ds_read_b128 v[64:67], v248 offset:30720
    s_waitcnt vmcnt(12)
    v_mfma_f32_16x16x32_bf16 v[16:19], a[80:83], v[128:131], v[16:19]
    v_add_u32 v246, 0xa000, v246
    v_add_u32 v247, 0xa000, v247
    v_add_u32 v248, 0xa000, v248
    v_mfma_f32_16x16x32_bf16 v[20:23], a[84:87], v[128:131], v[20:23]
    s_waitcnt lgkmcnt(4)
    v_add_f32 v84, v84, v68
    v_add_f32 v72, v72, v76
    v_mfma_f32_16x16x32_bf16 v[24:27], a[88:91], v[128:131], v[24:27]
    s_add_u32 s19, s11, s100
    buffer_load_dwordx4 a[240:243], v2, s[24:27], s19 offen offset:0 sc1
    v_add_f32 v85, v85, v69
    v_mfma_f32_16x16x32_bf16 v[28:31], a[92:95], v[128:131], v[28:31]
    v_add_f32 v73, v73, v77
    v_add_f32 v86, v86, v70
    v_mfma_f32_16x16x32_bf16 v[32:35], a[96:99], v[128:131], v[32:35]
    v_add_f32 v74, v74, v78
    v_add_f32 v87, v87, v71
    v_mfma_f32_16x16x32_bf16 v[36:39], a[80:83], v[132:135], v[36:39]
    v_add_f32 v75, v75, v79
    v_add_f32 v84, v84, v72
    v_mfma_f32_16x16x32_bf16 v[40:43], a[84:87], v[132:135], v[40:43]
    buffer_load_dwordx4 a[244:247], v4, s[24:27], s19 offen offset:0 sc1
    v_add_f32 v85, v85, v73
    v_mfma_f32_16x16x32_bf16 v[44:47], a[88:91], v[132:135], v[44:47]
    v_add_f32 v86, v86, v74
    v_add_f32 v87, v87, v75
    v_mfma_f32_16x16x32_bf16 v[48:51], a[92:95], v[132:135], v[48:51]
    s_waitcnt lgkmcnt(0)
    v_add_f32 v88, v88, v56
    v_add_f32 v60, v60, v64
    v_mfma_f32_16x16x32_bf16 v[52:55], a[96:99], v[132:135], v[52:55]
    v_add_f32 v89, v89, v57
    v_add_f32 v61, v61, v65
    v_mfma_f32_16x16x32_bf16 v[16:19], a[100:103], v[136:139], v[16:19]
    s_add_u32 s19, s11, s101
    buffer_load_dwordx4 a[248:251], v2, s[24:27], s19 offen offset:0 sc1
    v_add_f32 v90, v90, v58
    v_mfma_f32_16x16x32_bf16 v[20:23], a[104:107], v[136:139], v[20:23]
    v_add_f32 v62, v62, v66
    v_add_f32 v91, v91, v59
    v_add_f32 v63, v63, v67
    v_mfma_f32_16x16x32_bf16 v[24:27], a[108:111], v[136:139], v[24:27]
    v_add_f32 v88, v88, v60
    v_add_f32 v89, v89, v61
    v_mfma_f32_16x16x32_bf16 v[28:31], a[112:115], v[136:139], v[28:31]
    v_add_f32 v90, v90, v62
    v_add_f32 v91, v91, v63
    v_mfma_f32_16x16x32_bf16 v[32:35], a[116:119], v[136:139], v[32:35]
    buffer_load_dwordx4 a[252:255], v4, s[24:27], s19 offen offset:0 sc1
    v_bfi_b32 v80, v5, s66, v80
    v_bfi_b32 v81, v5, s67, v81
    v_mfma_f32_16x16x32_bf16 v[36:39], a[100:103], v[140:143], v[36:39]
    v_bfi_b32 v82, v5, s68, v82
    v_bfi_b32 v83, v5, s69, v83
    v_mfma_f32_16x16x32_bf16 v[40:43], a[104:107], v[140:143], v[40:43]
    v_bfi_b32 v84, v5, s66, v84
    v_bfi_b32 v85, v5, s67, v85
    v_mfma_f32_16x16x32_bf16 v[44:47], a[108:111], v[140:143], v[44:47]
    v_bfi_b32 v86, v5, s68, v86
    v_bfi_b32 v87, v5, s69, v87
    v_mfma_f32_16x16x32_bf16 v[48:51], a[112:115], v[140:143], v[48:51]
    s_lshl_b32 s87, s9, 14
    s_add_u32 s87, s87, 270464
    buffer_load_dword v6, v7, s[28:31], s87 offen sc1
    v_bfi_b32 v88, v5, s66, v88
    v_mfma_f32_16x16x32_bf16 v[52:55], a[116:119], v[140:143], v[52:55]
    v_bfi_b32 v89, v5, s67, v89
    v_bfi_b32 v90, v5, s68, v90
    v_bfi_b32 v91, v5, s69, v91
    s_waitcnt vmcnt(12)
    v_mfma_f32_16x16x32_bf16 v[16:19], a[120:123], v[144:147], v[16:19]
    s_xor_b32 s16, s92, 32
    s_mul_i32 s79, s16, 40960
    s_add_u32 s79, s79, s60
    s_lshl_b32 s61, s16, 11
    s_add_u32 s61, s61, 811136
    v_mfma_f32_16x16x32_bf16 v[20:23], a[124:127], v[144:147], v[20:23]
    buffer_store_dwordx4 v[80:83], v2, s[44:47], s76 offen sc1
    v_mfma_f32_16x16x32_bf16 v[24:27], a[128:131], v[144:147], v[24:27]
    v_mfma_f32_16x16x32_bf16 v[28:31], a[132:135], v[144:147], v[28:31]
    buffer_load_dwordx2 v[56:57], v249, s[20:23], s79 offen
    v_mfma_f32_16x16x32_bf16 v[32:35], a[136:139], v[144:147], v[32:35]
    v_mfma_f32_16x16x32_bf16 v[36:39], a[120:123], v[148:151], v[36:39]
    buffer_store_dwordx4 v[84:87], v2, s[44:47], s76 offen offset:1024 sc1
    v_mfma_f32_16x16x32_bf16 v[40:43], a[124:127], v[148:151], v[40:43]
    buffer_load_dwordx2 v[62:63], v252, s[28:31], s61 offen sc1
    v_mfma_f32_16x16x32_bf16 v[44:47], a[128:131], v[148:151], v[44:47]
    v_mfma_f32_16x16x32_bf16 v[48:51], a[132:135], v[148:151], v[48:51]
    buffer_load_dwordx2 v[58:59], v250, s[20:23], s79 offen
    v_mfma_f32_16x16x32_bf16 v[52:55], a[136:139], v[148:151], v[52:55]
    buffer_store_dwordx4 v[88:91], v3, s[44:47], s76 offen offset:2048 sc1
    v_mfma_f32_16x16x32_bf16 v[16:19], a[140:143], v[152:155], v[16:19]
    s_waitcnt vmcnt(12)
    v_xor_b32 v92, v241, v13
    v_xor_b32 v93, v243, v13
    v_xor_b32 v94, v245, v13
    v_or3_b32 v92, v92, v93, v94
    v_cmp_ne_u32 vcc, 0, v92
    s_cbranch_vccnz Lress_40
Lresb_41:
    v_mfma_f32_16x16x32_bf16 v[20:23], a[144:147], v[152:155], v[20:23]
    buffer_load_dwordx2 v[64:65], v253, s[28:31], s61 offen sc1
    v_and_b32 v241, s12, v240
    v_lshlrev_b32 v240, 16, v240
    v_mfma_f32_16x16x32_bf16 v[24:27], a[148:151], v[152:155], v[24:27]
    v_rcp_f32 v241, v241
    v_and_b32 v243, s12, v242
    v_lshlrev_b32 v242, 16, v242
    v_mfma_f32_16x16x32_bf16 v[28:31], a[152:155], v[152:155], v[28:31]
    buffer_load_dwordx2 v[60:61], v251, s[20:23], s79 offen
    v_rcp_f32 v243, v243
    v_and_b32 v245, s12, v244
    v_mfma_f32_16x16x32_bf16 v[32:35], a[156:159], v[152:155], v[32:35]
    v_lshlrev_b32 v244, 16, v244
    v_rcp_f32 v245, v245
    v_mfma_f32_16x16x32_bf16 v[36:39], a[140:143], v[156:159], v[36:39]
    v_lshlrev_b32 v216, 16, v228
    v_and_b32 v217, s12, v228
    v_mfma_f32_16x16x32_bf16 v[40:43], a[144:147], v[156:159], v[40:43]
    buffer_load_dwordx2 v[66:67], v254, s[28:31], s61 offen sc1
    v_add_f32 v94, v216, v240
    v_add_f32 v95, v217, v240
    v_mfma_f32_16x16x32_bf16 v[44:47], a[148:151], v[156:159], v[44:47]
    v_lshlrev_b32 v92, 16, v234
    v_and_b32 v93, s12, v234
    v_mfma_f32_16x16x32_bf16 v[48:51], a[152:155], v[156:159], v[48:51]
    s_lshl_b32 s79, s79, 1
    v_mul_f32 v92, v92, v241
    v_mul_f32 v93, v93, v241
    v_mfma_f32_16x16x32_bf16 v[52:55], a[156:159], v[156:159], v[52:55]
    v_fmac_f32 v216, v94, v92
    v_fmac_f32 v217, v95, v93
    s_waitcnt vmcnt(14)
    v_mfma_f32_16x16x32_bf16 v[16:19], a[160:163], v[160:163], v[16:19]
    v_lshlrev_b32 v218, 16, v229
    v_and_b32 v219, s12, v229
    v_mfma_f32_16x16x32_bf16 v[20:23], a[164:167], v[160:163], v[20:23]
    v_mfma_f32_16x16x32_bf16 v[24:27], a[168:171], v[160:163], v[24:27]
    v_add_f32 v94, v218, v240
    v_add_f32 v95, v219, v240
    v_mfma_f32_16x16x32_bf16 v[28:31], a[172:175], v[160:163], v[28:31]
    v_lshlrev_b32 v92, 16, v235
    v_and_b32 v93, s12, v235
    v_mfma_f32_16x16x32_bf16 v[32:35], a[176:179], v[160:163], v[32:35]
    s_waitcnt vmcnt(9)
    v_cmp_ne_u32 vcc, v6, v13
    s_cbranch_vccnz Lq2s_42
Lq2b_43:
    s_xor_b32 s16, s92, 32
    s_mul_i32 s11, s16, 192512
    s_add_u32 s19, s11, s93
    buffer_load_dwordx4 v[96:99], v2, s[24:27], s19 offen offset:0 sc1
    v_mfma_f32_16x16x32_bf16 v[36:39], a[160:163], v[164:167], v[36:39]
    v_mul_f32 v92, v92, v241
    v_mfma_f32_16x16x32_bf16 v[40:43], a[164:167], v[164:167], v[40:43]
    v_mul_f32 v93, v93, v241
    v_fmac_f32 v218, v94, v92
    v_mfma_f32_16x16x32_bf16 v[44:47], a[168:171], v[164:167], v[44:47]
    v_fmac_f32 v219, v95, v93
    v_lshlrev_b32 v220, 16, v230
    v_mfma_f32_16x16x32_bf16 v[48:51], a[172:175], v[164:167], v[48:51]
    buffer_load_dwordx4 v[100:103], v4, s[24:27], s19 offen offset:0 sc1
    v_mfma_f32_16x16x32_bf16 v[52:55], a[176:179], v[164:167], v[52:55]
    v_and_b32 v221, s12, v230
    v_add_f32 v94, v220, v242
    v_mfma_f32_16x16x32_bf16 v[16:19], a[180:183], v[168:171], v[16:19]
    v_mfma_f32_16x16x32_bf16 v[20:23], a[184:187], v[168:171], v[20:23]
    v_add_f32 v95, v221, v242
    v_lshlrev_b32 v92, 16, v236
    v_mfma_f32_16x16x32_bf16 v[24:27], a[188:191], v[168:171], v[24:27]
    v_and_b32 v93, s12, v236
    v_mul_f32 v92, v92, v243
    v_mfma_f32_16x16x32_bf16 v[28:31], a[192:195], v[168:171], v[28:31]
    buffer_load_dwordx4 v[104:107], v2, s[24:27], s19 offen offset:1024 sc1
    v_mfma_f32_16x16x32_bf16 v[32:35], a[196:199], v[168:171], v[32:35]
    v_mul_f32 v93, v93, v243
    v_fmac_f32 v220, v94, v92
    v_mfma_f32_16x16x32_bf16 v[36:39], a[180:183], v[172:175], v[36:39]
    v_fmac_f32 v221, v95, v93
    v_mfma_f32_16x16x32_bf16 v[40:43], a[184:187], v[172:175], v[40:43]
    v_lshlrev_b32 v222, 16, v231
    v_and_b32 v223, s12, v231
    v_mfma_f32_16x16x32_bf16 v[44:47], a[188:191], v[172:175], v[44:47]
    buffer_load_dwordx4 v[108:111], v4, s[24:27], s19 offen offset:1024 sc1
    v_mfma_f32_16x16x32_bf16 v[48:51], a[192:195], v[172:175], v[48:51]
    v_add_f32 v94, v222, v242
    v_add_f32 v95, v223, v242
    v_mfma_f32_16x16x32_bf16 v[52:55], a[196:199], v[172:175], v[52:55]
    v_lshlrev_b32 v92, 16, v237
    v_mfma_f32_16x16x32_bf16 v[16:19], a[200:203], a[240:243], v[16:19]
    v_and_b32 v93, s12, v237
    v_mul_f32 v92, v92, v243
    v_mfma_f32_16x16x32_bf16 v[20:23], a[204:207], a[240:243], v[20:23]
    buffer_load_dwordx4 v[112:115], v2, s[24:27], s19 offen offset:2048 sc1
    v_mfma_f32_16x16x32_bf16 v[24:27], a[208:211], a[240:243], v[24:27]
    v_mul_f32 v93, v93, v243
    v_fmac_f32 v222, v94, v92
    v_mfma_f32_16x16x32_bf16 v[28:31], a[212:215], a[240:243], v[28:31]
    buffer_load_dwordx4 v[116:119], v4, s[24:27], s19 offen offset:2048 sc1
    v_mfma_f32_16x16x32_bf16 v[32:35], a[216:219], a[240:243], v[32:35]
    v_fmac_f32 v223, v95, v93
    v_lshlrev_b32 v224, 16, v232
    v_mfma_f32_16x16x32_bf16 v[36:39], a[200:203], a[244:247], v[36:39]
    v_and_b32 v225, s12, v232
    v_add_f32 v94, v224, v244
    v_mfma_f32_16x16x32_bf16 v[40:43], a[204:207], a[244:247], v[40:43]
    buffer_load_dwordx4 v[120:123], v2, s[24:27], s19 offen offset:3072 sc1
    v_mfma_f32_16x16x32_bf16 v[44:47], a[208:211], a[244:247], v[44:47]
    v_add_f32 v95, v225, v244
    v_lshlrev_b32 v92, 16, v238
    v_mfma_f32_16x16x32_bf16 v[48:51], a[212:215], a[244:247], v[48:51]
    buffer_load_dwordx4 v[124:127], v4, s[24:27], s19 offen offset:3072 sc1
    v_mfma_f32_16x16x32_bf16 v[52:55], a[216:219], a[244:247], v[52:55]
    v_and_b32 v93, s12, v238
    v_mul_f32 v92, v92, v245
    v_mfma_f32_16x16x32_bf16 v[16:19], a[220:223], a[248:251], v[16:19]
    v_mul_f32 v93, v93, v245
    v_fmac_f32 v224, v94, v92
    v_mfma_f32_16x16x32_bf16 v[20:23], a[224:227], a[248:251], v[20:23]
    s_add_u32 s19, s19, 4096
L_hk7667:
    s_cbranch_execz L_hback
    buffer_load_dwordx4 v[128:131], v2, s[24:27], s19 offen offset:0 sc1
    v_fmac_f32 v225, v95, v93
    v_mfma_f32_16x16x32_bf16 v[24:27], a[228:231], a[248:251], v[24:27]
    v_lshlrev_b32 v226, 16, v233
    v_and_b32 v227, s12, v233
    v_mfma_f32_16x16x32_bf16 v[28:31], a[232:235], a[248:251], v[28:31]
    buffer_load_dwordx4 v[132:135], v4, s[24:27], s19 offen offset:0 sc1
    v_mfma_f32_16x16x32_bf16 v[32:35], a[236:239], a[248:251], v[32:35]
    v_add_f32 v94, v226, v244
    v_add_f32 v95, v227, v244
    v_mfma_f32_16x16x32_bf16 v[36:39], a[220:223], a[252:255], v[36:39]
    v_lshlrev_b32 v92, 16, v239
    v_and_b32 v93, s12, v239
    v_mfma_f32_16x16x32_bf16 v[40:43], a[224:227], a[252:255], v[40:43]
    buffer_load_dwordx4 v[136:139], v2, s[24:27], s19 offen offset:1024 sc1
    v_mfma_f32_16x16x32_bf16 v[44:47], a[228:231], a[252:255], v[44:47]
    v_mul_f32 v92, v92, v245
    v_mul_f32 v93, v93, v245
    v_mfma_f32_16x16x32_bf16 v[48:51], a[232:235], a[252:255], v[48:51]
    buffer_load_dwordx4 v[140:143], v4, s[24:27], s19 offen offset:1024 sc1
    v_mfma_f32_16x16x32_bf16 v[52:55], a[236:239], a[252:255], v[52:55]
    v_fmac_f32 v226, v94, v92
    v_fmac_f32 v227, v95, v93
    s_waitcnt vmcnt(8)
    v_mfma_f32_16x16x32_bf16 v[176:179], a[0:3], v[96:99], 0
    v_xor_b32 v92, v63, v13
    v_xor_b32 v93, v65, v13
    v_xor_b32 v94, v67, v13
    v_or3_b32 v92, v92, v93, v94
    v_cmp_ne_u32 vcc, 0, v92
    s_cbranch_vccnz Lress_44
Lresb_45:
    v_mfma_f32_16x16x32_bf16 v[180:183], a[4:7], v[96:99], 0
    v_and_b32 v63, s12, v62
    v_lshlrev_b32 v62, 16, v62
    v_rcp_f32 v63, v63
    v_mfma_f32_16x16x32_bf16 v[184:187], a[8:11], v[96:99], 0
    buffer_load_dwordx4 v[144:147], v2, s[24:27], s19 offen offset:2048 sc1
    v_and_b32 v65, s12, v64
    v_lshlrev_b32 v64, 16, v64
    v_mfma_f32_16x16x32_bf16 v[188:191], a[12:15], v[96:99], 0
    ds_write_b128 v8, v[16:19] offset:40960
    v_mfma_f32_16x16x32_bf16 v[192:195], a[16:19], v[96:99], 0
    v_rcp_f32 v65, v65
    v_and_b32 v67, s12, v66
    v_mfma_f32_16x16x32_bf16 v[196:199], a[0:3], v[100:103], 0
    v_lshlrev_b32 v66, 16, v66
    v_rcp_f32 v67, v67
    v_mfma_f32_16x16x32_bf16 v[200:203], a[4:7], v[100:103], 0
    buffer_load_dwordx4 v[148:151], v4, s[24:27], s19 offen offset:2048 sc1
    v_lshlrev_b32 v80, 16, v56
    v_and_b32 v81, s12, v56
    v_mfma_f32_16x16x32_bf16 v[204:207], a[8:11], v[100:103], 0
    ds_write_b128 v9, v[20:23] offset:41984
    v_mfma_f32_16x16x32_bf16 v[208:211], a[12:15], v[100:103], 0
    v_add_f32 v94, v80, v62
    v_add_f32 v95, v81, v62
    v_lshlrev_b32 v92, 16, v234
    v_mfma_f32_16x16x32_bf16 v[212:215], a[16:19], v[100:103], 0
    v_and_b32 v93, s12, v234
    v_mul_f32 v92, v92, v63
    v_mfma_f32_16x16x32_bf16 v[176:179], a[20:23], v[104:107], v[176:179]
    v_mul_f32 v93, v93, v63
    v_fmac_f32 v80, v94, v92
    v_mfma_f32_16x16x32_bf16 v[180:183], a[24:27], v[104:107], v[180:183]
    ds_write_b128 v10, v[24:27] offset:43008
    v_mfma_f32_16x16x32_bf16 v[184:187], a[28:31], v[104:107], v[184:187]
    buffer_load_dwordx4 v[152:155], v2, s[24:27], s19 offen offset:3072 sc1
    v_fmac_f32 v81, v95, v93
    v_lshlrev_b32 v82, 16, v57
    v_mfma_f32_16x16x32_bf16 v[188:191], a[32:35], v[104:107], v[188:191]
    v_and_b32 v83, s12, v57
    v_add_f32 v94, v82, v62
    v_mfma_f32_16x16x32_bf16 v[192:195], a[36:39], v[104:107], v[192:195]
    v_add_f32 v95, v83, v62
    v_lshlrev_b32 v92, 16, v235
    v_and_b32 v93, s12, v235
    v_mfma_f32_16x16x32_bf16 v[196:199], a[20:23], v[108:111], v[196:199]
    ds_write_b128 v11, v[28:31] offset:44032
    v_mfma_f32_16x16x32_bf16 v[200:203], a[24:27], v[108:111], v[200:203]
    v_mul_f32 v92, v92, v63
    v_mul_f32 v93, v93, v63
    v_mfma_f32_16x16x32_bf16 v[204:207], a[28:31], v[108:111], v[204:207]
    buffer_load_dwordx4 v[156:159], v4, s[24:27], s19 offen offset:3072 sc1
    v_fmac_f32 v82, v94, v92
    v_fmac_f32 v83, v95, v93
    v_mfma_f32_16x16x32_bf16 v[208:211], a[32:35], v[108:111], v[208:211]
    v_lshlrev_b32 v84, 16, v58
    v_and_b32 v85, s12, v58
    v_add_f32 v94, v84, v64
    v_mfma_f32_16x16x32_bf16 v[212:215], a[36:39], v[108:111], v[212:215]
    ds_write_b128 v8, v[32:35] offset:45056
    s_waitcnt vmcnt(8)
    v_mfma_f32_16x16x32_bf16 v[176:179], a[40:43], v[112:115], v[176:179]
    v_add_f32 v95, v85, v64
    v_lshlrev_b32 v92, 16, v236
    v_mfma_f32_16x16x32_bf16 v[180:183], a[44:47], v[112:115], v[180:183]
    v_and_b32 v93, s12, v236
    v_mul_f32 v92, v92, v65
    v_mul_f32 v93, v93, v65
    v_mfma_f32_16x16x32_bf16 v[184:187], a[48:51], v[112:115], v[184:187]
    ds_write_b128 v8, v[36:39] offset:46080
    v_mfma_f32_16x16x32_bf16 v[188:191], a[52:55], v[112:115], v[188:191]
    s_add_u32 s19, s19, 4096
    buffer_load_dwordx4 v[160:163], v2, s[24:27], s19 offen offset:0 sc1
    v_fmac_f32 v84, v94, v92
    v_fmac_f32 v85, v95, v93
    v_mfma_f32_16x16x32_bf16 v[192:195], a[56:59], v[112:115], v[192:195]
    v_lshlrev_b32 v86, 16, v59
    v_and_b32 v87, s12, v59
    v_mfma_f32_16x16x32_bf16 v[196:199], a[40:43], v[116:119], v[196:199]
    v_add_f32 v94, v86, v64
    v_add_f32 v95, v87, v64
    v_lshlrev_b32 v92, 16, v237
    v_mfma_f32_16x16x32_bf16 v[200:203], a[44:47], v[116:119], v[200:203]
    ds_write_b128 v9, v[40:43] offset:47104
    v_mfma_f32_16x16x32_bf16 v[204:207], a[48:51], v[116:119], v[204:207]
    buffer_load_dwordx4 v[164:167], v4, s[24:27], s19 offen offset:0 sc1
    v_and_b32 v93, s12, v237
    v_mul_f32 v92, v92, v65
    v_mfma_f32_16x16x32_bf16 v[208:211], a[52:55], v[116:119], v[208:211]
    v_mul_f32 v93, v93, v65
    v_fmac_f32 v86, v94, v92
    v_fmac_f32 v87, v95, v93
    v_mfma_f32_16x16x32_bf16 v[212:215], a[56:59], v[116:119], v[212:215]
    v_lshlrev_b32 v88, 16, v60
    v_and_b32 v89, s12, v60
    v_mfma_f32_16x16x32_bf16 v[176:179], a[60:63], v[120:123], v[176:179]
    ds_write_b128 v10, v[44:47] offset:48128
    v_mfma_f32_16x16x32_bf16 v[180:183], a[64:67], v[120:123], v[180:183]
    v_add_f32 v94, v88, v66
    v_add_f32 v95, v89, v66
    v_lshlrev_b32 v92, 16, v238
    v_mfma_f32_16x16x32_bf16 v[184:187], a[68:71], v[120:123], v[184:187]
    buffer_load_dwordx4 v[168:171], v2, s[24:27], s19 offen offset:1024 sc1
    v_and_b32 v93, s12, v238
    v_mul_f32 v92, v92, v67
    v_mfma_f32_16x16x32_bf16 v[188:191], a[72:75], v[120:123], v[188:191]
    v_mul_f32 v93, v93, v67
    v_fmac_f32 v88, v94, v92
    v_fmac_f32 v89, v95, v93
    v_mfma_f32_16x16x32_bf16 v[192:195], a[76:79], v[120:123], v[192:195]
    ds_write_b128 v11, v[48:51] offset:49152
    v_mfma_f32_16x16x32_bf16 v[196:199], a[60:63], v[124:127], v[196:199]
    v_lshlrev_b32 v90, 16, v61
    v_and_b32 v91, s12, v61
    v_add_f32 v94, v90, v66
    v_mfma_f32_16x16x32_bf16 v[200:203], a[64:67], v[124:127], v[200:203]
    v_add_f32 v95, v91, v66
    v_lshlrev_b32 v92, 16, v239
    v_mfma_f32_16x16x32_bf16 v[204:207], a[68:71], v[124:127], v[204:207]
    buffer_load_dwordx4 v[172:175], v4, s[24:27], s19 offen offset:1024 sc1
    v_and_b32 v93, s12, v239
    v_mul_f32 v92, v92, v67
    v_mfma_f32_16x16x32_bf16 v[208:211], a[72:75], v[124:127], v[208:211]
    ds_write_b128 v8, v[52:55] offset:50176
    v_mfma_f32_16x16x32_bf16 v[212:215], a[76:79], v[124:127], v[212:215]
    v_mul_f32 v93, v93, v67
    v_fmac_f32 v90, v94, v92
    v_fmac_f32 v91, v95, v93
    s_waitcnt vmcnt(8)
    v_mfma_f32_16x16x32_bf16 v[176:179], a[80:83], v[128:131], v[176:179]
    v_mfma_f32_16x16x32_bf16 v[180:183], a[84:87], v[128:131], v[180:183]
    s_add_u32 s19, s11, s100
    buffer_load_dwordx4 a[240:243], v2, s[24:27], s19 offen offset:0 sc1
    v_mfma_f32_16x16x32_bf16 v[184:187], a[88:91], v[128:131], v[184:187]
    v_mfma_f32_16x16x32_bf16 v[188:191], a[92:95], v[128:131], v[188:191]
    s_waitcnt lgkmcnt(0)
    s_barrier
    ds_read_b128 v[16:19], v246 offset:0
    v_mfma_f32_16x16x32_bf16 v[192:195], a[96:99], v[128:131], v[192:195]
    buffer_load_dwordx4 a[244:247], v4, s[24:27], s19 offen offset:0 sc1
    v_mfma_f32_16x16x32_bf16 v[196:199], a[80:83], v[132:135], v[196:199]
    ds_read_b128 v[20:23], v246 offset:10240
    v_mfma_f32_16x16x32_bf16 v[200:203], a[84:87], v[132:135], v[200:203]
    ds_read_b128 v[24:27], v246 offset:20480
    ds_read_b128 v[28:31], v246 offset:30720
    v_mfma_f32_16x16x32_bf16 v[204:207], a[88:91], v[132:135], v[204:207]
    buffer_load_dwordx4 v[228:231], v2, s[44:47], s77 offen sc1
    v_mfma_f32_16x16x32_bf16 v[208:211], a[92:95], v[132:135], v[208:211]
    ds_read_b128 v[32:35], v247 offset:0
    ds_read_b128 v[36:39], v247 offset:10240
    v_mfma_f32_16x16x32_bf16 v[212:215], a[96:99], v[132:135], v[212:215]
    ds_read_b128 v[40:43], v247 offset:20480
    ds_read_b128 v[44:47], v247 offset:30720
    v_mfma_f32_16x16x32_bf16 v[176:179], a[100:103], v[136:139], v[176:179]
    s_add_u32 s19, s11, s101
    buffer_load_dwordx4 a[248:251], v2, s[24:27], s19 offen offset:0 sc1
    v_mfma_f32_16x16x32_bf16 v[180:183], a[104:107], v[136:139], v[180:183]
    ds_read_b128 v[56:59], v248 offset:0
    ds_read_b128 v[60:63], v248 offset:10240
    v_mfma_f32_16x16x32_bf16 v[184:187], a[108:111], v[136:139], v[184:187]
    buffer_load_dwordx4 v[240:243], v2, s[44:47], s77 offen offset:1024 sc1
    v_mfma_f32_16x16x32_bf16 v[188:191], a[112:115], v[136:139], v[188:191]
    ds_read_b128 v[64:67], v248 offset:20480
    ds_read_b128 v[68:71], v248 offset:30720
    v_mfma_f32_16x16x32_bf16 v[192:195], a[116:119], v[136:139], v[192:195]
    v_add_u32 v246, 0xffff6000, v246
    v_mfma_f32_16x16x32_bf16 v[196:199], a[100:103], v[140:143], v[196:199]
    buffer_load_dwordx4 a[252:255], v4, s[24:27], s19 offen offset:0 sc1
    v_mfma_f32_16x16x32_bf16 v[200:203], a[104:107], v[140:143], v[200:203]
    v_add_u32 v247, 0xffff6000, v247
    v_mfma_f32_16x16x32_bf16 v[204:207], a[108:111], v[140:143], v[204:207]
    v_add_u32 v248, 0xffff6000, v248
    v_mfma_f32_16x16x32_bf16 v[208:211], a[112:115], v[140:143], v[208:211]
    s_waitcnt lgkmcnt(8)
    buffer_load_dwordx4 v[72:75], v12, s[44:47], s77 offen offset:2048 sc1
    v_mfma_f32_16x16x32_bf16 v[212:215], a[116:119], v[140:143], v[212:215]
    v_add_f32 v16, v16, v20
    v_add_f32 v24, v24, v28
    s_waitcnt vmcnt(11)
    v_mfma_f32_16x16x32_bf16 v[176:179], a[120:123], v[144:147], v[176:179]
    v_add_f32 v17, v17, v21
    v_add_f32 v25, v25, v29
    v_mfma_f32_16x16x32_bf16 v[180:183], a[124:127], v[144:147], v[180:183]
    v_add_f32 v18, v18, v22
    v_add_f32 v26, v26, v30
    v_mfma_f32_16x16x32_bf16 v[184:187], a[128:131], v[144:147], v[184:187]
    s_xor_b32 s16, s92, 33
    s_mul_i32 s11, s16, 192512
    s_add_u32 s19, s11, s93
    buffer_load_dwordx4 v[96:99], v2, s[24:27], s19 offen offset:0 sc1
    v_mfma_f32_16x16x32_bf16 v[188:191], a[132:135], v[144:147], v[188:191]
    v_add_f32 v19, v19, v23
    v_add_f32 v27, v27, v31
    v_mfma_f32_16x16x32_bf16 v[192:195], a[136:139], v[144:147], v[192:195]
    v_add_f32 v216, v216, v16
    v_add_f32 v217, v217, v17
    v_mfma_f32_16x16x32_bf16 v[196:199], a[120:123], v[148:151], v[196:199]
    v_add_f32 v218, v218, v18
    v_add_f32 v219, v219, v19
    v_mfma_f32_16x16x32_bf16 v[200:203], a[124:127], v[148:151], v[200:203]
    v_add_f32 v216, v216, v24
    v_add_f32 v217, v217, v25
    v_mfma_f32_16x16x32_bf16 v[204:207], a[128:131], v[148:151], v[204:207]
    buffer_load_dwordx4 v[100:103], v4, s[24:27], s19 offen offset:0 sc1
    v_mfma_f32_16x16x32_bf16 v[208:211], a[132:135], v[148:151], v[208:211]
    v_add_f32 v218, v218, v26
    v_add_f32 v219, v219, v27
    v_mfma_f32_16x16x32_bf16 v[212:215], a[136:139], v[148:151], v[212:215]
    s_waitcnt lgkmcnt(4)
    v_add_f32 v32, v32, v36
    v_add_f32 v40, v40, v44
    v_mfma_f32_16x16x32_bf16 v[176:179], a[140:143], v[152:155], v[176:179]
    v_add_f32 v33, v33, v37
    v_add_f32 v41, v41, v45
    v_mfma_f32_16x16x32_bf16 v[180:183], a[144:147], v[152:155], v[180:183]
    v_add_f32 v34, v34, v38
    v_add_f32 v42, v42, v46
    v_mfma_f32_16x16x32_bf16 v[184:187], a[148:151], v[152:155], v[184:187]
    buffer_load_dwordx4 v[104:107], v2, s[24:27], s19 offen offset:1024 sc1
    v_mfma_f32_16x16x32_bf16 v[188:191], a[152:155], v[152:155], v[188:191]
    v_add_f32 v35, v35, v39
    v_add_f32 v43, v43, v47
    v_mfma_f32_16x16x32_bf16 v[192:195], a[156:159], v[152:155], v[192:195]
    v_add_f32 v220, v220, v32
    v_add_f32 v221, v221, v33
    v_mfma_f32_16x16x32_bf16 v[196:199], a[140:143], v[156:159], v[196:199]
    v_add_f32 v222, v222, v34
    v_add_f32 v223, v223, v35
    v_mfma_f32_16x16x32_bf16 v[200:203], a[144:147], v[156:159], v[200:203]
    v_add_f32 v220, v220, v40
    v_add_f32 v221, v221, v41
    v_mfma_f32_16x16x32_bf16 v[204:207], a[148:151], v[156:159], v[204:207]
    buffer_load_dwordx4 v[108:111], v4, s[24:27], s19 offen offset:1024 sc1
    v_mfma_f32_16x16x32_bf16 v[208:211], a[152:155], v[156:159], v[208:211]
    v_add_f32 v222, v222, v42
    v_add_f32 v223, v223, v43
    v_mfma_f32_16x16x32_bf16 v[212:215], a[156:159], v[156:159], v[212:215]
    s_waitcnt lgkmcnt(0)
    v_add_f32 v56, v56, v60
    s_waitcnt vmcnt(5)
    v_mfma_f32_16x16x32_bf16 v[176:179], a[160:163], v[160:163], v[176:179]
    v_add_f32 v64, v64, v68
    v_add_f32 v57, v57, v61
    v_mfma_f32_16x16x32_bf16 v[180:183], a[164:167], v[160:163], v[180:183]
    buffer_load_dwordx4 v[112:115], v2, s[24:27], s19 offen offset:2048 sc1
    v_mfma_f32_16x16x32_bf16 v[184:187], a[168:171], v[160:163], v[184:187]
    v_add_f32 v65, v65, v69
    v_add_f32 v58, v58, v62
    v_mfma_f32_16x16x32_bf16 v[188:191], a[172:175], v[160:163], v[188:191]
    v_add_f32 v66, v66, v70
    v_add_f32 v59, v59, v63
    v_mfma_f32_16x16x32_bf16 v[192:195], a[176:179], v[160:163], v[192:195]
    v_add_f32 v67, v67, v71
    v_add_f32 v224, v224, v56
    v_mfma_f32_16x16x32_bf16 v[176:179], a[180:183], v[168:171], v[176:179]
    buffer_load_dwordx4 v[116:119], v4, s[24:27], s19 offen offset:2048 sc1
    v_mfma_f32_16x16x32_bf16 v[180:183], a[184:187], v[168:171], v[180:183]
    v_add_f32 v225, v225, v57
    v_add_f32 v226, v226, v58
    v_mfma_f32_16x16x32_bf16 v[184:187], a[188:191], v[168:171], v[184:187]
    v_add_f32 v227, v227, v59
    v_add_f32 v224, v224, v64
    v_mfma_f32_16x16x32_bf16 v[188:191], a[192:195], v[168:171], v[188:191]
    buffer_load_dwordx4 v[120:123], v2, s[24:27], s19 offen offset:3072 sc1
    v_add_f32 v225, v225, v65
    v_mfma_f32_16x16x32_bf16 v[192:195], a[196:199], v[168:171], v[192:195]
    v_add_f32 v226, v226, v66
    v_add_f32 v227, v227, v67
    v_mfma_f32_16x16x32_bf16 v[176:179], a[200:203], a[240:243], v[176:179]
    s_xor_b32 s16, s92, 33
    s_mul_i32 s80, s16, 40960
    s_add_u32 s80, s80, s60
    s_lshl_b32 s80, s80, 1
    v_mfma_f32_16x16x32_bf16 v[180:183], a[204:207], a[240:243], v[180:183]
    buffer_load_dwordx4 v[124:127], v4, s[24:27], s19 offen offset:3072 sc1
    v_mfma_f32_16x16x32_bf16 v[184:187], a[208:211], a[240:243], v[184:187]
    s_waitcnt vmcnt(8)
    v_xor_b32 v228, s66, v228
    v_xor_b32 v229, s67, v229
    v_mfma_f32_16x16x32_bf16 v[188:191], a[212:215], a[240:243], v[188:191]
    v_xor_b32 v230, s68, v230
    v_xor_b32 v231, s69, v231
    v_mfma_f32_16x16x32_bf16 v[192:195], a[216:219], a[240:243], v[192:195]
    v_xor_b32 v240, s66, v240
    v_xor_b32 v241, s67, v241
    v_mfma_f32_16x16x32_bf16 v[176:179], a[220:223], a[248:251], v[176:179]
    s_add_u32 s19, s19, 4096
    buffer_load_dwordx4 v[128:131], v2, s[24:27], s19 offen offset:0 sc1
    v_mfma_f32_16x16x32_bf16 v[180:183], a[224:227], a[248:251], v[180:183]
    v_xor_b32 v242, s68, v242
    v_xor_b32 v243, s69, v243
    v_mfma_f32_16x16x32_bf16 v[184:187], a[228:231], a[248:251], v[184:187]
    v_xor_b32 v72, s66, v72
    v_xor_b32 v73, s67, v73
    v_mfma_f32_16x16x32_bf16 v[188:191], a[232:235], a[248:251], v[188:191]
    buffer_load_dwordx4 v[132:135], v4, s[24:27], s19 offen offset:0 sc1
    v_mfma_f32_16x16x32_bf16 v[192:195], a[236:239], a[248:251], v[192:195]
    v_xor_b32 v74, s68, v74
    v_xor_b32 v75, s69, v75
    v_mfma_f32_16x16x32_bf16 v[196:199], a[160:163], v[164:167], v[196:199]
    v_or3_b32 v92, v228, v229, v230
    v_or3_b32 v92, v92, v231, v240
    v_mfma_f32_16x16x32_bf16 v[200:203], a[164:167], v[164:167], v[200:203]
    buffer_load_dwordx4 v[136:139], v2, s[24:27], s19 offen offset:1024 sc1
    v_mfma_f32_16x16x32_bf16 v[204:207], a[168:171], v[164:167], v[204:207]
    v_or3_b32 v92, v92, v241, v242
    v_or3_b32 v92, v92, v243, v72
    v_mfma_f32_16x16x32_bf16 v[208:211], a[172:175], v[164:167], v[208:211]
    ds_write_b128 v8, v[176:179] offset:0
    v_mfma_f32_16x16x32_bf16 v[212:215], a[176:179], v[164:167], v[212:215]
    v_or3_b32 v92, v92, v73, v74
    v_or_b32 v92, v92, v75
    v_mfma_f32_16x16x32_bf16 v[196:199], a[180:183], v[172:175], v[196:199]
    buffer_load_dwordx4 v[140:143], v4, s[24:27], s19 offen offset:1024 sc1
    v_and_b32 v92, v92, v5
    v_mfma_f32_16x16x32_bf16 v[200:203], a[184:187], v[172:175], v[200:203]
    v_cmp_ne_u32 vcc, 0, v92
    s_cbranch_vccnz Lpps_46
Lppb_47:
    v_mfma_f32_16x16x32_bf16 v[204:207], a[188:191], v[172:175], v[204:207]
    ds_write_b128 v9, v[180:183] offset:1024
    v_mfma_f32_16x16x32_bf16 v[208:211], a[192:195], v[172:175], v[208:211]
    buffer_load_dwordx4 v[144:147], v2, s[24:27], s19 offen offset:2048 sc1
    v_add_f32 v216, v216, v228
    v_mfma_f32_16x16x32_bf16 v[212:215], a[196:199], v[172:175], v[212:215]
    v_add_f32 v217, v217, v229
    v_add_f32 v218, v218, v230
    v_mfma_f32_16x16x32_bf16 v[196:199], a[200:203], a[244:247], v[196:199]
    v_add_f32 v219, v219, v231
    v_add_f32 v220, v220, v240
    v_mfma_f32_16x16x32_bf16 v[200:203], a[204:207], a[244:247], v[200:203]
    ds_write_b128 v10, v[184:187] offset:2048
    v_mfma_f32_16x16x32_bf16 v[204:207], a[208:211], a[244:247], v[204:207]
    buffer_load_dwordx4 v[148:151], v4, s[24:27], s19 offen offset:2048 sc1
    v_add_f32 v221, v221, v241
    v_mfma_f32_16x16x32_bf16 v[208:211], a[212:215], a[244:247], v[208:211]
    v_add_f32 v222, v222, v242
    v_add_f32 v223, v223, v243
    v_mfma_f32_16x16x32_bf16 v[212:215], a[216:219], a[244:247], v[212:215]
    buffer_load_dwordx4 v[152:155], v2, s[24:27], s19 offen offset:3072 sc1
    v_add_f32 v224, v224, v72
    v_mfma_f32_16x16x32_bf16 v[196:199], a[220:223], a[252:255], v[196:199]
    ds_write_b128 v11, v[188:191] offset:3072
    v_mfma_f32_16x16x32_bf16 v[200:203], a[224:227], a[252:255], v[200:203]
    v_add_f32 v225, v225, v73
    v_add_f32 v226, v226, v74
    v_mfma_f32_16x16x32_bf16 v[204:207], a[228:231], a[252:255], v[204:207]
    v_add_f32 v227, v227, v75
    s_xor_b32 s66, s66, 0xff
    v_mfma_f32_16x16x32_bf16 v[208:211], a[232:235], a[252:255], v[208:211]
    s_xor_b32 s67, s67, 0xff
    s_xor_b32 s68, s68, 0xff
    buffer_load_dwordx4 v[156:159], v4, s[24:27], s19 offen offset:3072 sc1
    v_mfma_f32_16x16x32_bf16 v[212:215], a[236:239], a[252:255], v[212:215]
    s_xor_b32 s69, s69, 0xff
    ds_write_b128 v8, v[192:195] offset:4096
    s_waitcnt vmcnt(12)
    v_mfma_f32_16x16x32_bf16 v[16:19], a[0:3], v[96:99], 0
    v_mfma_f32_16x16x32_bf16 v[20:23], a[4:7], v[96:99], 0
    s_add_u32 s19, s19, 4096
    buffer_load_dwordx4 v[160:163], v2, s[24:27], s19 offen offset:0 sc1
    v_mfma_f32_16x16x32_bf16 v[24:27], a[8:11], v[96:99], 0
    v_mfma_f32_16x16x32_bf16 v[28:31], a[12:15], v[96:99], 0
    ds_write_b128 v8, v[196:199] offset:5120
    v_mfma_f32_16x16x32_bf16 v[32:35], a[16:19], v[96:99], 0
    buffer_load_dwordx4 v[164:167], v4, s[24:27], s19 offen offset:0 sc1
    v_mfma_f32_16x16x32_bf16 v[36:39], a[0:3], v[100:103], 0
    ds_write_b128 v9, v[200:203] offset:6144
    v_mfma_f32_16x16x32_bf16 v[40:43], a[4:7], v[100:103], 0
    buffer_load_dwordx4 v[168:171], v2, s[24:27], s19 offen offset:1024 sc1
    v_mfma_f32_16x16x32_bf16 v[44:47], a[8:11], v[100:103], 0
    ds_write_b128 v10, v[204:207] offset:7168
    v_mfma_f32_16x16x32_bf16 v[48:51], a[12:15], v[100:103], 0
    buffer_load_dwordx4 v[172:175], v4, s[24:27], s19 offen offset:1024 sc1
    v_mfma_f32_16x16x32_bf16 v[52:55], a[16:19], v[100:103], 0
    ds_write_b128 v11, v[208:211] offset:8192
    v_mfma_f32_16x16x32_bf16 v[16:19], a[20:23], v[104:107], v[16:19]
    s_add_u32 s19, s11, s100
    buffer_load_dwordx4 a[240:243], v2, s[24:27], s19 offen offset:0 sc1
    v_mfma_f32_16x16x32_bf16 v[20:23], a[24:27], v[104:107], v[20:23]
    ds_write_b128 v8, v[212:215] offset:9216
    v_mfma_f32_16x16x32_bf16 v[24:27], a[28:31], v[104:107], v[24:27]
    v_mfma_f32_16x16x32_bf16 v[28:31], a[32:35], v[104:107], v[28:31]
    s_waitcnt lgkmcnt(0)
    s_barrier
    buffer_load_dwordx4 a[244:247], v4, s[24:27], s19 offen offset:0 sc1
    v_mfma_f32_16x16x32_bf16 v[32:35], a[36:39], v[104:107], v[32:35]
    ds_read_b128 v[176:179], v246 offset:0
    ds_read_b128 v[180:183], v246 offset:10240
    ds_read_b128 v[184:187], v246 offset:20480
    v_mfma_f32_16x16x32_bf16 v[36:39], a[20:23], v[108:111], v[36:39]
    ds_read_b128 v[188:191], v246 offset:30720
    ds_read_b128 v[192:195], v247 offset:0
    ds_read_b128 v[196:199], v247 offset:10240
    v_mfma_f32_16x16x32_bf16 v[40:43], a[24:27], v[108:111], v[40:43]
    s_add_u32 s19, s11, s101
    buffer_load_dwordx4 a[248:251], v2, s[24:27], s19 offen offset:0 sc1
    v_mfma_f32_16x16x32_bf16 v[44:47], a[28:31], v[108:111], v[44:47]
    ds_read_b128 v[200:203], v247 offset:20480
    ds_read_b128 v[204:207], v247 offset:30720
    ds_read_b128 v[56:59], v248 offset:0
    v_mfma_f32_16x16x32_bf16 v[48:51], a[32:35], v[108:111], v[48:51]
    buffer_load_dwordx4 a[252:255], v4, s[24:27], s19 offen offset:0 sc1
    v_mfma_f32_16x16x32_bf16 v[52:55], a[36:39], v[108:111], v[52:55]
    ds_read_b128 v[60:63], v248 offset:10240
    ds_read_b128 v[64:67], v248 offset:20480
    ds_read_b128 v[68:71], v248 offset:30720
    s_waitcnt vmcnt(16)
    v_mfma_f32_16x16x32_bf16 v[16:19], a[40:43], v[112:115], v[16:19]
    s_waitcnt lgkmcnt(8)
    v_add_f32 v176, v176, v180
    v_add_f32 v184, v184, v188
    v_mfma_f32_16x16x32_bf16 v[20:23], a[44:47], v[112:115], v[20:23]
    v_add_f32 v177, v177, v181
    v_add_f32 v185, v185, v189
    v_mfma_f32_16x16x32_bf16 v[24:27], a[48:51], v[112:115], v[24:27]
    v_add_f32 v178, v178, v182
    v_add_f32 v186, v186, v190
    v_mfma_f32_16x16x32_bf16 v[28:31], a[52:55], v[112:115], v[28:31]
    v_add_f32 v179, v179, v183
    v_add_f32 v187, v187, v191
    v_mfma_f32_16x16x32_bf16 v[32:35], a[56:59], v[112:115], v[32:35]
    v_add_f32 v80, v80, v176
    v_add_f32 v81, v81, v177
    v_mfma_f32_16x16x32_bf16 v[36:39], a[40:43], v[116:119], v[36:39]
    v_add_f32 v82, v82, v178
    v_add_f32 v83, v83, v179
    v_mfma_f32_16x16x32_bf16 v[40:43], a[44:47], v[116:119], v[40:43]
    v_add_f32 v80, v80, v184
    v_add_f32 v81, v81, v185
    v_add_f32 v82, v82, v186
    v_mfma_f32_16x16x32_bf16 v[44:47], a[48:51], v[116:119], v[44:47]
    v_add_f32 v83, v83, v187
    v_bfi_b32 v80, v5, s66, v80
    v_mfma_f32_16x16x32_bf16 v[48:51], a[52:55], v[116:119], v[48:51]
    v_bfi_b32 v81, v5, s67, v81
    v_bfi_b32 v82, v5, s68, v82
    v_bfi_b32 v83, v5, s69, v83
    v_mfma_f32_16x16x32_bf16 v[52:55], a[56:59], v[116:119], v[52:55]
    buffer_store_dwordx4 v[80:83], v2, s[44:47], s77 offen sc1
    v_mfma_f32_16x16x32_bf16 v[16:19], a[60:63], v[120:123], v[16:19]
    s_waitcnt lgkmcnt(4)
    v_add_f32 v192, v192, v196
    v_add_f32 v200, v200, v204
    v_mfma_f32_16x16x32_bf16 v[20:23], a[64:67], v[120:123], v[20:23]
    v_add_f32 v193, v193, v197
    v_add_f32 v201, v201, v205
    v_mfma_f32_16x16x32_bf16 v[24:27], a[68:71], v[120:123], v[24:27]
    v_add_f32 v194, v194, v198
    v_add_f32 v202, v202, v206
    v_mfma_f32_16x16x32_bf16 v[28:31], a[72:75], v[120:123], v[28:31]
    v_add_f32 v195, v195, v199
    v_add_f32 v203, v203, v207
    v_mfma_f32_16x16x32_bf16 v[32:35], a[76:79], v[120:123], v[32:35]
    v_add_f32 v84, v84, v192
    v_add_f32 v85, v85, v193
    v_mfma_f32_16x16x32_bf16 v[36:39], a[60:63], v[124:127], v[36:39]
    v_add_f32 v86, v86, v194
    v_add_f32 v87, v87, v195
    v_mfma_f32_16x16x32_bf16 v[40:43], a[64:67], v[124:127], v[40:43]
    v_add_f32 v84, v84, v200
    v_add_f32 v85, v85, v201
    v_add_f32 v86, v86, v202
    v_mfma_f32_16x16x32_bf16 v[44:47], a[68:71], v[124:127], v[44:47]
    v_add_f32 v87, v87, v203
    v_bfi_b32 v84, v5, s66, v84
    v_mfma_f32_16x16x32_bf16 v[48:51], a[72:75], v[124:127], v[48:51]
    v_bfi_b32 v85, v5, s67, v85
    v_bfi_b32 v86, v5, s68, v86
    v_bfi_b32 v87, v5, s69, v87
    v_mfma_f32_16x16x32_bf16 v[52:55], a[76:79], v[124:127], v[52:55]
    buffer_store_dwordx4 v[84:87], v2, s[44:47], s77 offen offset:1024 sc1
    s_waitcnt vmcnt(14)
    v_mfma_f32_16x16x32_bf16 v[16:19], a[80:83], v[128:131], v[16:19]
    s_waitcnt lgkmcnt(0)
    v_add_f32 v56, v56, v60
    v_add_f32 v64, v64, v68
    v_mfma_f32_16x16x32_bf16 v[20:23], a[84:87], v[128:131], v[20:23]
    v_add_f32 v57, v57, v61
    v_add_f32 v65, v65, v69
    v_mfma_f32_16x16x32_bf16 v[24:27], a[88:91], v[128:131], v[24:27]
    v_add_f32 v58, v58, v62
    v_add_f32 v66, v66, v70
    v_mfma_f32_16x16x32_bf16 v[28:31], a[92:95], v[128:131], v[28:31]
    v_add_f32 v59, v59, v63
    v_add_f32 v67, v67, v71
    v_mfma_f32_16x16x32_bf16 v[32:35], a[96:99], v[128:131], v[32:35]
    v_add_f32 v88, v88, v56
    v_add_f32 v89, v89, v57
    v_mfma_f32_16x16x32_bf16 v[36:39], a[80:83], v[132:135], v[36:39]
    v_add_f32 v90, v90, v58
    v_add_f32 v91, v91, v59
    v_mfma_f32_16x16x32_bf16 v[40:43], a[84:87], v[132:135], v[40:43]
    v_add_f32 v88, v88, v64
    v_add_f32 v89, v89, v65
    v_mfma_f32_16x16x32_bf16 v[44:47], a[88:91], v[132:135], v[44:47]
    v_add_f32 v90, v90, v66
    v_add_f32 v91, v91, v67
    v_mfma_f32_16x16x32_bf16 v[48:51], a[92:95], v[132:135], v[48:51]
    v_bfi_b32 v88, v5, s66, v88
    v_mfma_f32_16x16x32_bf16 v[52:55], a[96:99], v[132:135], v[52:55]
    v_bfi_b32 v89, v5, s67, v89
    v_mfma_f32_16x16x32_bf16 v[16:19], a[100:103], v[136:139], v[16:19]
    v_bfi_b32 v90, v5, s68, v90
    v_bfi_b32 v91, v5, s69, v91
    v_mfma_f32_16x16x32_bf16 v[20:23], a[104:107], v[136:139], v[20:23]
    buffer_store_dwordx4 v[88:91], v3, s[44:47], s77 offen offset:2048 sc1
    v_mfma_f32_16x16x32_bf16 v[24:27], a[108:111], v[136:139], v[24:27]
    v_add_u32 v246, 0xa000, v246
    v_add_u32 v247, 0xa000, v247
    v_mfma_f32_16x16x32_bf16 v[28:31], a[112:115], v[136:139], v[28:31]
    v_add_u32 v248, 0xa000, v248
    v_lshlrev_b32 v92, 1, v249
    v_mfma_f32_16x16x32_bf16 v[32:35], a[116:119], v[136:139], v[32:35]
    v_lshlrev_b32 v93, 1, v250
    v_lshlrev_b32 v94, 1, v251
    v_mfma_f32_16x16x32_bf16 v[36:39], a[100:103], v[140:143], v[36:39]
    v_mfma_f32_16x16x32_bf16 v[40:43], a[104:107], v[140:143], v[40:43]
    buffer_store_dwordx4 v[216:219], v92, s[36:39], s78 offen sc1
    v_mfma_f32_16x16x32_bf16 v[44:47], a[108:111], v[140:143], v[44:47]
    v_mfma_f32_16x16x32_bf16 v[48:51], a[112:115], v[140:143], v[48:51]
    v_mfma_f32_16x16x32_bf16 v[52:55], a[116:119], v[140:143], v[52:55]
    s_waitcnt vmcnt(12)
    v_mfma_f32_16x16x32_bf16 v[16:19], a[120:123], v[144:147], v[16:19]
    buffer_store_dwordx4 v[220:223], v93, s[36:39], s78 offen sc1
    v_mfma_f32_16x16x32_bf16 v[20:23], a[124:127], v[144:147], v[20:23]
    v_mfma_f32_16x16x32_bf16 v[24:27], a[128:131], v[144:147], v[24:27]
    v_mfma_f32_16x16x32_bf16 v[28:31], a[132:135], v[144:147], v[28:31]
    v_mfma_f32_16x16x32_bf16 v[32:35], a[136:139], v[144:147], v[32:35]
    buffer_store_dwordx4 v[224:227], v94, s[36:39], s78 offen sc1
    v_mfma_f32_16x16x32_bf16 v[36:39], a[120:123], v[148:151], v[36:39]
    v_mfma_f32_16x16x32_bf16 v[40:43], a[124:127], v[148:151], v[40:43]
    v_mfma_f32_16x16x32_bf16 v[44:47], a[128:131], v[148:151], v[44:47]
    v_mfma_f32_16x16x32_bf16 v[48:51], a[132:135], v[148:151], v[48:51]
    v_mfma_f32_16x16x32_bf16 v[52:55], a[136:139], v[148:151], v[52:55]
    v_mfma_f32_16x16x32_bf16 v[16:19], a[140:143], v[152:155], v[16:19]
    v_mfma_f32_16x16x32_bf16 v[20:23], a[144:147], v[152:155], v[20:23]
    v_mfma_f32_16x16x32_bf16 v[24:27], a[148:151], v[152:155], v[24:27]
    v_mfma_f32_16x16x32_bf16 v[28:31], a[152:155], v[152:155], v[28:31]
    v_mfma_f32_16x16x32_bf16 v[32:35], a[156:159], v[152:155], v[32:35]
    v_mfma_f32_16x16x32_bf16 v[36:39], a[140:143], v[156:159], v[36:39]
    v_mfma_f32_16x16x32_bf16 v[40:43], a[144:147], v[156:159], v[40:43]
    v_mfma_f32_16x16x32_bf16 v[44:47], a[148:151], v[156:159], v[44:47]
    v_mfma_f32_16x16x32_bf16 v[48:51], a[152:155], v[156:159], v[48:51]
    v_mfma_f32_16x16x32_bf16 v[52:55], a[156:159], v[156:159], v[52:55]
    s_waitcnt vmcnt(6)
    v_mfma_f32_16x16x32_bf16 v[16:19], a[160:163], v[160:163], v[16:19]
    v_mfma_f32_16x16x32_bf16 v[20:23], a[164:167], v[160:163], v[20:23]
    v_mfma_f32_16x16x32_bf16 v[24:27], a[168:171], v[160:163], v[24:27]
    v_mfma_f32_16x16x32_bf16 v[28:31], a[172:175], v[160:163], v[28:31]
    v_mfma_f32_16x16x32_bf16 v[32:35], a[176:179], v[160:163], v[32:35]
    v_mfma_f32_16x16x32_bf16 v[16:19], a[180:183], v[168:171], v[16:19]
    v_mfma_f32_16x16x32_bf16 v[20:23], a[184:187], v[168:171], v[20:23]
    v_mfma_f32_16x16x32_bf16 v[24:27], a[188:191], v[168:171], v[24:27]
    v_mfma_f32_16x16x32_bf16 v[28:31], a[192:195], v[168:171], v[28:31]
    v_mfma_f32_16x16x32_bf16 v[32:35], a[196:199], v[168:171], v[32:35]
    v_mfma_f32_16x16x32_bf16 v[16:19], a[200:203], a[240:243], v[16:19]
    v_mfma_f32_16x16x32_bf16 v[20:23], a[204:207], a[240:243], v[20:23]
    v_mfma_f32_16x16x32_bf16 v[24:27], a[208:211], a[240:243], v[24:27]
    v_mfma_f32_16x16x32_bf16 v[28:31], a[212:215], a[240:243], v[28:31]
    v_mfma_f32_16x16x32_bf16 v[32:35], a[216:219], a[240:243], v[32:35]
    v_mfma_f32_16x16x32_bf16 v[16:19], a[220:223], a[248:251], v[16:19]
    v_mfma_f32_16x16x32_bf16 v[20:23], a[224:227], a[248:251], v[20:23]
    v_mfma_f32_16x16x32_bf16 v[24:27], a[228:231], a[248:251], v[24:27]
    v_mfma_f32_16x16x32_bf16 v[28:31], a[232:235], a[248:251], v[28:31]
    v_mfma_f32_16x16x32_bf16 v[32:35], a[236:239], a[248:251], v[32:35]
    v_mfma_f32_16x16x32_bf16 v[36:39], a[160:163], v[164:167], v[36:39]
    v_mfma_f32_16x16x32_bf16 v[40:43], a[164:167], v[164:167], v[40:43]
    v_mfma_f32_16x16x32_bf16 v[44:47], a[168:171], v[164:167], v[44:47]
    v_mfma_f32_16x16x32_bf16 v[48:51], a[172:175], v[164:167], v[48:51]
    ds_write_b128 v8, v[16:19] offset:40960
    v_mfma_f32_16x16x32_bf16 v[52:55], a[176:179], v[164:167], v[52:55]
    v_mfma_f32_16x16x32_bf16 v[36:39], a[180:183], v[172:175], v[36:39]
    v_mfma_f32_16x16x32_bf16 v[40:43], a[184:187], v[172:175], v[40:43]
    buffer_load_dwordx4 v[56:59], v2, s[44:47], s76 offen sc1
    v_mfma_f32_16x16x32_bf16 v[44:47], a[188:191], v[172:175], v[44:47]
    ds_write_b128 v9, v[20:23] offset:41984
    v_mfma_f32_16x16x32_bf16 v[48:51], a[192:195], v[172:175], v[48:51]
    buffer_load_dwordx4 v[60:63], v2, s[44:47], s76 offen offset:1024 sc1
    v_mfma_f32_16x16x32_bf16 v[52:55], a[196:199], v[172:175], v[52:55]
    v_mfma_f32_16x16x32_bf16 v[36:39], a[200:203], a[244:247], v[36:39]
    buffer_load_dwordx4 v[64:67], v12, s[44:47], s76 offen offset:2048 sc1
    v_mfma_f32_16x16x32_bf16 v[40:43], a[204:207], a[244:247], v[40:43]
    ds_write_b128 v10, v[24:27] offset:43008
    v_mfma_f32_16x16x32_bf16 v[44:47], a[208:211], a[244:247], v[44:47]
    v_mfma_f32_16x16x32_bf16 v[48:51], a[212:215], a[244:247], v[48:51]
    v_mfma_f32_16x16x32_bf16 v[52:55], a[216:219], a[244:247], v[52:55]
    v_mfma_f32_16x16x32_bf16 v[36:39], a[220:223], a[252:255], v[36:39]
    ds_write_b128 v11, v[28:31] offset:44032
    v_mfma_f32_16x16x32_bf16 v[40:43], a[224:227], a[252:255], v[40:43]
    v_mfma_f32_16x16x32_bf16 v[44:47], a[228:231], a[252:255], v[44:47]
    v_mfma_f32_16x16x32_bf16 v[48:51], a[232:235], a[252:255], v[48:51]
    v_mfma_f32_16x16x32_bf16 v[52:55], a[236:239], a[252:255], v[52:55]
    ds_write_b128 v8, v[32:35] offset:45056
    s_nop 1
    ds_write_b128 v8, v[36:39] offset:46080
    s_nop 0
    ds_write_b128 v9, v[40:43] offset:47104
    ds_write_b128 v10, v[44:47] offset:48128
    ds_write_b128 v11, v[48:51] offset:49152
    ds_write_b128 v8, v[52:55] offset:50176
    s_waitcnt lgkmcnt(0)
    s_barrier
    ds_read_b128 v[96:99], v246 offset:0
L_hk8304:
    s_cbranch_execz L_hback
    ds_read_b128 v[100:103], v246 offset:10240
    ds_read_b128 v[104:107], v246 offset:20480
    ds_read_b128 v[108:111], v246 offset:30720
    ds_read_b128 v[112:115], v247 offset:0
    ds_read_b128 v[116:119], v247 offset:10240
    ds_read_b128 v[120:123], v247 offset:20480
    ds_read_b128 v[124:127], v247 offset:30720
    ds_read_b128 v[128:131], v248 offset:0
    ds_read_b128 v[132:135], v248 offset:10240
    ds_read_b128 v[136:139], v248 offset:20480
    ds_read_b128 v[140:143], v248 offset:30720
    s_waitcnt vmcnt(0)
    v_xor_b32 v56, s66, v56
    v_xor_b32 v57, s67, v57
    v_xor_b32 v58, s68, v58
    v_xor_b32 v59, s69, v59
    v_xor_b32 v60, s66, v60
    v_xor_b32 v61, s67, v61
    v_xor_b32 v62, s68, v62
    v_xor_b32 v63, s69, v63
    v_xor_b32 v64, s66, v64
    v_xor_b32 v65, s67, v65
    v_xor_b32 v66, s68, v66
    v_xor_b32 v67, s69, v67
    v_or3_b32 v92, v56, v57, v58
    v_or3_b32 v92, v92, v59, v60
    v_or3_b32 v92, v92, v61, v62
    v_or3_b32 v92, v92, v63, v64
    v_or3_b32 v92, v92, v65, v66
    v_or_b32 v92, v92, v67
    v_and_b32 v92, v92, v5
    v_cmp_ne_u32 vcc, 0, v92
    s_cbranch_vccnz Lpps_48
Lppb_49:
    s_waitcnt lgkmcnt(8)
    v_pk_add_f32 v[96:97], v[96:97], v[100:101]
    v_pk_add_f32 v[104:105], v[104:105], v[108:109]
    v_pk_add_f32 v[98:99], v[98:99], v[102:103]
    v_pk_add_f32 v[106:107], v[106:107], v[110:111]
    v_pk_add_f32 v[56:57], v[56:57], v[96:97]
    v_pk_add_f32 v[58:59], v[58:59], v[98:99]
    v_pk_add_f32 v[56:57], v[56:57], v[104:105]
    v_pk_add_f32 v[58:59], v[58:59], v[106:107]
    v_lshlrev_b32 v93, 1, v249
    buffer_store_dwordx4 v[56:59], v93, s[36:39], s80 offen sc1
    s_waitcnt lgkmcnt(4)
    v_pk_add_f32 v[112:113], v[112:113], v[116:117]
    v_pk_add_f32 v[120:121], v[120:121], v[124:125]
    v_pk_add_f32 v[114:115], v[114:115], v[118:119]
    v_pk_add_f32 v[122:123], v[122:123], v[126:127]
    v_pk_add_f32 v[60:61], v[60:61], v[112:113]
    v_pk_add_f32 v[62:63], v[62:63], v[114:115]
    v_pk_add_f32 v[60:61], v[60:61], v[120:121]
    v_pk_add_f32 v[62:63], v[62:63], v[122:123]
    v_lshlrev_b32 v94, 1, v250
    buffer_store_dwordx4 v[60:63], v94, s[36:39], s80 offen sc1
    s_waitcnt lgkmcnt(0)
    v_pk_add_f32 v[128:129], v[128:129], v[132:133]
    v_pk_add_f32 v[136:137], v[136:137], v[140:141]
    v_pk_add_f32 v[130:131], v[130:131], v[134:135]
    v_pk_add_f32 v[138:139], v[138:139], v[142:143]
    v_pk_add_f32 v[64:65], v[64:65], v[128:129]
    v_pk_add_f32 v[66:67], v[66:67], v[130:131]
    v_pk_add_f32 v[64:65], v[64:65], v[136:137]
    v_pk_add_f32 v[66:67], v[66:67], v[138:139]
    v_lshlrev_b32 v95, 1, v251
    buffer_store_dwordx4 v[64:67], v95, s[36:39], s80 offen sc1
    s_endpgm
Lgrs_2:
    s_mov_b32 s13, 0
Lgrd_50:
    buffer_load_dwordx2 v[88:89], v90, s[28:31], 0 offen sc1
    buffer_load_dwordx2 v[92:93], v94, s[28:31], 0 offen sc1
    s_add_u32 s13, s13, 1
    s_waitcnt vmcnt(0)
    v_xor_b32 v72, v89, v13
    v_xor_b32 v73, v93, v13
    v_or_b32 v72, v72, v73
    v_cmp_ne_u32 vcc, 0, v72
    s_cmp_ge_u32 s13, 131072
    s_cbranch_scc1 Lgrdo_51
    s_cbranch_vccnz Lgrd_50
Lgrdo_51:
    s_branch Lgrb_3
Lf6s_4:
    s_mov_b32 s13, 0
Lf6d_52:
    buffer_load_dword v6, v7, s[28:31], s51 offen sc1
    s_add_u32 s13, s13, 1
    s_waitcnt vmcnt(0)
    v_cmp_ne_u32 vcc, v6, v13
    s_cmp_ge_u32 s13, 131072
    s_cbranch_scc1 Lf6do_53
    s_cbranch_vccnz Lf6d_52
Lf6do_53:
    s_branch Lf6b_5
Lq0s_6:
    s_mov_b32 s13, 0
Lq0d_54:
    buffer_load_dword v6, v7, s[28:31], s87 offen sc1
    s_add_u32 s13, s13, 1
    s_waitcnt vmcnt(0)
    v_cmp_ne_u32 vcc, v6, v13
    s_cmp_ge_u32 s13, 131072
    s_cbranch_scc1 Lq0do_55
    s_cbranch_vccnz Lq0d_54
Lq0do_55:
    s_branch Lq0b_7
Lq0s_8:
    s_mov_b32 s13, 0
Lq0d_56:
    buffer_load_dword v6, v7, s[28:31], s87 offen sc1
    s_add_u32 s13, s13, 1
    s_waitcnt vmcnt(0)
    v_cmp_ne_u32 vcc, v6, v13
    s_cmp_ge_u32 s13, 131072
    s_cbranch_scc1 Lq0do_57
    s_cbranch_vccnz Lq0d_56
Lq0do_57:
    s_branch Lq0b_9
Lgrss_10:
    s_mov_b32 s13, 0
Lgrsd_58:
    buffer_load_dwordx2 v[28:29], v30, s[28:31], 0 offen sc1
    s_add_u32 s13, s13, 1
    s_waitcnt vmcnt(0)
    v_cmp_ne_u32 vcc, v29, v13
    s_cmp_ge_u32 s13, 131072
    s_cbranch_scc1 Lgrsdo_59
    s_cbranch_vccnz Lgrsd_58
Lgrsdo_59:
    s_branch Lgrsb_11
Laggs_12:
    s_mov_b32 s13, 0
Laggd_60:
    buffer_load_dwordx2 v[88:89], v170, s[44:47], s73 offen offset:0 sc1
    buffer_load_dwordx2 v[90:91], v170, s[44:47], s73 offen offset:256 sc1
    buffer_load_dwordx2 v[92:93], v170, s[44:47], s73 offen offset:512 sc1
    buffer_load_dwordx2 v[94:95], v170, s[44:47], s73 offen offset:768 sc1
    s_add_u32 s13, s13, 1
    s_waitcnt vmcnt(0)
    v_xor_b32 v89, v89, v13
    v_xor_b32 v91, v91, v13
    v_xor_b32 v93, v93, v13
    v_xor_b32 v95, v95, v13
    v_or3_b32 v89, v89, v91, v93
    v_or_b32 v89, v89, v95
    v_cmp_ne_u32 vcc, 0, v89
    s_cmp_ge_u32 s13, 131072
    s_cbranch_scc1 Laggdo_61
    s_cbranch_vccnz Laggd_60
Laggdo_61:
    s_branch Laggb_13
Lf6ss_14:
    s_mov_b32 s13, 0
Lf6sd_62:
    buffer_load_dword v6, v7, s[28:31], s51 offen sc1
    s_add_u32 s13, s13, 1
    s_waitcnt vmcnt(0)
    v_cmp_ne_u32 vcc, v6, v13
    s_cmp_ge_u32 s13, 131072
    s_cbranch_scc1 Lf6sdo_63
    s_cbranch_vccnz Lf6sd_62
Lf6sdo_63:
    s_branch Lf6sb_15
Laggs_16:
    s_mov_b32 s13, 0
Laggd_64:
    buffer_load_dwordx2 v[88:89], v170, s[44:47], s73 offen offset:2048 sc1
    buffer_load_dwordx2 v[90:91], v170, s[44:47], s73 offen offset:2304 sc1
    buffer_load_dwordx2 v[92:93], v170, s[44:47], s73 offen offset:2560 sc1
    buffer_load_dwordx2 v[94:95], v170, s[44:47], s73 offen offset:2816 sc1
    s_add_u32 s13, s13, 1
    s_waitcnt vmcnt(0)
    v_xor_b32 v89, v89, v13
    v_xor_b32 v91, v91, v13
    v_xor_b32 v93, v93, v13
    v_xor_b32 v95, v95, v13
    v_or3_b32 v89, v89, v91, v93
    v_or_b32 v89, v89, v95
    v_cmp_ne_u32 vcc, 0, v89
    s_cmp_ge_u32 s13, 131072
    s_cbranch_scc1 Laggdo_65
    s_cbranch_vccnz Laggd_64
Laggdo_65:
    s_branch Laggb_17
Laggs_18:
    s_mov_b32 s13, 0
Laggd_66:
    buffer_load_dwordx2 v[88:89], v170, s[44:47], s73 offen offset:0 sc1
    buffer_load_dwordx2 v[90:91], v170, s[44:47], s73 offen offset:256 sc1
    buffer_load_dwordx2 v[92:93], v170, s[44:47], s73 offen offset:512 sc1
    buffer_load_dwordx2 v[94:95], v170, s[44:47], s73 offen offset:768 sc1
    s_add_u32 s13, s13, 1
    s_waitcnt vmcnt(0)
    v_xor_b32 v89, v89, v13
    v_xor_b32 v91, v91, v13
    v_xor_b32 v93, v93, v13
    v_xor_b32 v95, v95, v13
    v_or3_b32 v89, v89, v91, v93
    v_or_b32 v89, v89, v95
    v_cmp_ne_u32 vcc, 0, v89
    s_cmp_ge_u32 s13, 131072
    s_cbranch_scc1 Laggdo_67
    s_cbranch_vccnz Laggd_66
Laggdo_67:
    s_branch Laggb_19
Laggs_20:
    s_mov_b32 s13, 0
Laggd_68:
    buffer_load_dwordx2 v[88:89], v170, s[44:47], s73 offen offset:2048 sc1
    buffer_load_dwordx2 v[90:91], v170, s[44:47], s73 offen offset:2304 sc1
    buffer_load_dwordx2 v[92:93], v170, s[44:47], s73 offen offset:2560 sc1
    buffer_load_dwordx2 v[94:95], v170, s[44:47], s73 offen offset:2816 sc1
    s_add_u32 s13, s13, 1
    s_waitcnt vmcnt(0)
    v_xor_b32 v89, v89, v13
    v_xor_b32 v91, v91, v13
    v_xor_b32 v93, v93, v13
    v_xor_b32 v95, v95, v13
    v_or3_b32 v89, v89, v91, v93
    v_or_b32 v89, v89, v95
    v_cmp_ne_u32 vcc, 0, v89
    s_cmp_ge_u32 s13, 131072
    s_cbranch_scc1 Laggdo_69
    s_cbranch_vccnz Laggd_68
Laggdo_69:
    s_branch Laggb_21
Laggs_22:
    s_mov_b32 s13, 0
Laggd_70:
    buffer_load_dwordx2 v[88:89], v170, s[44:47], s73 offen offset:0 sc1
    buffer_load_dwordx2 v[90:91], v170, s[44:47], s73 offen offset:256 sc1
    buffer_load_dwordx2 v[92:93], v170, s[44:47], s73 offen offset:512 sc1
    buffer_load_dwordx2 v[94:95], v170, s[44:47], s73 offen offset:768 sc1
    s_add_u32 s13, s13, 1
    s_waitcnt vmcnt(0)
    v_xor_b32 v89, v89, v13
    v_xor_b32 v91, v91, v13
    v_xor_b32 v93, v93, v13
    v_xor_b32 v95, v95, v13
    v_or3_b32 v89, v89, v91, v93
    v_or_b32 v89, v89, v95
    v_cmp_ne_u32 vcc, 0, v89
    s_cmp_ge_u32 s13, 131072
    s_cbranch_scc1 Laggdo_71
    s_cbranch_vccnz Laggd_70
Laggdo_71:
    s_branch Laggb_23
Laggs_24:
    s_mov_b32 s13, 0
Laggd_72:
    buffer_load_dwordx2 v[88:89], v170, s[44:47], s73 offen offset:2048 sc1
    buffer_load_dwordx2 v[90:91], v170, s[44:47], s73 offen offset:2304 sc1
    buffer_load_dwordx2 v[92:93], v170, s[44:47], s73 offen offset:2560 sc1
    buffer_load_dwordx2 v[94:95], v170, s[44:47], s73 offen offset:2816 sc1
    s_add_u32 s13, s13, 1
    s_waitcnt vmcnt(0)
    v_xor_b32 v89, v89, v13
    v_xor_b32 v91, v91, v13
    v_xor_b32 v93, v93, v13
    v_xor_b32 v95, v95, v13
    v_or3_b32 v89, v89, v91, v93
    v_or_b32 v89, v89, v95
    v_cmp_ne_u32 vcc, 0, v89
    s_cmp_ge_u32 s13, 131072
    s_cbranch_scc1 Laggdo_73
    s_cbranch_vccnz Laggd_72
Laggdo_73:
    s_branch Laggb_25
Lq0s_26:
    s_mov_b32 s13, 0
Lq0d_74:
    buffer_load_dword v6, v7, s[28:31], s87 offen sc1
    s_add_u32 s13, s13, 1
    s_waitcnt vmcnt(0)
    v_cmp_ne_u32 vcc, v6, v13
    s_cmp_ge_u32 s13, 131072
    s_cbranch_scc1 Lq0do_75
    s_cbranch_vccnz Lq0d_74
Lq0do_75:
    s_branch Lq0b_27
Laggs_28:
    s_mov_b32 s13, 0
Laggd_76:
    buffer_load_dwordx2 v[32:33], v170, s[44:47], s57 offen offset:0 sc1
    buffer_load_dwordx2 v[34:35], v170, s[44:47], s57 offen offset:256 sc1
    buffer_load_dwordx2 v[36:37], v170, s[44:47], s57 offen offset:512 sc1
    buffer_load_dwordx2 v[38:39], v170, s[44:47], s57 offen offset:768 sc1
    s_add_u32 s13, s13, 1
    s_waitcnt vmcnt(0)
    v_xor_b32 v33, v33, v13
    v_xor_b32 v35, v35, v13
    v_xor_b32 v37, v37, v13
    v_xor_b32 v39, v39, v13
    v_or3_b32 v33, v33, v35, v37
    v_or_b32 v33, v33, v39
    v_cmp_ne_u32 vcc, 0, v33
    s_cmp_ge_u32 s13, 131072
    s_cbranch_scc1 Laggdo_77
    s_cbranch_vccnz Laggd_76
Laggdo_77:
    s_branch Laggb_29
Laggs_30:
    s_mov_b32 s13, 0
Laggd_78:
    buffer_load_dwordx2 v[40:41], v170, s[44:47], s57 offen offset:2048 sc1
    buffer_load_dwordx2 v[42:43], v170, s[44:47], s57 offen offset:2304 sc1
    buffer_load_dwordx2 v[44:45], v170, s[44:47], s57 offen offset:2560 sc1
    buffer_load_dwordx2 v[46:47], v170, s[44:47], s57 offen offset:2816 sc1
    s_add_u32 s13, s13, 1
    s_waitcnt vmcnt(0)
    v_xor_b32 v41, v41, v13
    v_xor_b32 v43, v43, v13
    v_xor_b32 v45, v45, v13
    v_xor_b32 v47, v47, v13
    v_or3_b32 v41, v41, v43, v45
    v_or_b32 v41, v41, v47
    v_cmp_ne_u32 vcc, 0, v41
    s_cmp_ge_u32 s13, 131072
    s_cbranch_scc1 Laggdo_79
    s_cbranch_vccnz Laggd_78
Laggdo_79:
    s_branch Laggb_31
Lress_40:
    s_mov_b32 s13, 0
Lresd_80:
    buffer_load_dwordx2 v[240:241], v252, s[28:31], s81 offen sc1
    buffer_load_dwordx2 v[242:243], v253, s[28:31], s81 offen sc1
    buffer_load_dwordx2 v[244:245], v254, s[28:31], s81 offen sc1
    s_add_u32 s13, s13, 1
    s_waitcnt vmcnt(0)
    v_xor_b32 v92, v241, v13
    v_xor_b32 v93, v243, v13
    v_xor_b32 v94, v245, v13
    v_or3_b32 v92, v92, v93, v94
    v_cmp_ne_u32 vcc, 0, v92
    s_cmp_ge_u32 s13, 131072
    s_cbranch_scc1 Lresdo_81
    s_cbranch_vccnz Lresd_80
Lresdo_81:
    s_branch Lresb_41
Lq2s_42:
    s_mov_b32 s13, 0
Lq2d_82:
    buffer_load_dword v6, v7, s[28:31], s87 offen sc1
    s_add_u32 s13, s13, 1
    s_waitcnt vmcnt(0)
    v_cmp_ne_u32 vcc, v6, v13
    s_cmp_ge_u32 s13, 131072
    s_cbranch_scc1 Lq2do_83
    s_cbranch_vccnz Lq2d_82
Lq2do_83:
    s_branch Lq2b_43
Lress_44:
    s_mov_b32 s13, 0
Lresd_84:
    buffer_load_dwordx2 v[62:63], v252, s[28:31], s61 offen sc1
    buffer_load_dwordx2 v[64:65], v253, s[28:31], s61 offen sc1
    buffer_load_dwordx2 v[66:67], v254, s[28:31], s61 offen sc1
    s_add_u32 s13, s13, 1
    s_waitcnt vmcnt(0)
    v_xor_b32 v92, v63, v13
    v_xor_b32 v93, v65, v13
    v_xor_b32 v94, v67, v13
    v_or3_b32 v92, v92, v93, v94
    v_cmp_ne_u32 vcc, 0, v92
    s_cmp_ge_u32 s13, 131072
    s_cbranch_scc1 Lresdo_85
    s_cbranch_vccnz Lresd_84
Lresdo_85:
    s_branch Lresb_45
Lpps_46:
    s_mov_b32 s13, 0
Lppd_86:
    buffer_load_dwordx4 v[228:231], v2, s[44:47], s77 offen sc1
    buffer_load_dwordx4 v[240:243], v2, s[44:47], s77 offen offset:1024 sc1
    buffer_load_dwordx4 v[72:75], v12, s[44:47], s77 offen offset:2048 sc1
    s_add_u32 s13, s13, 1
    s_waitcnt vmcnt(0)
    v_xor_b32 v228, s66, v228
    v_xor_b32 v229, s67, v229
    v_xor_b32 v230, s68, v230
    v_xor_b32 v231, s69, v231
    v_xor_b32 v240, s66, v240
    v_xor_b32 v241, s67, v241
    v_xor_b32 v242, s68, v242
    v_xor_b32 v243, s69, v243
    v_xor_b32 v72, s66, v72
    v_xor_b32 v73, s67, v73
    v_xor_b32 v74, s68, v74
    v_xor_b32 v75, s69, v75
    v_or3_b32 v92, v228, v229, v230
    v_or3_b32 v92, v92, v231, v240
    v_or3_b32 v92, v92, v241, v242
    v_or3_b32 v92, v92, v243, v72
    v_or3_b32 v92, v92, v73, v74
    v_or_b32 v92, v92, v75
    v_and_b32 v92, v92, v5
    v_cmp_ne_u32 vcc, 0, v92
    s_cmp_ge_u32 s13, 131072
    s_cbranch_scc1 Lppdo_87
    s_cbranch_vccnz Lppd_86
Lppdo_87:
    s_branch Lppb_47
Lpps_48:
    s_mov_b32 s13, 0
Lppd_88:
    buffer_load_dwordx4 v[56:59], v2, s[44:47], s76 offen sc1
    buffer_load_dwordx4 v[60:63], v2, s[44:47], s76 offen offset:1024 sc1
    buffer_load_dwordx4 v[64:67], v12, s[44:47], s76 offen offset:2048 sc1
    s_add_u32 s13, s13, 1
    s_waitcnt vmcnt(0)
    v_xor_b32 v56, s66, v56
    v_xor_b32 v57, s67, v57
    v_xor_b32 v58, s68, v58
    v_xor_b32 v59, s69, v59
    v_xor_b32 v60, s66, v60
    v_xor_b32 v61, s67, v61
    v_xor_b32 v62, s68, v62
    v_xor_b32 v63, s69, v63
    v_xor_b32 v64, s66, v64
    v_xor_b32 v65, s67, v65
    v_xor_b32 v66, s68, v66
    v_xor_b32 v67, s69, v67
    v_or3_b32 v92, v56, v57, v58
    v_or3_b32 v92, v92, v59, v60
    v_or3_b32 v92, v92, v61, v62
    v_or3_b32 v92, v92, v63, v64
    v_or3_b32 v92, v92, v65, v66
    v_or_b32 v92, v92, v67
    v_and_b32 v92, v92, v5
    v_cmp_ne_u32 vcc, 0, v92
    s_cmp_ge_u32 s13, 131072
    s_cbranch_scc1 Lppdo_89
    s_cbranch_vccnz Lppd_88
Lppdo_89:
    s_branch Lppb_49
L_end:
    s_endpgm
.section .rodata,"a"
.p2align 6
.amdhsa_kernel parallel_sum__ssm_conv_s5__glu_gated_swiglu__prompt_kernel
  .amdhsa_next_free_vgpr 512
  .amdhsa_next_free_sgpr 102
  .amdhsa_accum_offset 256
  .amdhsa_group_segment_fixed_size 0
  .amdhsa_kernarg_size 128
  .amdhsa_user_sgpr_count 2
  .amdhsa_user_sgpr_kernarg_segment_ptr 1
  .amdhsa_system_sgpr_workgroup_id_x 1
  .amdhsa_float_denorm_mode_32 3
.end_amdhsa_kernel
```
